```python
import torch

def _softmax(x, axis=-1):
    return torch.softmax(x, dim=axis)
def _gelu(x):
    return torch.nn.functional.gelu(x, approximate="tanh")
def _silu(x):
    return torch.nn.functional.silu(x)
def _sigmoid(x):
    return torch.sigmoid(x)
def _layernorm(x, axis=-1, eps=1e-5):
    m = x.mean(dim=axis, keepdim=True)
    v = x.var(dim=axis, keepdim=True, unbiased=False)
    return (x - m) / torch.sqrt(v + eps)
def _scatter_add(tgt, idx, src, axis=0):
    return tgt.clone().index_add_(axis, idx, src)
def _segment_sum(src, seg, n):
    out = torch.zeros((n,) + src.shape[1:], dtype=src.dtype)
    return out.index_add_(0, seg, src)
def _pad(x, pw):
    flat = tuple(v for pair in reversed(pw) for v in pair)
    return torch.nn.functional.pad(x, flat)

kernel_name = 'sequential_preLN__spectral_fnet__swiglu_ffn__prompt'

def setup_inputs():

    _w = (lambda a: (lambda t: t.to(torch.bfloat16) if t.is_floating_point() else t)(torch.as_tensor(a)))
    def _A_setup():
        B, S, D = 1, 2048, 576
        ns = torch.arange(S)[:, None] * torch.arange(S)[None, :]
        nd = torch.arange(D)[:, None] * torch.arange(D)[None, :]
        Ws_re = torch.cos(-2.0 * torch.pi * ns / S).to(float)
        Ws_im = torch.sin(-2.0 * torch.pi * ns / S).to(float)
        Wd_re = torch.cos(-2.0 * torch.pi * nd / D).to(float)
        Wd_im = torch.sin(-2.0 * torch.pi * nd / D).to(float)
        return {
            "x": _w((lambda *s: torch.randn(*s, dtype=torch.bfloat16) * 0.05)(B, S, D)),
            "dft_seq_re": _w(Ws_re),
            "dft_seq_im": _w(Ws_im),
            "dft_hid_re": _w(Wd_re),
            "dft_hid_im": _w(Wd_im),
        }
    _A_in = _A_setup()

    def _B_setup():
        B, S, D, F = 1, 2048, 576, 4608
        return {
            "x": _w((lambda *s: torch.randn(*s, dtype=torch.bfloat16) * 0.05)(B, S, D)),
            "w_gate": _w((lambda *s: torch.randn(*s, dtype=torch.bfloat16) * 0.2)(D, F)),
            "w_up": _w((lambda *s: torch.randn(*s, dtype=torch.bfloat16) * 0.2)(D, F)),
            "w_down": _w((lambda *s: torch.randn(*s, dtype=torch.bfloat16) * 0.2)(F, D)),
        }
    _B_in = _B_setup()

    return {
        "A_x": _A_in["x"],
        "A_dft_seq_re": _A_in["dft_seq_re"],
        "A_dft_seq_im": _A_in["dft_seq_im"],
        "A_dft_hid_re": _A_in["dft_hid_re"],
        "A_dft_hid_im": _A_in["dft_hid_im"],
        "B_x": _B_in["x"],
        "B_w_gate": _B_in["w_gate"],
        "B_w_up": _B_in["w_up"],
        "B_w_down": _B_in["w_down"],
    }

def reference(A_x, A_dft_seq_re, A_dft_seq_im, A_dft_hid_re, A_dft_hid_im, B_x, B_w_gate, B_w_up, B_w_down):
    def _A_ref(x, dft_seq_re, dft_seq_im, dft_hid_re, dft_hid_im):
        a = torch.einsum("bsd,ed->bse", x, dft_hid_re)
        b = torch.einsum("bsd,ed->bse", x, dft_hid_im)
        y = torch.einsum("ts,bse->bte", dft_seq_re, a) - torch.einsum("ts,bse->bte", dft_seq_im, b)
        return y

    def _B_ref(x, w_gate, w_up, w_down):
        g = _silu(x @ w_gate)
        u = x @ w_up
        return (g * u) @ w_down

    x = A_x
    h = x + _A_ref(_layernorm(x, axis=-1), A_dft_seq_re, A_dft_seq_im, A_dft_hid_re, A_dft_hid_im)
    h2 = h + _B_ref(_layernorm(h, axis=-1), B_w_gate, B_w_up, B_w_down)
    return h2
```

```asm
; @launch grid=(256,1,1) block=(256,1,1) lds=163840
.amdgcn_target "amdgcn-amd-amdhsa--gfx950"
.text
.globl sequential_preLN__spectral_fnet__swiglu_ffn__prompt_kernel
.p2align 8
.type sequential_preLN__spectral_fnet__swiglu_ffn__prompt_kernel,@function
sequential_preLN__spectral_fnet__swiglu_ffn__prompt_kernel:
    s_cmp_ge_u32 s2, 256
    s_cbranch_scc1 Lend
    s_load_dwordx2 s[4:5], s[0:1], 88
    s_load_dwordx8 s[36:43], s[0:1], 0
    s_load_dwordx2 s[44:45], s[0:1], 32
    s_load_dwordx2 s[52:53], s[0:1], 64
    v_lshrrev_b32 v2, 6, v0
    v_and_b32 v1, 63, v0
    v_lshlrev_b32 v4, 4, v1
    v_readfirstlane_b32 s3, v2
    v_and_b32 v2, 15, v1
    v_lshrrev_b32 v3, 4, v1
    s_and_b32 s7, s2, 7
    s_lshr_b32 s8, s2, 3
    s_and_b32 s23, s8, 3
    s_cmp_lg_u32 s23, 3
    s_cbranch_scc1 Lnc
    s_and_b32 s24, s8, -4
    s_add_u32 s24, s24, s3
    s_cmp_lt_u32 s24, 24
    s_cbranch_scc1 Lrolec
    s_getpc_b64 s[28:29]
Lpc:
    s_sub_u32 s30, s24, 24
    s_lshl_b32 s30, s30, 13
    v_lshlrev_b32 v5, 7, v1
    v_add_u32 v5, s30, v5
    v_min_u32 v5, Lcodeend-Lpc, v5
    v_mov_b32 v7, s29
    v_add_co_u32 v6, vcc, s28, v5
    s_nop 1
    v_addc_co_u32 v7, vcc, 0, v7, vcc
    global_load_dword v30, v[6:7], off
    s_branch Lrolec
Lnc:
    s_lshl_b32 s24, s7, 2
    s_lshr_b32 s25, s8, 3
    s_add_u32 s24, s24, s25
    s_bfe_u32 s26, s8, 0x10002
    s_and_b32 s25, s8, 1
    s_lshl_b32 s51, s24, 2
    s_lshl_b32 s27, s26, 1
    s_add_u32 s51, s51, s27
    s_add_u32 s51, s51, s25
    s_lshl_b32 s27, s26, 5
    s_cmp_eq_u32 s24, 0
    s_cselect_b32 s46, s27, s24
    s_cselect_b32 s48, 0, -1
    s_cselect_b32 s47, 0, 32
    s_cselect_b32 s26, 0, s26
    s_add_u32 s47, s47, s46
    s_sub_u32 s27, 64, s46
    s_cmp_eq_u32 s26, 1
    s_cselect_b32 s27, s27, s46
    s_cselect_b32 s49, 0x80008000, 0
    s_lshl_b32 s50, s25, 10
    s_add_u32 s50, s50, s27
    v_lshrrev_b32 v17, 2, v1
    v_lshlrev_b32 v17, 18, v17
    v_and_b32 v18, 3, v1
    v_lshl_add_u32 v17, v18, 4, v17
    s_lshl_b32 s27, s50, 12
    v_add_u32 v17, s27, v17
    s_lshr_b32 s25, s8, 2
    s_sub_u32 s25, s8, s25
    s_and_b32 s24, s25, 3
    s_lshl_b32 s24, s24, 3
    s_add_u32 s24, s24, s7
    s_lshr_b32 s25, s25, 2
    s_mul_i32 s26, s25, 6
    s_lshl_b32 s27, s3, 1
    s_add_u32 s26, s26, s27
    v_lshrrev_b32 v5, 3, v1
    v_and_b32 v6, 7, v1
    v_xor_b32 v6, v6, v3
    v_lshlrev_b32 v6, 4, v6
    v_mul_u32_u24 v7, 36864, v5
    v_add_u32 v7, v7, v6
    v_xor_b32 v19, 64, v7
    v_add_u32 v19, 294912, v19
    s_mul_i32 s28, s3, 18432
    s_mul_i32 s29, s3, 589824
    s_mul_i32 s30, s24, 1152
    s_add_u32 s29, s29, s30
    s_mul_i32 s20, s25, 3
    s_lshr_b32 s20, s20, 1
    s_lshr_b32 s21, s24, 3
    s_lshl_b32 s21, s21, 1
    s_add_u32 s20, s20, s21
    s_cmp_ge_u32 s20, 9
    s_cselect_b32 s21, 9, 0
    s_sub_u32 s20, s20, s21
    s_sub_u32 s21, 9, s20
    s_lshl_b32 s20, s20, 7
    s_mov_b32 s18, 2360448
    s_mov_b32 s19, 0x20000
    s_cmp_lt_u32 s26, 18
    s_cselect_b32 s27, 0, 18
    s_sub_u32 s27, s26, s27
    s_mul_i32 s27, s27, 18432
    s_add_u32 s27, s27, s20
    s_add_u32 s23, s20, 331776
    v_mul_u32_u24 v8, 1152, v5
    v_add_u32 v8, v8, v6
    v_xor_b32 v14, 64, v8
    v_add_u32 v14, 9216, v14
    v_add_u32 v15, 18432, v8
    v_add_u32 v16, 18432, v14
    v_xor_b32 v15, 32, v15
    v_xor_b32 v16, 32, v16
    s_mul_i32 s31, s3, 24576
    s_add_u32 s31, s31, 73728
    s_waitcnt lgkmcnt(0)
    s_add_u32 s16, s36, s20
    s_addc_u32 s17, s37, 0
    s_add_u32 m0, s28, 0
    s_nop 0
    buffer_load_dwordx4 v7, s[16:19], s29 offen offset:0 lds
    s_add_u32 m0, s28, 9216
    s_nop 0
    buffer_load_dwordx4 v19, s[16:19], s29 offen offset:0 lds
    s_cmp_eq_u32 s21, 1
    s_cselect_b32 s22, 1152, 0
    s_sub_u32 s16, s16, s22
    s_subb_u32 s17, s17, 0
    s_add_u32 m0, s28, 896
    s_nop 0
    buffer_load_dwordx4 v7, s[16:19], s29 offen offset:128 lds
    s_add_u32 m0, s28, 10112
    s_nop 0
    buffer_load_dwordx4 v19, s[16:19], s29 offen offset:128 lds
    s_cmp_eq_u32 s3, 3
    s_cbranch_scc1 Lstat_1
    s_cmp_lt_u32 s26, 18
    s_cselect_b64 s[32:33], s[42:43], s[44:45]
    s_add_u32 s32, s32, s27
    s_addc_u32 s33, s33, 0
    s_add_u32 s34, s42, s23
    s_addc_u32 s35, s43, 0
    s_cmp_eq_u32 s26, 18
    s_cselect_b64 s[34:35], s[34:35], s[32:33]
    v_cmp_eq_u32 vcc, 0, v5
    v_mov_b32 v12, s32
    v_mov_b32 v13, s33
    v_mov_b32 v10, s34
    v_mov_b32 v11, s35
    v_cndmask_b32 v12, v12, v10, vcc
    v_cndmask_b32 v13, v13, v11, vcc
    v_add_co_u32 v12, vcc, v12, v8
    s_nop 1
    v_addc_co_u32 v13, vcc, 0, v13, vcc
    s_add_u32 m0, s31, 0
    s_nop 0
    global_load_lds_dwordx4 v[12:13], off offset:0
    s_add_u32 m0, s31, 1024
    s_nop 0
    global_load_lds_dwordx4 v14, s[32:33] offset:0
    s_add_u32 m0, s31, 2048
    s_nop 0
    global_load_lds_dwordx4 v15, s[32:33] offset:0
    s_add_u32 m0, s31, 3072
    s_nop 0
    global_load_lds_dwordx4 v16, s[32:33] offset:0
    s_cmp_eq_u32 s21, 1
    s_cselect_b32 s23, 1152, 0
    v_subrev_co_u32 v12, vcc, s23, v12
    s_sub_u32 s32, s32, s23
    s_subb_u32 s33, s33, 0
    v_subbrev_co_u32 v13, vcc, 0, v13, vcc
    s_add_u32 m0, s31, 3968
    s_nop 0
    global_load_lds_dwordx4 v[12:13], off offset:128
    s_add_u32 m0, s31, 4992
    s_nop 0
    global_load_lds_dwordx4 v14, s[32:33] offset:128
    s_add_u32 m0, s31, 6016
    s_nop 0
    global_load_lds_dwordx4 v15, s[32:33] offset:128
    s_add_u32 m0, s31, 7040
    s_nop 0
    global_load_lds_dwordx4 v16, s[32:33] offset:128
    s_load_dword s10, s[4:5], 0
    s_andn2_b32 s9, s3, s8
    s_bitcmp0_b32 s9, 1
    s_cbranch_scc1 Lnco_3
    s_lshl_b32 s9, s3, 10
    s_add_u32 m0, s9, 158720
    s_cmp_eq_u32 s3, 2
    s_cselect_b64 s[12:13], s[38:39], s[40:41]
    global_load_lds_dwordx4 v17, s[12:13]
Lnco_3:
    s_mov_b32 s12, s4
    s_mov_b32 s13, s5
    s_mov_b32 s14, 0x60000
    s_mov_b32 s15, 0x20000
    v_lshrrev_b32 v10, 1, v2
    v_xor_b32 v10, v10, v3
    v_lshlrev_b32 v10, 4, v10
    v_and_b32 v11, 7, v2
    v_lshl_add_u32 v10, v11, 7, v10
    v_lshrrev_b32 v9, 3, v2
    v_mov_b32 v72, 0x3f803f80
    v_mov_b32 v73, 0x3f803f80
    v_mov_b32 v74, 0x3f803f80
    v_mov_b32 v75, 0x3f803f80
    v_lshrrev_b32 v5, 2, v2
    v_bfe_u32 v6, v2, 1, 1
    v_and_b32 v17, 1, v5
    v_lshl_or_b32 v6, v17, 2, v6
    v_lshl_or_b32 v6, v9, 1, v6
    v_xor_b32 v6, v6, v3
    v_lshlrev_b32 v6, 4, v6
    v_lshl_or_b32 v6, v5, 10, v6
    v_and_b32 v5, 3, v2
    v_lshl_or_b32 v6, v5, 7, v6
    v_add_u32 v20, s31, v6
    v_xor_b32 v21, 64, v20
    v_xor_b32 v22, 544, v20
    v_xor_b32 v23, 64, v22
    v_lshrrev_b32 v5, 2, v1
    v_and_b32 v6, 3, v1
    v_mul_u32_u24 v24, 36864, v5
    v_lshl_add_u32 v24, v6, 4, v24
    s_mul_i32 s27, s3, 5120
    v_mul_u32_u24 v25, 80, v5
    v_lshl_add_u32 v25, v6, 4, v25
    v_add_u32 v25, s27, v25
    v_mul_u32_u24 v17, 80, v2
    v_lshl_add_u32 v17, v3, 4, v17
    v_add_u32 v17, s27, v17
    v_mul_u32_u24 v9, 9216, v9
    v_add_u32 v10, v10, v9
    v_xor_b32 v11, 64, v10
    v_lshrrev_b32 v5, 1, v2
    v_lshrrev_b32 v6, 1, v3
    v_xor_b32 v5, v5, v6
    v_lshlrev_b32 v5, 4, v5
    v_lshl_add_u32 v5, v2, 7, v5
    v_and_b32 v6, 1, v3
    v_lshl_add_u32 v5, v6, 3, v5
    v_add_u32 v26, 147456, v5
    v_xor_b32 v27, 32, v26
    v_xor_b32 v28, 64, v26
    v_xor_b32 v29, 96, v26
    s_call_b64 s[96:97], LhopdispE
    s_branch Lp1a
Lstat_1:
    s_load_dword s10, s[4:5], 0
    s_andn2_b32 s9, s3, s8
    s_bitcmp0_b32 s9, 1
    s_cbranch_scc1 Lnco_4
    s_lshl_b32 s9, s3, 10
    s_add_u32 m0, s9, 158720
    s_cmp_eq_u32 s3, 2
    s_cselect_b64 s[12:13], s[38:39], s[40:41]
    global_load_lds_dwordx4 v17, s[12:13]
Lnco_4:
    s_mov_b32 s12, s4
    s_mov_b32 s13, s5
    s_mov_b32 s14, 0x60000
    s_mov_b32 s15, 0x20000
    s_add_u32 s34, s38, 4194304
    s_addc_u32 s35, s39, 0
    v_lshl_add_u32 v8, v5, 17, v6
    v_mov_b32 v12, s40
    v_mov_b32 v13, s41
    v_mov_b32 v14, s34
    v_mov_b32 v15, s35
    v_cmp_eq_u32 vcc, 0, v5
    s_nop 1
    v_cndmask_b32 v12, v12, v14, vcc
    v_cndmask_b32 v13, v13, v15, vcc
    v_add_co_u32 v12, vcc, v12, v8
    v_xor_b32 v14, 64, v8
    v_add_u32 v14, 1048576, v14
    v_addc_co_u32 v13, vcc, 0, v13, vcc
    v_add_u32 v15, 2097152, v8
    v_add_u32 v16, 2097152, v14
    v_lshrrev_b32 v10, 1, v2
    v_xor_b32 v10, v10, v3
    v_lshlrev_b32 v10, 4, v10
    v_and_b32 v11, 7, v2
    v_lshl_add_u32 v10, v11, 7, v10
    v_lshrrev_b32 v9, 3, v2
    v_mov_b32 v72, 0x3f803f80
    v_mov_b32 v73, 0x3f803f80
    v_mov_b32 v74, 0x3f803f80
    v_mov_b32 v75, 0x3f803f80
    v_mul_u32_u24 v9, 9216, v9
    v_add_u32 v10, v10, v9
    v_xor_b32 v11, 64, v10
    s_add_u32 s31, s30, 589824
    s_add_u32 s32, s30, 1179648
    s_add_u32 s33, s30, 1769472
    v_mul_u32_u24 v18, 73728, v2
    v_lshl_add_u32 v18, v3, 7, v18
    s_mul_i32 s34, s50, 1152
    v_and_b32 v26, 3, v2
    v_lshrrev_b32 v27, 2, v2
    v_cmp_eq_u32 s[80:81], 1, v26
    v_cmp_eq_u32 s[82:83], 2, v26
    v_cmp_eq_u32 s[84:85], 3, v26
    v_cmp_eq_u32 s[86:87], v27, v3
    v_lshlrev_b32 v26, 2, v2
    v_add_u32 v26, 155648, v26
    s_call_b64 s[96:97], LhopdispE
    s_branch Lp1b
LhopdispE:
    s_mov_b64 exec, 0
    s_cmp_eq_u32 s3, 0
    s_cbranch_scc1 Lhop1
    s_cmp_eq_u32 s3, 1
    s_cbranch_scc1 Lhop2
    s_cmp_eq_u32 s3, 2
    s_cbranch_scc1 Lhop3
    s_branch Lhopret
LhopdispF:
    s_mov_b64 exec, 0
    s_cmp_eq_u32 s3, 0
    s_cbranch_scc1 Lhop4
    s_cmp_eq_u32 s3, 1
    s_cbranch_scc1 Lhop5
    s_cmp_eq_u32 s3, 2
    s_cbranch_scc1 Lhop6
    s_cmp_eq_u32 s3, 3
    s_cbranch_scc1 Lhop7
    s_branch Lhopret
Lhopret:
    s_mov_b64 exec, -1
    s_setpc_b64 s[96:97]
.p2align 12
Lp1a:
    s_cmp_eq_u32 s21, 2
    s_cselect_b32 s22, 1152, 0
    s_sub_u32 s16, s16, s22
    s_subb_u32 s17, s17, 0
    s_add_u32 m0, s28, 1792
    s_nop 0
    buffer_load_dwordx4 v7, s[16:19], s29 offen offset:256 lds
    s_add_u32 m0, s28, 11008
    s_nop 0
    buffer_load_dwordx4 v19, s[16:19], s29 offen offset:256 lds
    s_cmp_eq_u32 s21, 3
    s_cselect_b32 s22, 1152, 0
    s_sub_u32 s16, s16, s22
    s_subb_u32 s17, s17, 0
    s_add_u32 m0, s28, 2688
    s_nop 0
    buffer_load_dwordx4 v7, s[16:19], s29 offen offset:384 lds
    s_add_u32 m0, s28, 11904
    s_nop 0
    buffer_load_dwordx4 v19, s[16:19], s29 offen offset:384 lds
    s_cmp_eq_u32 s21, 2
    s_cselect_b32 s23, 1152, 0
    v_subrev_co_u32 v12, vcc, s23, v12
    s_sub_u32 s32, s32, s23
    s_subb_u32 s33, s33, 0
    v_subbrev_co_u32 v13, vcc, 0, v13, vcc
    s_add_u32 m0, s31, 7936
    s_nop 0
    global_load_lds_dwordx4 v[12:13], off offset:256
    s_add_u32 m0, s31, 8960
    s_nop 0
    global_load_lds_dwordx4 v14, s[32:33] offset:256
    s_add_u32 m0, s31, 9984
    s_nop 0
    global_load_lds_dwordx4 v15, s[32:33] offset:256
    s_add_u32 m0, s31, 11008
    s_nop 0
    global_load_lds_dwordx4 v16, s[32:33] offset:256
    s_cmp_eq_u32 s21, 3
    s_cselect_b32 s23, 1152, 0
    v_subrev_co_u32 v12, vcc, s23, v12
    s_sub_u32 s32, s32, s23
    s_subb_u32 s33, s33, 0
    v_subbrev_co_u32 v13, vcc, 0, v13, vcc
    s_waitcnt vmcnt(12) lgkmcnt(0)
    s_barrier
    ds_read_b128 v[140:143], v20 offset:0
    ds_read_b128 v[144:147], v22 offset:0
    ds_read_b128 v[108:111], v10 offset:0
    ds_read_b128 v[112:115], v10 offset:18432
    ds_read_b128 v[116:119], v10 offset:36864
    ds_read_b128 v[120:123], v10 offset:55296
    ds_read_b128 v[148:151], v21 offset:0
    ds_read_b128 v[152:155], v23 offset:0
    ds_read_b128 v[124:127], v11 offset:0
    ds_read_b128 v[128:131], v11 offset:18432
    ds_read_b128 v[132:135], v11 offset:36864
    ds_read_b128 v[136:139], v11 offset:55296
    s_waitcnt lgkmcnt(8)
    v_mfma_f32_16x16x32_bf16 v[32:35], v[108:111], v[140:143], 0
    s_waitcnt vmcnt(8)
    ds_read_b128 v[156:159], v20 offset:4096
    v_mfma_f32_16x16x32_bf16 v[48:51], v[108:111], v[144:147], 0
    ds_read_b128 v[108:111], v10 offset:1024
    v_mfma_f32_16x16x32_bf16 v[36:39], v[112:115], v[140:143], 0
    s_add_u32 m0, s31, 11904
    ds_read_b128 v[160:163], v22 offset:4096
    v_mfma_f32_16x16x32_bf16 v[52:55], v[112:115], v[144:147], 0
    s_waitcnt lgkmcnt(9)
    ds_read_b128 v[112:115], v10 offset:19456
    v_mfma_f32_16x16x32_bf16 v[40:43], v[116:119], v[140:143], 0
    global_load_lds_dwordx4 v[12:13], off offset:384
    v_mfma_f32_16x16x32_bf16 v[56:59], v[116:119], v[144:147], 0
    s_add_u32 m0, s31, 12928
    ds_read_b128 v[116:119], v10 offset:37888
    v_mfma_f32_16x16x32_bf16 v[44:47], v[120:123], v[140:143], 0
    global_load_lds_dwordx4 v14, s[32:33] offset:384
    v_mfma_f32_16x16x32_bf16 v[60:63], v[120:123], v[144:147], 0
    ds_read_b128 v[120:123], v10 offset:56320
    v_mfma_f32_16x16x32_bf16 v[64:67], v[72:75], v[140:143], 0
    v_mfma_f32_16x16x32_bf16 v[68:71], v[72:75], v[144:147], 0
    s_waitcnt lgkmcnt(8)
    v_mfma_f32_16x16x32_bf16 v[32:35], v[124:127], v[148:151], v[32:35]
    s_cmp_eq_u32 s21, 4
    s_cselect_b32 s23, 1152, 0
    ds_read_b128 v[140:143], v21 offset:4096
    v_mfma_f32_16x16x32_bf16 v[48:51], v[124:127], v[152:155], v[48:51]
    ds_read_b128 v[124:127], v11 offset:1024
    v_subrev_co_u32 v12, vcc, s23, v12
    v_mfma_f32_16x16x32_bf16 v[36:39], v[128:131], v[148:151], v[36:39]
    s_add_u32 m0, s31, 13952
    ds_read_b128 v[144:147], v23 offset:4096
    v_mfma_f32_16x16x32_bf16 v[52:55], v[128:131], v[152:155], v[52:55]
    s_waitcnt lgkmcnt(9)
    ds_read_b128 v[128:131], v11 offset:19456
    v_subbrev_co_u32 v13, vcc, 0, v13, vcc
    v_mfma_f32_16x16x32_bf16 v[40:43], v[132:135], v[148:151], v[40:43]
    global_load_lds_dwordx4 v15, s[32:33] offset:384
    v_mfma_f32_16x16x32_bf16 v[56:59], v[132:135], v[152:155], v[56:59]
    s_add_u32 m0, s31, 14976
    ds_read_b128 v[132:135], v11 offset:37888
    v_mfma_f32_16x16x32_bf16 v[44:47], v[136:139], v[148:151], v[44:47]
    global_load_lds_dwordx4 v16, s[32:33] offset:384
    v_mfma_f32_16x16x32_bf16 v[60:63], v[136:139], v[152:155], v[60:63]
    ds_read_b128 v[136:139], v11 offset:56320
    v_mfma_f32_16x16x32_bf16 v[64:67], v[72:75], v[148:151], v[64:67]
    s_sub_u32 s32, s32, s23
    s_subb_u32 s33, s33, 0
    v_mfma_f32_16x16x32_bf16 v[68:71], v[72:75], v[152:155], v[68:71]
    s_waitcnt lgkmcnt(8)
    v_mfma_f32_16x16x32_bf16 v[32:35], v[108:111], v[156:159], v[32:35]
    s_waitcnt vmcnt(4)
    s_barrier
    ds_read_b128 v[148:151], v20 offset:8192
    v_mfma_f32_16x16x32_bf16 v[48:51], v[108:111], v[160:163], v[48:51]
    ds_read_b128 v[108:111], v10 offset:2048
    v_mfma_f32_16x16x32_bf16 v[36:39], v[112:115], v[156:159], v[36:39]
    s_add_u32 m0, s31, 15872
    ds_read_b128 v[152:155], v22 offset:8192
    v_mfma_f32_16x16x32_bf16 v[52:55], v[112:115], v[160:163], v[52:55]
    s_waitcnt lgkmcnt(9)
    ds_read_b128 v[112:115], v10 offset:20480
    v_mfma_f32_16x16x32_bf16 v[40:43], v[116:119], v[156:159], v[40:43]
    global_load_lds_dwordx4 v[12:13], off offset:512
    v_mfma_f32_16x16x32_bf16 v[56:59], v[116:119], v[160:163], v[56:59]
    s_add_u32 m0, s31, 16896
    ds_read_b128 v[116:119], v10 offset:38912
    v_mfma_f32_16x16x32_bf16 v[44:47], v[120:123], v[156:159], v[44:47]
    global_load_lds_dwordx4 v14, s[32:33] offset:512
    v_mfma_f32_16x16x32_bf16 v[60:63], v[120:123], v[160:163], v[60:63]
    ds_read_b128 v[120:123], v10 offset:57344
    v_mfma_f32_16x16x32_bf16 v[64:67], v[72:75], v[156:159], v[64:67]
    v_mfma_f32_16x16x32_bf16 v[68:71], v[72:75], v[160:163], v[68:71]
    s_waitcnt lgkmcnt(8)
    v_mfma_f32_16x16x32_bf16 v[32:35], v[124:127], v[140:143], v[32:35]
    s_cmp_eq_u32 s21, 5
    s_cselect_b32 s23, 1152, 0
    ds_read_b128 v[156:159], v21 offset:8192
    v_mfma_f32_16x16x32_bf16 v[48:51], v[124:127], v[144:147], v[48:51]
    ds_read_b128 v[124:127], v11 offset:2048
    v_subrev_co_u32 v12, vcc, s23, v12
    v_mfma_f32_16x16x32_bf16 v[36:39], v[128:131], v[140:143], v[36:39]
    s_add_u32 m0, s31, 17920
    ds_read_b128 v[160:163], v23 offset:8192
    v_mfma_f32_16x16x32_bf16 v[52:55], v[128:131], v[144:147], v[52:55]
    s_waitcnt lgkmcnt(9)
    ds_read_b128 v[128:131], v11 offset:20480
    v_subbrev_co_u32 v13, vcc, 0, v13, vcc
    v_mfma_f32_16x16x32_bf16 v[40:43], v[132:135], v[140:143], v[40:43]
    global_load_lds_dwordx4 v15, s[32:33] offset:512
    v_mfma_f32_16x16x32_bf16 v[56:59], v[132:135], v[144:147], v[56:59]
    s_add_u32 m0, s31, 18944
    ds_read_b128 v[132:135], v11 offset:38912
    v_mfma_f32_16x16x32_bf16 v[44:47], v[136:139], v[140:143], v[44:47]
    global_load_lds_dwordx4 v16, s[32:33] offset:512
    v_mfma_f32_16x16x32_bf16 v[60:63], v[136:139], v[144:147], v[60:63]
    ds_read_b128 v[136:139], v11 offset:57344
    v_mfma_f32_16x16x32_bf16 v[64:67], v[72:75], v[140:143], v[64:67]
    s_sub_u32 s32, s32, s23
    s_subb_u32 s33, s33, 0
    v_mfma_f32_16x16x32_bf16 v[68:71], v[72:75], v[144:147], v[68:71]
    s_waitcnt lgkmcnt(8)
    v_mfma_f32_16x16x32_bf16 v[32:35], v[108:111], v[148:151], v[32:35]
    s_waitcnt vmcnt(4)
    ds_read_b128 v[140:143], v20 offset:12288
    v_mfma_f32_16x16x32_bf16 v[48:51], v[108:111], v[152:155], v[48:51]
    ds_read_b128 v[108:111], v10 offset:3072
    v_mfma_f32_16x16x32_bf16 v[36:39], v[112:115], v[148:151], v[36:39]
    s_add_u32 m0, s31, 19840
    ds_read_b128 v[144:147], v22 offset:12288
    v_mfma_f32_16x16x32_bf16 v[52:55], v[112:115], v[152:155], v[52:55]
    s_waitcnt lgkmcnt(9)
    ds_read_b128 v[112:115], v10 offset:21504
    v_mfma_f32_16x16x32_bf16 v[40:43], v[116:119], v[148:151], v[40:43]
    global_load_lds_dwordx4 v[12:13], off offset:640
    v_mfma_f32_16x16x32_bf16 v[56:59], v[116:119], v[152:155], v[56:59]
    s_add_u32 m0, s31, 20864
    ds_read_b128 v[116:119], v10 offset:39936
    v_mfma_f32_16x16x32_bf16 v[44:47], v[120:123], v[148:151], v[44:47]
    global_load_lds_dwordx4 v14, s[32:33] offset:640
    v_mfma_f32_16x16x32_bf16 v[60:63], v[120:123], v[152:155], v[60:63]
    ds_read_b128 v[120:123], v10 offset:58368
    v_mfma_f32_16x16x32_bf16 v[64:67], v[72:75], v[148:151], v[64:67]
    v_mfma_f32_16x16x32_bf16 v[68:71], v[72:75], v[152:155], v[68:71]
    s_waitcnt lgkmcnt(8)
    v_mfma_f32_16x16x32_bf16 v[32:35], v[124:127], v[156:159], v[32:35]
    s_cmp_eq_u32 s21, 6
    s_cselect_b32 s23, 1152, 0
    ds_read_b128 v[148:151], v21 offset:12288
    v_mfma_f32_16x16x32_bf16 v[48:51], v[124:127], v[160:163], v[48:51]
    ds_read_b128 v[124:127], v11 offset:3072
    v_subrev_co_u32 v12, vcc, s23, v12
    v_mfma_f32_16x16x32_bf16 v[36:39], v[128:131], v[156:159], v[36:39]
    s_add_u32 m0, s31, 21888
    ds_read_b128 v[152:155], v23 offset:12288
    v_mfma_f32_16x16x32_bf16 v[52:55], v[128:131], v[160:163], v[52:55]
    s_waitcnt lgkmcnt(9)
    ds_read_b128 v[128:131], v11 offset:21504
    v_subbrev_co_u32 v13, vcc, 0, v13, vcc
    v_mfma_f32_16x16x32_bf16 v[40:43], v[132:135], v[156:159], v[40:43]
    global_load_lds_dwordx4 v15, s[32:33] offset:640
    v_mfma_f32_16x16x32_bf16 v[56:59], v[132:135], v[160:163], v[56:59]
    s_add_u32 m0, s31, 22912
    ds_read_b128 v[132:135], v11 offset:39936
    v_mfma_f32_16x16x32_bf16 v[44:47], v[136:139], v[156:159], v[44:47]
    global_load_lds_dwordx4 v16, s[32:33] offset:640
    v_mfma_f32_16x16x32_bf16 v[60:63], v[136:139], v[160:163], v[60:63]
    ds_read_b128 v[136:139], v11 offset:58368
    v_mfma_f32_16x16x32_bf16 v[64:67], v[72:75], v[156:159], v[64:67]
    s_sub_u32 s32, s32, s23
    s_subb_u32 s33, s33, 0
    v_mfma_f32_16x16x32_bf16 v[68:71], v[72:75], v[160:163], v[68:71]
    s_waitcnt lgkmcnt(8)
    v_mfma_f32_16x16x32_bf16 v[32:35], v[108:111], v[140:143], v[32:35]
    s_waitcnt vmcnt(4)
    s_barrier
    ds_read_b128 v[156:159], v20 offset:16384
    v_mfma_f32_16x16x32_bf16 v[48:51], v[108:111], v[144:147], v[48:51]
    ds_read_b128 v[108:111], v10 offset:4096
    v_mfma_f32_16x16x32_bf16 v[36:39], v[112:115], v[140:143], v[36:39]
    s_add_u32 m0, s31, -768
    ds_read_b128 v[160:163], v22 offset:16384
    v_mfma_f32_16x16x32_bf16 v[52:55], v[112:115], v[144:147], v[52:55]
    s_waitcnt lgkmcnt(9)
    ds_read_b128 v[112:115], v10 offset:22528
    v_mfma_f32_16x16x32_bf16 v[40:43], v[116:119], v[140:143], v[40:43]
    global_load_lds_dwordx4 v[12:13], off offset:768
    v_mfma_f32_16x16x32_bf16 v[56:59], v[116:119], v[144:147], v[56:59]
    s_add_u32 m0, s31, 256
    ds_read_b128 v[116:119], v10 offset:40960
    v_mfma_f32_16x16x32_bf16 v[44:47], v[120:123], v[140:143], v[44:47]
    global_load_lds_dwordx4 v14, s[32:33] offset:768
    v_mfma_f32_16x16x32_bf16 v[60:63], v[120:123], v[144:147], v[60:63]
    ds_read_b128 v[120:123], v10 offset:59392
    v_mfma_f32_16x16x32_bf16 v[64:67], v[72:75], v[140:143], v[64:67]
    v_mfma_f32_16x16x32_bf16 v[68:71], v[72:75], v[144:147], v[68:71]
    s_waitcnt lgkmcnt(8)
    v_mfma_f32_16x16x32_bf16 v[32:35], v[124:127], v[148:151], v[32:35]
    s_cmp_eq_u32 s21, 7
    s_cselect_b32 s23, 1152, 0
    ds_read_b128 v[140:143], v21 offset:16384
    v_mfma_f32_16x16x32_bf16 v[48:51], v[124:127], v[152:155], v[48:51]
    ds_read_b128 v[124:127], v11 offset:4096
    v_subrev_co_u32 v12, vcc, s23, v12
    v_mfma_f32_16x16x32_bf16 v[36:39], v[128:131], v[148:151], v[36:39]
    s_add_u32 m0, s31, 1280
    ds_read_b128 v[144:147], v23 offset:16384
    v_mfma_f32_16x16x32_bf16 v[52:55], v[128:131], v[152:155], v[52:55]
    s_waitcnt lgkmcnt(9)
    ds_read_b128 v[128:131], v11 offset:22528
    v_subbrev_co_u32 v13, vcc, 0, v13, vcc
    v_mfma_f32_16x16x32_bf16 v[40:43], v[132:135], v[148:151], v[40:43]
    global_load_lds_dwordx4 v15, s[32:33] offset:768
    v_mfma_f32_16x16x32_bf16 v[56:59], v[132:135], v[152:155], v[56:59]
    s_add_u32 m0, s31, 2304
    ds_read_b128 v[132:135], v11 offset:40960
    v_mfma_f32_16x16x32_bf16 v[44:47], v[136:139], v[148:151], v[44:47]
    global_load_lds_dwordx4 v16, s[32:33] offset:768
    v_mfma_f32_16x16x32_bf16 v[60:63], v[136:139], v[152:155], v[60:63]
    ds_read_b128 v[136:139], v11 offset:59392
    v_mfma_f32_16x16x32_bf16 v[64:67], v[72:75], v[148:151], v[64:67]
    s_sub_u32 s32, s32, s23
    s_subb_u32 s33, s33, 0
    v_mfma_f32_16x16x32_bf16 v[68:71], v[72:75], v[152:155], v[68:71]
    s_waitcnt lgkmcnt(8)
    v_mfma_f32_16x16x32_bf16 v[32:35], v[108:111], v[156:159], v[32:35]
    s_waitcnt vmcnt(4)
    ds_read_b128 v[148:151], v20 offset:20480
    v_mfma_f32_16x16x32_bf16 v[48:51], v[108:111], v[160:163], v[48:51]
    ds_read_b128 v[108:111], v10 offset:5120
    v_mfma_f32_16x16x32_bf16 v[36:39], v[112:115], v[156:159], v[36:39]
    s_add_u32 m0, s31, 3200
    ds_read_b128 v[152:155], v22 offset:20480
    v_mfma_f32_16x16x32_bf16 v[52:55], v[112:115], v[160:163], v[52:55]
    s_waitcnt lgkmcnt(9)
    ds_read_b128 v[112:115], v10 offset:23552
    v_mfma_f32_16x16x32_bf16 v[40:43], v[116:119], v[156:159], v[40:43]
    global_load_lds_dwordx4 v[12:13], off offset:896
    v_mfma_f32_16x16x32_bf16 v[56:59], v[116:119], v[160:163], v[56:59]
    s_add_u32 m0, s31, 4224
    ds_read_b128 v[116:119], v10 offset:41984
    v_mfma_f32_16x16x32_bf16 v[44:47], v[120:123], v[156:159], v[44:47]
    global_load_lds_dwordx4 v14, s[32:33] offset:896
    v_mfma_f32_16x16x32_bf16 v[60:63], v[120:123], v[160:163], v[60:63]
    ds_read_b128 v[120:123], v10 offset:60416
    v_mfma_f32_16x16x32_bf16 v[64:67], v[72:75], v[156:159], v[64:67]
    v_mfma_f32_16x16x32_bf16 v[68:71], v[72:75], v[160:163], v[68:71]
    s_waitcnt lgkmcnt(8)
    v_mfma_f32_16x16x32_bf16 v[32:35], v[124:127], v[140:143], v[32:35]
    s_cmp_eq_u32 s21, 8
    s_cselect_b32 s23, 1152, 0
    ds_read_b128 v[156:159], v21 offset:20480
    v_mfma_f32_16x16x32_bf16 v[48:51], v[124:127], v[144:147], v[48:51]
    ds_read_b128 v[124:127], v11 offset:5120
    v_subrev_co_u32 v12, vcc, s23, v12
    v_mfma_f32_16x16x32_bf16 v[36:39], v[128:131], v[140:143], v[36:39]
    s_add_u32 m0, s31, 5248
    ds_read_b128 v[160:163], v23 offset:20480
    v_mfma_f32_16x16x32_bf16 v[52:55], v[128:131], v[144:147], v[52:55]
    s_waitcnt lgkmcnt(9)
    ds_read_b128 v[128:131], v11 offset:23552
    v_subbrev_co_u32 v13, vcc, 0, v13, vcc
    v_mfma_f32_16x16x32_bf16 v[40:43], v[132:135], v[140:143], v[40:43]
    global_load_lds_dwordx4 v15, s[32:33] offset:896
    v_mfma_f32_16x16x32_bf16 v[56:59], v[132:135], v[144:147], v[56:59]
    s_add_u32 m0, s31, 6272
    ds_read_b128 v[132:135], v11 offset:41984
    v_mfma_f32_16x16x32_bf16 v[44:47], v[136:139], v[140:143], v[44:47]
    global_load_lds_dwordx4 v16, s[32:33] offset:896
    v_mfma_f32_16x16x32_bf16 v[60:63], v[136:139], v[144:147], v[60:63]
    ds_read_b128 v[136:139], v11 offset:60416
    v_mfma_f32_16x16x32_bf16 v[64:67], v[72:75], v[140:143], v[64:67]
    s_sub_u32 s32, s32, s23
    s_subb_u32 s33, s33, 0
    v_mfma_f32_16x16x32_bf16 v[68:71], v[72:75], v[144:147], v[68:71]
    s_waitcnt lgkmcnt(8)
    v_mfma_f32_16x16x32_bf16 v[32:35], v[108:111], v[148:151], v[32:35]
    s_waitcnt vmcnt(4)
    s_barrier
    ds_read_b128 v[140:143], v20 offset:0
    v_mfma_f32_16x16x32_bf16 v[48:51], v[108:111], v[152:155], v[48:51]
    ds_read_b128 v[108:111], v10 offset:6144
    v_mfma_f32_16x16x32_bf16 v[36:39], v[112:115], v[148:151], v[36:39]
    s_add_u32 m0, s31, 7168
    ds_read_b128 v[144:147], v22 offset:0
    v_mfma_f32_16x16x32_bf16 v[52:55], v[112:115], v[152:155], v[52:55]
    s_waitcnt lgkmcnt(9)
    ds_read_b128 v[112:115], v10 offset:24576
    v_mfma_f32_16x16x32_bf16 v[40:43], v[116:119], v[148:151], v[40:43]
    global_load_lds_dwordx4 v[12:13], off offset:1024
    v_mfma_f32_16x16x32_bf16 v[56:59], v[116:119], v[152:155], v[56:59]
    s_add_u32 m0, s31, 8192
    ds_read_b128 v[116:119], v10 offset:43008
    v_mfma_f32_16x16x32_bf16 v[44:47], v[120:123], v[148:151], v[44:47]
    global_load_lds_dwordx4 v14, s[32:33] offset:1024
    v_mfma_f32_16x16x32_bf16 v[60:63], v[120:123], v[152:155], v[60:63]
    ds_read_b128 v[120:123], v10 offset:61440
    v_mfma_f32_16x16x32_bf16 v[64:67], v[72:75], v[148:151], v[64:67]
    v_mfma_f32_16x16x32_bf16 v[68:71], v[72:75], v[152:155], v[68:71]
    s_waitcnt lgkmcnt(8)
    v_mfma_f32_16x16x32_bf16 v[32:35], v[124:127], v[156:159], v[32:35]
    ds_read_b128 v[148:151], v21 offset:0
    v_mfma_f32_16x16x32_bf16 v[48:51], v[124:127], v[160:163], v[48:51]
    ds_read_b128 v[124:127], v11 offset:6144
    v_mfma_f32_16x16x32_bf16 v[36:39], v[128:131], v[156:159], v[36:39]
    s_add_u32 m0, s31, 9216
    ds_read_b128 v[152:155], v23 offset:0
    v_mfma_f32_16x16x32_bf16 v[52:55], v[128:131], v[160:163], v[52:55]
    s_waitcnt lgkmcnt(9)
    ds_read_b128 v[128:131], v11 offset:24576
    v_mfma_f32_16x16x32_bf16 v[40:43], v[132:135], v[156:159], v[40:43]
    global_load_lds_dwordx4 v15, s[32:33] offset:1024
    v_mfma_f32_16x16x32_bf16 v[56:59], v[132:135], v[160:163], v[56:59]
    s_add_u32 m0, s31, 10240
    ds_read_b128 v[132:135], v11 offset:43008
    v_mfma_f32_16x16x32_bf16 v[44:47], v[136:139], v[156:159], v[44:47]
    global_load_lds_dwordx4 v16, s[32:33] offset:1024
    v_mfma_f32_16x16x32_bf16 v[60:63], v[136:139], v[160:163], v[60:63]
    ds_read_b128 v[136:139], v11 offset:61440
    v_mfma_f32_16x16x32_bf16 v[64:67], v[72:75], v[156:159], v[64:67]
    v_mfma_f32_16x16x32_bf16 v[68:71], v[72:75], v[160:163], v[68:71]
    s_waitcnt lgkmcnt(8)
    v_mfma_f32_16x16x32_bf16 v[32:35], v[108:111], v[140:143], v[32:35]
    s_waitcnt vmcnt(4)
    s_barrier
    ds_read_b128 v[156:159], v20 offset:4096
    v_mfma_f32_16x16x32_bf16 v[48:51], v[108:111], v[144:147], v[48:51]
    ds_read_b128 v[108:111], v10 offset:7168
    v_mfma_f32_16x16x32_bf16 v[36:39], v[112:115], v[140:143], v[36:39]
    ds_read_b128 v[160:163], v22 offset:4096
    v_mfma_f32_16x16x32_bf16 v[52:55], v[112:115], v[144:147], v[52:55]
    s_waitcnt lgkmcnt(9)
    ds_read_b128 v[112:115], v10 offset:25600
    v_mfma_f32_16x16x32_bf16 v[40:43], v[116:119], v[140:143], v[40:43]
    v_mfma_f32_16x16x32_bf16 v[56:59], v[116:119], v[144:147], v[56:59]
    ds_read_b128 v[116:119], v10 offset:44032
    v_mfma_f32_16x16x32_bf16 v[44:47], v[120:123], v[140:143], v[44:47]
    v_mfma_f32_16x16x32_bf16 v[60:63], v[120:123], v[144:147], v[60:63]
    ds_read_b128 v[120:123], v10 offset:62464
    v_mfma_f32_16x16x32_bf16 v[64:67], v[72:75], v[140:143], v[64:67]
    v_mfma_f32_16x16x32_bf16 v[68:71], v[72:75], v[144:147], v[68:71]
    s_waitcnt lgkmcnt(8)
    v_mfma_f32_16x16x32_bf16 v[32:35], v[124:127], v[148:151], v[32:35]
    ds_read_b128 v[140:143], v21 offset:4096
    v_mfma_f32_16x16x32_bf16 v[48:51], v[124:127], v[152:155], v[48:51]
    ds_read_b128 v[124:127], v11 offset:7168
    v_mfma_f32_16x16x32_bf16 v[36:39], v[128:131], v[148:151], v[36:39]
    ds_read_b128 v[144:147], v23 offset:4096
    v_mfma_f32_16x16x32_bf16 v[52:55], v[128:131], v[152:155], v[52:55]
    s_waitcnt lgkmcnt(9)
    ds_read_b128 v[128:131], v11 offset:25600
    v_mfma_f32_16x16x32_bf16 v[40:43], v[132:135], v[148:151], v[40:43]
    v_mfma_f32_16x16x32_bf16 v[56:59], v[132:135], v[152:155], v[56:59]
    ds_read_b128 v[132:135], v11 offset:44032
    v_mfma_f32_16x16x32_bf16 v[44:47], v[136:139], v[148:151], v[44:47]
    v_mfma_f32_16x16x32_bf16 v[60:63], v[136:139], v[152:155], v[60:63]
    ds_read_b128 v[136:139], v11 offset:62464
    v_mfma_f32_16x16x32_bf16 v[64:67], v[72:75], v[148:151], v[64:67]
    v_mfma_f32_16x16x32_bf16 v[68:71], v[72:75], v[152:155], v[68:71]
    s_waitcnt lgkmcnt(8)
    v_mfma_f32_16x16x32_bf16 v[32:35], v[108:111], v[156:159], v[32:35]
    s_waitcnt vmcnt(0)
    s_barrier
    ds_read_b128 v[148:151], v20 offset:8192
    v_mfma_f32_16x16x32_bf16 v[48:51], v[108:111], v[160:163], v[48:51]
    ds_read_b128 v[108:111], v10 offset:8192
    v_mfma_f32_16x16x32_bf16 v[36:39], v[112:115], v[156:159], v[36:39]
    ds_read_b128 v[152:155], v22 offset:8192
    v_mfma_f32_16x16x32_bf16 v[52:55], v[112:115], v[160:163], v[52:55]
    s_waitcnt lgkmcnt(9)
    ds_read_b128 v[112:115], v10 offset:26624
    v_mfma_f32_16x16x32_bf16 v[40:43], v[116:119], v[156:159], v[40:43]
    v_mfma_f32_16x16x32_bf16 v[56:59], v[116:119], v[160:163], v[56:59]
    ds_read_b128 v[116:119], v10 offset:45056
    v_mfma_f32_16x16x32_bf16 v[44:47], v[120:123], v[156:159], v[44:47]
    v_mfma_f32_16x16x32_bf16 v[60:63], v[120:123], v[160:163], v[60:63]
    ds_read_b128 v[120:123], v10 offset:63488
    v_mfma_f32_16x16x32_bf16 v[64:67], v[72:75], v[156:159], v[64:67]
    v_mfma_f32_16x16x32_bf16 v[68:71], v[72:75], v[160:163], v[68:71]
    s_waitcnt lgkmcnt(8)
    v_mfma_f32_16x16x32_bf16 v[32:35], v[124:127], v[140:143], v[32:35]
    ds_read_b128 v[156:159], v21 offset:8192
    v_mfma_f32_16x16x32_bf16 v[48:51], v[124:127], v[144:147], v[48:51]
    ds_read_b128 v[124:127], v11 offset:8192
    v_mfma_f32_16x16x32_bf16 v[36:39], v[128:131], v[140:143], v[36:39]
    ds_read_b128 v[160:163], v23 offset:8192
    v_mfma_f32_16x16x32_bf16 v[52:55], v[128:131], v[144:147], v[52:55]
    s_waitcnt lgkmcnt(9)
    ds_read_b128 v[128:131], v11 offset:26624
    v_mfma_f32_16x16x32_bf16 v[40:43], v[132:135], v[140:143], v[40:43]
    v_mfma_f32_16x16x32_bf16 v[56:59], v[132:135], v[144:147], v[56:59]
    ds_read_b128 v[132:135], v11 offset:45056
    v_mfma_f32_16x16x32_bf16 v[44:47], v[136:139], v[140:143], v[44:47]
    v_mfma_f32_16x16x32_bf16 v[60:63], v[136:139], v[144:147], v[60:63]
    ds_read_b128 v[136:139], v11 offset:63488
    v_mfma_f32_16x16x32_bf16 v[64:67], v[72:75], v[140:143], v[64:67]
    v_mfma_f32_16x16x32_bf16 v[68:71], v[72:75], v[144:147], v[68:71]
    s_waitcnt lgkmcnt(8)
    v_mfma_f32_16x16x32_bf16 v[32:35], v[108:111], v[148:151], v[32:35]
    s_barrier
    ds_read_b64 v[76:77], v26 offset:0
    v_mfma_f32_16x16x32_bf16 v[48:51], v[108:111], v[152:155], v[48:51]
    ds_read_b64 v[78:79], v27 offset:0
    v_mfma_f32_16x16x32_bf16 v[36:39], v[112:115], v[148:151], v[36:39]
    ds_read_b64 v[80:81], v28 offset:0
    v_mfma_f32_16x16x32_bf16 v[52:55], v[112:115], v[152:155], v[52:55]
    s_waitcnt lgkmcnt(9)
    ds_read_b64 v[82:83], v29 offset:0
    v_mfma_f32_16x16x32_bf16 v[40:43], v[116:119], v[148:151], v[40:43]
    ds_read_b64 v[84:85], v26 offset:2048
    v_mfma_f32_16x16x32_bf16 v[56:59], v[116:119], v[152:155], v[56:59]
    ds_read_b64 v[86:87], v27 offset:2048
    v_mfma_f32_16x16x32_bf16 v[44:47], v[120:123], v[148:151], v[44:47]
    ds_read_b64 v[88:89], v28 offset:2048
    v_mfma_f32_16x16x32_bf16 v[60:63], v[120:123], v[152:155], v[60:63]
    ds_read_b64 v[90:91], v29 offset:2048
    v_mfma_f32_16x16x32_bf16 v[64:67], v[72:75], v[148:151], v[64:67]
    v_mfma_f32_16x16x32_bf16 v[68:71], v[72:75], v[152:155], v[68:71]
    s_waitcnt lgkmcnt(10)
    v_mfma_f32_16x16x32_bf16 v[32:35], v[124:127], v[156:159], v[32:35]
    ds_read_b64 v[92:93], v26 offset:4096
    v_mfma_f32_16x16x32_bf16 v[48:51], v[124:127], v[160:163], v[48:51]
    ds_read_b64 v[94:95], v27 offset:4096
    v_mfma_f32_16x16x32_bf16 v[36:39], v[128:131], v[156:159], v[36:39]
    ds_read_b64 v[96:97], v28 offset:4096
    v_mfma_f32_16x16x32_bf16 v[52:55], v[128:131], v[160:163], v[52:55]
    s_waitcnt lgkmcnt(11)
    ds_read_b64 v[98:99], v29 offset:4096
    v_mfma_f32_16x16x32_bf16 v[40:43], v[132:135], v[156:159], v[40:43]
    ds_read_b64 v[100:101], v26 offset:6144
    v_mfma_f32_16x16x32_bf16 v[56:59], v[132:135], v[160:163], v[56:59]
    ds_read_b64 v[102:103], v27 offset:6144
    v_mfma_f32_16x16x32_bf16 v[44:47], v[136:139], v[156:159], v[44:47]
    ds_read_b64 v[104:105], v28 offset:6144
    v_mfma_f32_16x16x32_bf16 v[60:63], v[136:139], v[160:163], v[60:63]
    ds_read_b64 v[106:107], v29 offset:6144
    v_mfma_f32_16x16x32_bf16 v[64:67], v[72:75], v[156:159], v[64:67]
    v_mfma_f32_16x16x32_bf16 v[68:71], v[72:75], v[160:163], v[68:71]
    v_lshlrev_b32 v12, 4, v3
    v_add_u32 v12, 155648, v12
    s_lshl_b32 s33, s26, 5
    s_add_u32 s33, s33, s30
    s_load_dwordx4 s[28:31], s[0:1], 48
    s_add_u32 s20, s4, 0x720000
    s_addc_u32 s21, s5, 0
    s_mov_b32 s22, 0x240000
    s_mov_b32 s23, 0x20000
    s_barrier
    ds_read_b128 v[164:167], v12 offset:0
    ds_read_b128 v[168:171], v12 offset:256
    ds_read_b128 v[172:175], v12 offset:64
    ds_read_b128 v[176:179], v12 offset:320
    ds_read_b128 v[180:183], v12 offset:128
    ds_read_b128 v[184:187], v12 offset:384
    ds_read_b128 v[188:191], v12 offset:192
    ds_read_b128 v[192:195], v12 offset:448
    s_waitcnt lgkmcnt(6)
    v_pk_fma_f32 v[32:33], v[168:169], v[64:65], v[32:33] neg_lo:[1,0,0] neg_hi:[1,0,0]
    v_pk_fma_f32 v[34:35], v[170:171], v[64:65], v[34:35] neg_lo:[1,0,0] neg_hi:[1,0,0]
    v_pk_mul_f32 v[32:33], v[32:33], v[164:165]
    v_pk_mul_f32 v[34:35], v[34:35], v[166:167]
    v_cvt_pk_bf16_f32 v196, v32, v33
    v_cvt_pk_bf16_f32 v197, v34, v35
    s_waitcnt lgkmcnt(4)
    v_pk_fma_f32 v[36:37], v[176:177], v[64:65], v[36:37] neg_lo:[1,0,0] neg_hi:[1,0,0]
    v_pk_fma_f32 v[38:39], v[178:179], v[64:65], v[38:39] neg_lo:[1,0,0] neg_hi:[1,0,0]
    v_pk_mul_f32 v[36:37], v[36:37], v[172:173]
    v_pk_mul_f32 v[38:39], v[38:39], v[174:175]
    v_cvt_pk_bf16_f32 v198, v36, v37
    v_cvt_pk_bf16_f32 v199, v38, v39
    s_waitcnt lgkmcnt(2)
    v_pk_fma_f32 v[40:41], v[184:185], v[64:65], v[40:41] neg_lo:[1,0,0] neg_hi:[1,0,0]
    v_pk_fma_f32 v[42:43], v[186:187], v[64:65], v[42:43] neg_lo:[1,0,0] neg_hi:[1,0,0]
    v_pk_mul_f32 v[40:41], v[40:41], v[180:181]
    v_pk_mul_f32 v[42:43], v[42:43], v[182:183]
    v_cvt_pk_bf16_f32 v200, v40, v41
    v_cvt_pk_bf16_f32 v201, v42, v43
    s_waitcnt lgkmcnt(0)
    v_pk_fma_f32 v[44:45], v[192:193], v[64:65], v[44:45] neg_lo:[1,0,0] neg_hi:[1,0,0]
    v_pk_fma_f32 v[46:47], v[194:195], v[64:65], v[46:47] neg_lo:[1,0,0] neg_hi:[1,0,0]
    v_pk_mul_f32 v[44:45], v[44:45], v[188:189]
    v_pk_mul_f32 v[46:47], v[46:47], v[190:191]
    v_cvt_pk_bf16_f32 v202, v44, v45
    v_cvt_pk_bf16_f32 v203, v46, v47
    v_pk_fma_f32 v[48:49], v[168:169], v[68:69], v[48:49] neg_lo:[1,0,0] neg_hi:[1,0,0]
    v_pk_fma_f32 v[50:51], v[170:171], v[68:69], v[50:51] neg_lo:[1,0,0] neg_hi:[1,0,0]
    v_pk_mul_f32 v[48:49], v[48:49], v[164:165]
    v_pk_mul_f32 v[50:51], v[50:51], v[166:167]
    v_cvt_pk_bf16_f32 v204, v48, v49
    v_cvt_pk_bf16_f32 v205, v50, v51
    v_pk_fma_f32 v[52:53], v[176:177], v[68:69], v[52:53] neg_lo:[1,0,0] neg_hi:[1,0,0]
    v_pk_fma_f32 v[54:55], v[178:179], v[68:69], v[54:55] neg_lo:[1,0,0] neg_hi:[1,0,0]
    v_pk_mul_f32 v[52:53], v[52:53], v[172:173]
    v_pk_mul_f32 v[54:55], v[54:55], v[174:175]
    v_cvt_pk_bf16_f32 v206, v52, v53
    v_cvt_pk_bf16_f32 v207, v54, v55
    v_pk_fma_f32 v[56:57], v[184:185], v[68:69], v[56:57] neg_lo:[1,0,0] neg_hi:[1,0,0]
    v_pk_fma_f32 v[58:59], v[186:187], v[68:69], v[58:59] neg_lo:[1,0,0] neg_hi:[1,0,0]
    v_pk_mul_f32 v[56:57], v[56:57], v[180:181]
    v_pk_mul_f32 v[58:59], v[58:59], v[182:183]
    v_cvt_pk_bf16_f32 v208, v56, v57
    v_cvt_pk_bf16_f32 v209, v58, v59
    v_pk_fma_f32 v[60:61], v[192:193], v[68:69], v[60:61] neg_lo:[1,0,0] neg_hi:[1,0,0]
    v_pk_fma_f32 v[62:63], v[194:195], v[68:69], v[62:63] neg_lo:[1,0,0] neg_hi:[1,0,0]
    v_pk_mul_f32 v[60:61], v[60:61], v[188:189]
    v_pk_mul_f32 v[62:63], v[62:63], v[190:191]
    v_cvt_pk_bf16_f32 v210, v60, v61
    v_cvt_pk_bf16_f32 v211, v62, v63
    s_nop 0
    v_mfma_f32_16x16x32_bf16 v[32:35], v[196:199], v[76:79], 0
    v_mfma_f32_16x16x32_bf16 v[32:35], v[200:203], v[80:83], v[32:35]
    v_mfma_f32_16x16x32_bf16 v[48:51], v[204:207], v[76:79], 0
    v_mfma_f32_16x16x32_bf16 v[48:51], v[208:211], v[80:83], v[48:51]
    v_mfma_f32_16x16x32_bf16 v[36:39], v[196:199], v[84:87], 0
    v_mfma_f32_16x16x32_bf16 v[36:39], v[200:203], v[88:91], v[36:39]
    v_mfma_f32_16x16x32_bf16 v[52:55], v[204:207], v[84:87], 0
    v_mfma_f32_16x16x32_bf16 v[52:55], v[208:211], v[88:91], v[52:55]
    v_mfma_f32_16x16x32_bf16 v[40:43], v[196:199], v[92:95], 0
    v_mfma_f32_16x16x32_bf16 v[40:43], v[200:203], v[96:99], v[40:43]
    v_mfma_f32_16x16x32_bf16 v[56:59], v[204:207], v[92:95], 0
    v_mfma_f32_16x16x32_bf16 v[56:59], v[208:211], v[96:99], v[56:59]
    v_cvt_pk_bf16_f32 v108, v32, v33
    v_cvt_pk_bf16_f32 v109, v34, v35
    v_cvt_pk_bf16_f32 v110, v48, v49
    v_cvt_pk_bf16_f32 v111, v50, v51
    ds_write_b128 v17, v[108:111] offset:0
    ds_read_b128 v[124:127], v25 offset:0
    v_mfma_f32_16x16x32_bf16 v[44:47], v[196:199], v[100:103], 0
Lhop1:
    s_cbranch_execz Lhopret
    v_mfma_f32_16x16x32_bf16 v[44:47], v[200:203], v[104:107], v[44:47]
    v_mfma_f32_16x16x32_bf16 v[60:63], v[204:207], v[100:103], 0
    v_mfma_f32_16x16x32_bf16 v[60:63], v[208:211], v[104:107], v[60:63]
    v_cvt_pk_bf16_f32 v112, v36, v37
    v_cvt_pk_bf16_f32 v113, v38, v39
    v_cvt_pk_bf16_f32 v114, v52, v53
    v_cvt_pk_bf16_f32 v115, v54, v55
    ds_write_b128 v17, v[112:115] offset:1280
    ds_read_b128 v[128:131], v25 offset:1280
    v_cvt_pk_bf16_f32 v116, v40, v41
    v_cvt_pk_bf16_f32 v117, v42, v43
    v_cvt_pk_bf16_f32 v118, v56, v57
    v_cvt_pk_bf16_f32 v119, v58, v59
    ds_write_b128 v17, v[116:119] offset:2560
    ds_read_b128 v[132:135], v25 offset:2560
    v_cvt_pk_bf16_f32 v120, v44, v45
    v_cvt_pk_bf16_f32 v121, v46, v47
    v_cvt_pk_bf16_f32 v122, v60, v61
    v_cvt_pk_bf16_f32 v123, v62, v63
    ds_write_b128 v17, v[120:123] offset:3840
    ds_read_b128 v[136:139], v25 offset:3840
    s_add_u32 s32, s33, 0
    s_waitcnt lgkmcnt(6)
    buffer_store_dwordx4 v[124:127], v24, s[20:23], s32 offen sc1
    s_add_u32 s32, s33, 589824
    s_waitcnt lgkmcnt(4)
    buffer_store_dwordx4 v[128:131], v24, s[20:23], s32 offen sc1
    s_add_u32 s32, s33, 1179648
    s_waitcnt lgkmcnt(2)
    buffer_store_dwordx4 v[132:135], v24, s[20:23], s32 offen sc1
    s_add_u32 s32, s33, 1769472
    s_waitcnt lgkmcnt(0)
    buffer_store_dwordx4 v[136:139], v24, s[20:23], s32 offen sc1
    s_branch Lp1j_2
Lp1b:
    s_cmp_eq_u32 s21, 2
    s_cselect_b32 s22, 1152, 0
    s_sub_u32 s16, s16, s22
    s_subb_u32 s17, s17, 0
    s_add_u32 m0, s28, 1792
    s_nop 0
    buffer_load_dwordx4 v7, s[16:19], s29 offen offset:256 lds
    s_add_u32 m0, s28, 11008
    s_nop 0
    buffer_load_dwordx4 v19, s[16:19], s29 offen offset:256 lds
    s_cmp_eq_u32 s21, 3
    s_cselect_b32 s22, 1152, 0
    s_sub_u32 s16, s16, s22
    s_subb_u32 s17, s17, 0
    s_add_u32 m0, s28, 2688
    s_nop 0
    buffer_load_dwordx4 v7, s[16:19], s29 offen offset:384 lds
    s_add_u32 m0, s28, 11904
    s_nop 0
    buffer_load_dwordx4 v19, s[16:19], s29 offen offset:384 lds
    s_cmp_eq_u32 s21, 4
    s_cselect_b32 s22, 1152, 0
    s_sub_u32 s16, s16, s22
    s_subb_u32 s17, s17, 0
    s_mov_b32 m0, 3584
    s_nop 0
    buffer_load_dwordx4 v7, s[16:19], s30 offen offset:512 lds
    s_mov_b32 m0, 12800
    s_nop 0
    buffer_load_dwordx4 v19, s[16:19], s30 offen offset:512 lds
    s_mov_b32 m0, 22016
    s_nop 0
    buffer_load_dwordx4 v7, s[16:19], s31 offen offset:512 lds
    s_mov_b32 m0, 31232
    s_nop 0
    buffer_load_dwordx4 v19, s[16:19], s31 offen offset:512 lds
    s_waitcnt vmcnt(8) lgkmcnt(0)
    s_barrier
    ds_read_b128 v[108:111], v10 offset:0
    ds_read_b128 v[112:115], v10 offset:18432
    ds_read_b128 v[116:119], v10 offset:36864
    ds_read_b128 v[120:123], v10 offset:55296
    ds_read_b128 v[124:127], v11 offset:0
    ds_read_b128 v[128:131], v11 offset:18432
    ds_read_b128 v[132:135], v11 offset:36864
    ds_read_b128 v[136:139], v11 offset:55296
    s_waitcnt lgkmcnt(6)
    v_mfma_f32_16x16x32_bf16 v[32:35], v[108:111], v[108:111], 0
    s_mov_b32 m0, 40448
    v_mfma_f32_16x16x32_bf16 v[36:39], v[72:75], v[108:111], 0
    buffer_load_dwordx4 v7, s[16:19], s32 offen offset:512 lds
    s_mov_b32 m0, 49664
    ds_read_b128 v[108:111], v10 offset:1024
    v_mfma_f32_16x16x32_bf16 v[40:43], v[112:115], v[112:115], 0
    buffer_load_dwordx4 v19, s[16:19], s32 offen offset:512 lds
    s_mov_b32 m0, 58880
    v_mfma_f32_16x16x32_bf16 v[44:47], v[72:75], v[112:115], 0
    buffer_load_dwordx4 v7, s[16:19], s33 offen offset:512 lds
    s_waitcnt lgkmcnt(5)
    s_mov_b32 m0, 68096
    ds_read_b128 v[112:115], v10 offset:19456
    v_mfma_f32_16x16x32_bf16 v[48:51], v[116:119], v[116:119], 0
    buffer_load_dwordx4 v19, s[16:19], s33 offen offset:512 lds
    s_cmp_eq_u32 s21, 5
    s_cselect_b32 s22, 1152, 0
    s_sub_u32 s16, s16, s22
    s_subb_u32 s17, s17, 0
    s_mov_b32 m0, 4480
    v_mfma_f32_16x16x32_bf16 v[52:55], v[72:75], v[116:119], 0
    buffer_load_dwordx4 v7, s[16:19], s30 offen offset:640 lds
    s_mov_b32 m0, 13696
    ds_read_b128 v[116:119], v10 offset:37888
    v_mfma_f32_16x16x32_bf16 v[56:59], v[120:123], v[120:123], 0
    buffer_load_dwordx4 v19, s[16:19], s30 offen offset:640 lds
    s_mov_b32 m0, 22912
    v_mfma_f32_16x16x32_bf16 v[60:63], v[72:75], v[120:123], 0
    buffer_load_dwordx4 v7, s[16:19], s31 offen offset:640 lds
    s_waitcnt lgkmcnt(5)
    s_mov_b32 m0, 32128
    ds_read_b128 v[120:123], v10 offset:56320
    v_mfma_f32_16x16x32_bf16 v[32:35], v[124:127], v[124:127], v[32:35]
    buffer_load_dwordx4 v19, s[16:19], s31 offen offset:640 lds
    s_mov_b32 m0, 41344
    v_mfma_f32_16x16x32_bf16 v[36:39], v[72:75], v[124:127], v[36:39]
    buffer_load_dwordx4 v7, s[16:19], s32 offen offset:640 lds
    s_mov_b32 m0, 50560
    ds_read_b128 v[124:127], v11 offset:1024
    v_mfma_f32_16x16x32_bf16 v[40:43], v[128:131], v[128:131], v[40:43]
    buffer_load_dwordx4 v19, s[16:19], s32 offen offset:640 lds
    s_mov_b32 m0, 59776
    v_mfma_f32_16x16x32_bf16 v[44:47], v[72:75], v[128:131], v[44:47]
    buffer_load_dwordx4 v7, s[16:19], s33 offen offset:640 lds
    s_waitcnt lgkmcnt(5)
    s_mov_b32 m0, 68992
    ds_read_b128 v[128:131], v11 offset:19456
    v_mfma_f32_16x16x32_bf16 v[48:51], v[132:135], v[132:135], v[48:51]
    buffer_load_dwordx4 v19, s[16:19], s33 offen offset:640 lds
    s_cmp_eq_u32 s21, 6
    s_cselect_b32 s22, 1152, 0
    s_sub_u32 s16, s16, s22
    s_subb_u32 s17, s17, 0
    s_mov_b32 m0, 5376
    v_mfma_f32_16x16x32_bf16 v[52:55], v[72:75], v[132:135], v[52:55]
    buffer_load_dwordx4 v7, s[16:19], s30 offen offset:768 lds
    s_mov_b32 m0, 14592
    ds_read_b128 v[132:135], v11 offset:37888
    v_mfma_f32_16x16x32_bf16 v[56:59], v[136:139], v[136:139], v[56:59]
    buffer_load_dwordx4 v19, s[16:19], s30 offen offset:768 lds
    s_mov_b32 m0, 23808
    v_mfma_f32_16x16x32_bf16 v[60:63], v[72:75], v[136:139], v[60:63]
    buffer_load_dwordx4 v7, s[16:19], s31 offen offset:768 lds
    s_waitcnt lgkmcnt(5)
    s_mov_b32 m0, 33024
    ds_read_b128 v[136:139], v11 offset:56320
    v_mfma_f32_16x16x32_bf16 v[32:35], v[108:111], v[108:111], v[32:35]
    buffer_load_dwordx4 v19, s[16:19], s31 offen offset:768 lds
    s_waitcnt vmcnt(20)
    s_barrier
    s_mov_b32 m0, 42240
    v_mfma_f32_16x16x32_bf16 v[36:39], v[72:75], v[108:111], v[36:39]
    buffer_load_dwordx4 v7, s[16:19], s32 offen offset:768 lds
    s_mov_b32 m0, 51456
    ds_read_b128 v[108:111], v10 offset:2048
    v_mfma_f32_16x16x32_bf16 v[40:43], v[112:115], v[112:115], v[40:43]
    buffer_load_dwordx4 v19, s[16:19], s32 offen offset:768 lds
    s_mov_b32 m0, 60672
    v_mfma_f32_16x16x32_bf16 v[44:47], v[72:75], v[112:115], v[44:47]
    buffer_load_dwordx4 v7, s[16:19], s33 offen offset:768 lds
    s_waitcnt lgkmcnt(5)
    s_mov_b32 m0, 69888
    ds_read_b128 v[112:115], v10 offset:20480
    v_mfma_f32_16x16x32_bf16 v[48:51], v[116:119], v[116:119], v[48:51]
    buffer_load_dwordx4 v19, s[16:19], s33 offen offset:768 lds
    s_cmp_eq_u32 s21, 7
    s_cselect_b32 s22, 1152, 0
    s_sub_u32 s16, s16, s22
    s_subb_u32 s17, s17, 0
    s_mov_b32 m0, 6272
    v_mfma_f32_16x16x32_bf16 v[52:55], v[72:75], v[116:119], v[52:55]
    buffer_load_dwordx4 v7, s[16:19], s30 offen offset:896 lds
    s_mov_b32 m0, 15488
    ds_read_b128 v[116:119], v10 offset:38912
    v_mfma_f32_16x16x32_bf16 v[56:59], v[120:123], v[120:123], v[56:59]
    buffer_load_dwordx4 v19, s[16:19], s30 offen offset:896 lds
    s_mov_b32 m0, 24704
    v_mfma_f32_16x16x32_bf16 v[60:63], v[72:75], v[120:123], v[60:63]
    buffer_load_dwordx4 v7, s[16:19], s31 offen offset:896 lds
    s_waitcnt lgkmcnt(5)
    s_mov_b32 m0, 33920
    ds_read_b128 v[120:123], v10 offset:57344
    v_mfma_f32_16x16x32_bf16 v[32:35], v[124:127], v[124:127], v[32:35]
    buffer_load_dwordx4 v19, s[16:19], s31 offen offset:896 lds
    s_mov_b32 m0, 43136
    v_mfma_f32_16x16x32_bf16 v[36:39], v[72:75], v[124:127], v[36:39]
    buffer_load_dwordx4 v7, s[16:19], s32 offen offset:896 lds
    s_mov_b32 m0, 52352
    ds_read_b128 v[124:127], v11 offset:2048
    v_mfma_f32_16x16x32_bf16 v[40:43], v[128:131], v[128:131], v[40:43]
    buffer_load_dwordx4 v19, s[16:19], s32 offen offset:896 lds
    s_mov_b32 m0, 61568
    v_mfma_f32_16x16x32_bf16 v[44:47], v[72:75], v[128:131], v[44:47]
    buffer_load_dwordx4 v7, s[16:19], s33 offen offset:896 lds
    s_waitcnt lgkmcnt(5)
    s_mov_b32 m0, 70784
    ds_read_b128 v[128:131], v11 offset:20480
    v_mfma_f32_16x16x32_bf16 v[48:51], v[132:135], v[132:135], v[48:51]
    buffer_load_dwordx4 v19, s[16:19], s33 offen offset:896 lds
    s_cmp_eq_u32 s21, 8
    s_cselect_b32 s22, 1152, 0
    s_sub_u32 s16, s16, s22
    s_subb_u32 s17, s17, 0
    s_mov_b32 m0, 7168
    v_mfma_f32_16x16x32_bf16 v[52:55], v[72:75], v[132:135], v[52:55]
    buffer_load_dwordx4 v7, s[16:19], s30 offen offset:1024 lds
    s_mov_b32 m0, 16384
    ds_read_b128 v[132:135], v11 offset:38912
    v_mfma_f32_16x16x32_bf16 v[56:59], v[136:139], v[136:139], v[56:59]
    buffer_load_dwordx4 v19, s[16:19], s30 offen offset:1024 lds
    s_mov_b32 m0, 25600
    v_mfma_f32_16x16x32_bf16 v[60:63], v[72:75], v[136:139], v[60:63]
    buffer_load_dwordx4 v7, s[16:19], s31 offen offset:1024 lds
    s_waitcnt lgkmcnt(5)
    s_mov_b32 m0, 34816
    ds_read_b128 v[136:139], v11 offset:57344
    v_mfma_f32_16x16x32_bf16 v[32:35], v[108:111], v[108:111], v[32:35]
    buffer_load_dwordx4 v19, s[16:19], s31 offen offset:1024 lds
    v_mfma_f32_16x16x32_bf16 v[36:39], v[72:75], v[108:111], v[36:39]
    s_mov_b32 m0, 44032
    ds_read_b128 v[108:111], v10 offset:3072
    v_mfma_f32_16x16x32_bf16 v[40:43], v[112:115], v[112:115], v[40:43]
    buffer_load_dwordx4 v7, s[16:19], s32 offen offset:1024 lds
    v_mfma_f32_16x16x32_bf16 v[44:47], v[72:75], v[112:115], v[44:47]
    s_waitcnt lgkmcnt(5)
    s_mov_b32 m0, 53248
    ds_read_b128 v[112:115], v10 offset:21504
    v_mfma_f32_16x16x32_bf16 v[48:51], v[116:119], v[116:119], v[48:51]
    buffer_load_dwordx4 v19, s[16:19], s32 offen offset:1024 lds
    v_mfma_f32_16x16x32_bf16 v[52:55], v[72:75], v[116:119], v[52:55]
    s_mov_b32 m0, 62464
    ds_read_b128 v[116:119], v10 offset:39936
    v_mfma_f32_16x16x32_bf16 v[56:59], v[120:123], v[120:123], v[56:59]
    buffer_load_dwordx4 v7, s[16:19], s33 offen offset:1024 lds
    v_mfma_f32_16x16x32_bf16 v[60:63], v[72:75], v[120:123], v[60:63]
    s_waitcnt lgkmcnt(5)
    s_mov_b32 m0, 71680
    ds_read_b128 v[120:123], v10 offset:58368
    v_mfma_f32_16x16x32_bf16 v[32:35], v[124:127], v[124:127], v[32:35]
    buffer_load_dwordx4 v19, s[16:19], s33 offen offset:1024 lds
    v_mfma_f32_16x16x32_bf16 v[36:39], v[72:75], v[124:127], v[36:39]
    s_mov_b32 m0, 147456
    ds_read_b128 v[124:127], v11 offset:3072
    v_mfma_f32_16x16x32_bf16 v[40:43], v[128:131], v[128:131], v[40:43]
    global_load_lds_dwordx4 v8, s[38:39]
    v_mfma_f32_16x16x32_bf16 v[44:47], v[72:75], v[128:131], v[44:47]
    s_waitcnt lgkmcnt(5)
    s_mov_b32 m0, 148480
    ds_read_b128 v[128:131], v11 offset:21504
    v_mfma_f32_16x16x32_bf16 v[48:51], v[132:135], v[132:135], v[48:51]
    global_load_lds_dwordx4 v14, s[38:39]
    v_mfma_f32_16x16x32_bf16 v[52:55], v[72:75], v[132:135], v[52:55]
    s_mov_b32 m0, 149504
    ds_read_b128 v[132:135], v11 offset:39936
    v_mfma_f32_16x16x32_bf16 v[56:59], v[136:139], v[136:139], v[56:59]
    global_load_lds_dwordx4 v15, s[38:39]
    v_mfma_f32_16x16x32_bf16 v[60:63], v[72:75], v[136:139], v[60:63]
    s_waitcnt lgkmcnt(5)
    s_mov_b32 m0, 150528
    ds_read_b128 v[136:139], v11 offset:58368
    v_mfma_f32_16x16x32_bf16 v[32:35], v[108:111], v[108:111], v[32:35]
    global_load_lds_dwordx4 v16, s[38:39]
    s_waitcnt vmcnt(28)
    s_barrier
    v_mfma_f32_16x16x32_bf16 v[36:39], v[72:75], v[108:111], v[36:39]
    s_mov_b32 m0, 151552
    ds_read_b128 v[108:111], v10 offset:4096
    v_mfma_f32_16x16x32_bf16 v[40:43], v[112:115], v[112:115], v[40:43]
    global_load_lds_dwordx4 v[12:13], off
    v_mfma_f32_16x16x32_bf16 v[44:47], v[72:75], v[112:115], v[44:47]
    s_waitcnt lgkmcnt(5)
    s_mov_b32 m0, 152576
    ds_read_b128 v[112:115], v10 offset:22528
    v_mfma_f32_16x16x32_bf16 v[48:51], v[116:119], v[116:119], v[48:51]
    global_load_lds_dwordx4 v14, s[40:41]
    v_mfma_f32_16x16x32_bf16 v[52:55], v[72:75], v[116:119], v[52:55]
    s_mov_b32 m0, 153600
    ds_read_b128 v[116:119], v10 offset:40960
    v_mfma_f32_16x16x32_bf16 v[56:59], v[120:123], v[120:123], v[56:59]
    global_load_lds_dwordx4 v15, s[40:41]
    v_mfma_f32_16x16x32_bf16 v[60:63], v[72:75], v[120:123], v[60:63]
    s_waitcnt lgkmcnt(5)
    s_mov_b32 m0, 154624
    ds_read_b128 v[120:123], v10 offset:59392
    v_mfma_f32_16x16x32_bf16 v[32:35], v[124:127], v[124:127], v[32:35]
    global_load_lds_dwordx4 v16, s[40:41]
    v_mfma_f32_16x16x32_bf16 v[36:39], v[72:75], v[124:127], v[36:39]
    ds_read_b128 v[124:127], v11 offset:4096
    v_mfma_f32_16x16x32_bf16 v[40:43], v[128:131], v[128:131], v[40:43]
    v_mfma_f32_16x16x32_bf16 v[44:47], v[72:75], v[128:131], v[44:47]
    s_waitcnt lgkmcnt(5)
    ds_read_b128 v[128:131], v11 offset:22528
    v_mfma_f32_16x16x32_bf16 v[48:51], v[132:135], v[132:135], v[48:51]
    v_mfma_f32_16x16x32_bf16 v[52:55], v[72:75], v[132:135], v[52:55]
    ds_read_b128 v[132:135], v11 offset:40960
    v_mfma_f32_16x16x32_bf16 v[56:59], v[136:139], v[136:139], v[56:59]
    v_mfma_f32_16x16x32_bf16 v[60:63], v[72:75], v[136:139], v[60:63]
    s_waitcnt lgkmcnt(5)
    ds_read_b128 v[136:139], v11 offset:59392
    v_mfma_f32_16x16x32_bf16 v[32:35], v[108:111], v[108:111], v[32:35]
    v_mfma_f32_16x16x32_bf16 v[36:39], v[72:75], v[108:111], v[36:39]
    ds_read_b128 v[108:111], v10 offset:5120
    v_mfma_f32_16x16x32_bf16 v[40:43], v[112:115], v[112:115], v[40:43]
    v_mfma_f32_16x16x32_bf16 v[44:47], v[72:75], v[112:115], v[44:47]
    s_waitcnt lgkmcnt(5)
    ds_read_b128 v[112:115], v10 offset:23552
    v_mfma_f32_16x16x32_bf16 v[48:51], v[116:119], v[116:119], v[48:51]
    v_mfma_f32_16x16x32_bf16 v[52:55], v[72:75], v[116:119], v[52:55]
    ds_read_b128 v[116:119], v10 offset:41984
    v_mfma_f32_16x16x32_bf16 v[56:59], v[120:123], v[120:123], v[56:59]
    v_mfma_f32_16x16x32_bf16 v[60:63], v[72:75], v[120:123], v[60:63]
    s_waitcnt lgkmcnt(5)
    ds_read_b128 v[120:123], v10 offset:60416
    v_mfma_f32_16x16x32_bf16 v[32:35], v[124:127], v[124:127], v[32:35]
    v_mfma_f32_16x16x32_bf16 v[36:39], v[72:75], v[124:127], v[36:39]
    ds_read_b128 v[124:127], v11 offset:5120
    v_mfma_f32_16x16x32_bf16 v[40:43], v[128:131], v[128:131], v[40:43]
    v_mfma_f32_16x16x32_bf16 v[44:47], v[72:75], v[128:131], v[44:47]
    s_waitcnt lgkmcnt(5)
    ds_read_b128 v[128:131], v11 offset:23552
    v_mfma_f32_16x16x32_bf16 v[48:51], v[132:135], v[132:135], v[48:51]
    v_mfma_f32_16x16x32_bf16 v[52:55], v[72:75], v[132:135], v[52:55]
    ds_read_b128 v[132:135], v11 offset:41984
    v_mfma_f32_16x16x32_bf16 v[56:59], v[136:139], v[136:139], v[56:59]
    v_mfma_f32_16x16x32_bf16 v[60:63], v[72:75], v[136:139], v[60:63]
    s_waitcnt lgkmcnt(5)
    ds_read_b128 v[136:139], v11 offset:60416
    v_mfma_f32_16x16x32_bf16 v[32:35], v[108:111], v[108:111], v[32:35]
    s_waitcnt vmcnt(24)
    s_barrier
    v_mfma_f32_16x16x32_bf16 v[36:39], v[72:75], v[108:111], v[36:39]
    ds_read_b128 v[108:111], v10 offset:6144
    v_mfma_f32_16x16x32_bf16 v[40:43], v[112:115], v[112:115], v[40:43]
    v_mfma_f32_16x16x32_bf16 v[44:47], v[72:75], v[112:115], v[44:47]
    s_waitcnt lgkmcnt(5)
    ds_read_b128 v[112:115], v10 offset:24576
    v_mfma_f32_16x16x32_bf16 v[48:51], v[116:119], v[116:119], v[48:51]
    v_mfma_f32_16x16x32_bf16 v[52:55], v[72:75], v[116:119], v[52:55]
    ds_read_b128 v[116:119], v10 offset:43008
    v_mfma_f32_16x16x32_bf16 v[56:59], v[120:123], v[120:123], v[56:59]
    v_mfma_f32_16x16x32_bf16 v[60:63], v[72:75], v[120:123], v[60:63]
    s_waitcnt lgkmcnt(5)
    ds_read_b128 v[120:123], v10 offset:61440
    v_mfma_f32_16x16x32_bf16 v[32:35], v[124:127], v[124:127], v[32:35]
    v_mfma_f32_16x16x32_bf16 v[36:39], v[72:75], v[124:127], v[36:39]
    ds_read_b128 v[124:127], v11 offset:6144
    v_mfma_f32_16x16x32_bf16 v[40:43], v[128:131], v[128:131], v[40:43]
    v_mfma_f32_16x16x32_bf16 v[44:47], v[72:75], v[128:131], v[44:47]
    s_waitcnt lgkmcnt(5)
    ds_read_b128 v[128:131], v11 offset:24576
    v_mfma_f32_16x16x32_bf16 v[48:51], v[132:135], v[132:135], v[48:51]
    v_mfma_f32_16x16x32_bf16 v[52:55], v[72:75], v[132:135], v[52:55]
    ds_read_b128 v[132:135], v11 offset:43008
    v_mfma_f32_16x16x32_bf16 v[56:59], v[136:139], v[136:139], v[56:59]
    v_mfma_f32_16x16x32_bf16 v[60:63], v[72:75], v[136:139], v[60:63]
    s_waitcnt lgkmcnt(5)
    ds_read_b128 v[136:139], v11 offset:61440
    v_mfma_f32_16x16x32_bf16 v[32:35], v[108:111], v[108:111], v[32:35]
    s_waitcnt vmcnt(16)
    s_barrier
    v_mfma_f32_16x16x32_bf16 v[36:39], v[72:75], v[108:111], v[36:39]
    ds_read_b128 v[108:111], v10 offset:7168
    v_mfma_f32_16x16x32_bf16 v[40:43], v[112:115], v[112:115], v[40:43]
    v_mfma_f32_16x16x32_bf16 v[44:47], v[72:75], v[112:115], v[44:47]
    s_waitcnt lgkmcnt(5)
    ds_read_b128 v[112:115], v10 offset:25600
    v_mfma_f32_16x16x32_bf16 v[48:51], v[116:119], v[116:119], v[48:51]
    v_mfma_f32_16x16x32_bf16 v[52:55], v[72:75], v[116:119], v[52:55]
    ds_read_b128 v[116:119], v10 offset:44032
    v_mfma_f32_16x16x32_bf16 v[56:59], v[120:123], v[120:123], v[56:59]
    v_mfma_f32_16x16x32_bf16 v[60:63], v[72:75], v[120:123], v[60:63]
    s_waitcnt lgkmcnt(5)
    ds_read_b128 v[120:123], v10 offset:62464
    v_mfma_f32_16x16x32_bf16 v[32:35], v[124:127], v[124:127], v[32:35]
    v_mfma_f32_16x16x32_bf16 v[36:39], v[72:75], v[124:127], v[36:39]
    ds_read_b128 v[124:127], v11 offset:7168
    v_mfma_f32_16x16x32_bf16 v[40:43], v[128:131], v[128:131], v[40:43]
    v_mfma_f32_16x16x32_bf16 v[44:47], v[72:75], v[128:131], v[44:47]
    s_waitcnt lgkmcnt(5)
    ds_read_b128 v[128:131], v11 offset:25600
    v_mfma_f32_16x16x32_bf16 v[48:51], v[132:135], v[132:135], v[48:51]
    v_mfma_f32_16x16x32_bf16 v[52:55], v[72:75], v[132:135], v[52:55]
    ds_read_b128 v[132:135], v11 offset:44032
    v_mfma_f32_16x16x32_bf16 v[56:59], v[136:139], v[136:139], v[56:59]
    v_mfma_f32_16x16x32_bf16 v[60:63], v[72:75], v[136:139], v[60:63]
    s_waitcnt lgkmcnt(5)
    ds_read_b128 v[136:139], v11 offset:62464
    v_mfma_f32_16x16x32_bf16 v[32:35], v[108:111], v[108:111], v[32:35]
    s_waitcnt vmcnt(8)
    s_barrier
    v_mfma_f32_16x16x32_bf16 v[36:39], v[72:75], v[108:111], v[36:39]
    s_mov_b64 s[16:17], s[36:37]
    ds_read_b128 v[108:111], v10 offset:8192
    v_mfma_f32_16x16x32_bf16 v[40:43], v[112:115], v[112:115], v[40:43]
    buffer_load_dword v30, v18, s[16:19], s34 offen offset:0
    v_mfma_f32_16x16x32_bf16 v[44:47], v[72:75], v[112:115], v[44:47]
    s_waitcnt lgkmcnt(5)
    s_mov_b64 s[16:17], s[36:37]
    ds_read_b128 v[112:115], v10 offset:26624
    v_mfma_f32_16x16x32_bf16 v[48:51], v[116:119], v[116:119], v[48:51]
    buffer_load_dword v30, v18, s[16:19], s34 offen offset:512
    v_mfma_f32_16x16x32_bf16 v[52:55], v[72:75], v[116:119], v[52:55]
    s_mov_b64 s[16:17], s[36:37]
    ds_read_b128 v[116:119], v10 offset:45056
    v_mfma_f32_16x16x32_bf16 v[56:59], v[120:123], v[120:123], v[56:59]
    buffer_load_dword v30, v18, s[16:19], s34 offen offset:640
    v_mfma_f32_16x16x32_bf16 v[60:63], v[72:75], v[120:123], v[60:63]
    s_waitcnt lgkmcnt(5)
    ds_read_b128 v[120:123], v10 offset:63488
    v_mfma_f32_16x16x32_bf16 v[32:35], v[124:127], v[124:127], v[32:35]
    v_mfma_f32_16x16x32_bf16 v[36:39], v[72:75], v[124:127], v[36:39]
    ds_read_b128 v[124:127], v11 offset:8192
    v_mfma_f32_16x16x32_bf16 v[40:43], v[128:131], v[128:131], v[40:43]
    v_mfma_f32_16x16x32_bf16 v[44:47], v[72:75], v[128:131], v[44:47]
    s_waitcnt lgkmcnt(5)
    ds_read_b128 v[128:131], v11 offset:26624
    v_mfma_f32_16x16x32_bf16 v[48:51], v[132:135], v[132:135], v[48:51]
    v_mfma_f32_16x16x32_bf16 v[52:55], v[72:75], v[132:135], v[52:55]
    ds_read_b128 v[132:135], v11 offset:45056
    v_mfma_f32_16x16x32_bf16 v[56:59], v[136:139], v[136:139], v[56:59]
    v_mfma_f32_16x16x32_bf16 v[60:63], v[72:75], v[136:139], v[60:63]
    s_waitcnt lgkmcnt(5)
    ds_read_b128 v[136:139], v11 offset:63488
    v_mfma_f32_16x16x32_bf16 v[32:35], v[108:111], v[108:111], v[32:35]
    s_waitcnt vmcnt(3)
    s_barrier
    v_mfma_f32_16x16x32_bf16 v[36:39], v[72:75], v[108:111], v[36:39]
    v_mfma_f32_16x16x32_bf16 v[40:43], v[112:115], v[112:115], v[40:43]
    v_mfma_f32_16x16x32_bf16 v[44:47], v[72:75], v[112:115], v[44:47]
    s_waitcnt lgkmcnt(4)
    v_mfma_f32_16x16x32_bf16 v[48:51], v[116:119], v[116:119], v[48:51]
    v_mfma_f32_16x16x32_bf16 v[52:55], v[72:75], v[116:119], v[52:55]
    v_mfma_f32_16x16x32_bf16 v[56:59], v[120:123], v[120:123], v[56:59]
    v_mfma_f32_16x16x32_bf16 v[60:63], v[72:75], v[120:123], v[60:63]
    s_waitcnt lgkmcnt(2)
    v_mfma_f32_16x16x32_bf16 v[32:35], v[124:127], v[124:127], v[32:35]
    v_mfma_f32_16x16x32_bf16 v[36:39], v[72:75], v[124:127], v[36:39]
    v_mfma_f32_16x16x32_bf16 v[40:43], v[128:131], v[128:131], v[40:43]
    v_mfma_f32_16x16x32_bf16 v[44:47], v[72:75], v[128:131], v[44:47]
    s_waitcnt lgkmcnt(0)
    v_mfma_f32_16x16x32_bf16 v[48:51], v[132:135], v[132:135], v[48:51]
    v_mfma_f32_16x16x32_bf16 v[52:55], v[72:75], v[132:135], v[52:55]
    v_mfma_f32_16x16x32_bf16 v[56:59], v[136:139], v[136:139], v[56:59]
    v_mfma_f32_16x16x32_bf16 v[60:63], v[72:75], v[136:139], v[60:63]
    s_load_dwordx4 s[28:31], s[0:1], 48
    s_nop 0
    v_cndmask_b32 v32, v32, v33, s[80:81]
    v_cndmask_b32 v32, v32, v34, s[82:83]
    v_cndmask_b32 v32, v32, v35, s[84:85]
    v_cndmask_b32 v40, v40, v41, s[80:81]
    v_cndmask_b32 v40, v40, v42, s[82:83]
    v_cndmask_b32 v40, v40, v43, s[84:85]
    v_cndmask_b32 v48, v48, v49, s[80:81]
    v_cndmask_b32 v48, v48, v50, s[82:83]
    v_cndmask_b32 v48, v48, v51, s[84:85]
    v_cndmask_b32 v56, v56, v57, s[80:81]
    v_cndmask_b32 v56, v56, v58, s[82:83]
    v_cndmask_b32 v56, v56, v59, s[84:85]
    v_mul_f32 v36, 0x3ae38e39, v36
    v_mul_f32 v44, 0x3ae38e39, v44
    v_mul_f32 v52, 0x3ae38e39, v52
    v_mul_f32 v60, 0x3ae38e39, v60
    v_mul_f32 v32, 0x3ae38e39, v32
    v_mul_f32 v40, 0x3ae38e39, v40
    v_mul_f32 v48, 0x3ae38e39, v48
    v_mul_f32 v56, 0x3ae38e39, v56
    v_fma_f32 v32, -v36, v36, v32
    v_fma_f32 v40, -v44, v44, v40
    v_fma_f32 v48, -v52, v52, v48
    v_fma_f32 v56, -v60, v60, v56
    v_max_f32 v32, 0, v32
    v_max_f32 v40, 0, v40
    v_max_f32 v48, 0, v48
    v_max_f32 v56, 0, v56
    v_cvt_pk_bf16_f32 v32, v32, v32
    v_cvt_pk_bf16_f32 v40, v40, v40
    v_cvt_pk_bf16_f32 v48, v48, v48
    v_cvt_pk_bf16_f32 v56, v56, v56
    v_lshlrev_b32 v32, 16, v32
    v_lshlrev_b32 v40, 16, v40
    v_lshlrev_b32 v48, 16, v48
    v_lshlrev_b32 v56, 16, v56
    v_add_f32 v32, 0x3727c5ac, v32
    v_add_f32 v40, 0x3727c5ac, v40
    v_add_f32 v48, 0x3727c5ac, v48
    v_add_f32 v56, 0x3727c5ac, v56
    v_cvt_pk_bf16_f32 v32, v32, v32
    v_cvt_pk_bf16_f32 v40, v40, v40
    v_cvt_pk_bf16_f32 v48, v48, v48
    v_cvt_pk_bf16_f32 v56, v56, v56
    v_lshlrev_b32 v32, 16, v32
    v_lshlrev_b32 v40, 16, v40
    v_lshlrev_b32 v48, 16, v48
    v_lshlrev_b32 v56, 16, v56
    v_sqrt_f32 v32, v32
    v_sqrt_f32 v40, v40
    v_sqrt_f32 v48, v48
    v_sqrt_f32 v56, v56
    s_nop 0
    v_cvt_pk_bf16_f32 v32, v32, v32
    v_cvt_pk_bf16_f32 v40, v40, v40
    v_cvt_pk_bf16_f32 v48, v48, v48
    v_cvt_pk_bf16_f32 v56, v56, v56
    v_lshlrev_b32 v32, 16, v32
    v_lshlrev_b32 v40, 16, v40
    v_lshlrev_b32 v48, 16, v48
    v_lshlrev_b32 v56, 16, v56
    v_rcp_f32 v32, v32
    v_rcp_f32 v40, v40
    v_rcp_f32 v48, v48
    v_rcp_f32 v56, v56
    s_nop 0
    v_cvt_pk_bf16_f32 v36, v36, v36
    v_cvt_pk_bf16_f32 v44, v44, v44
    v_cvt_pk_bf16_f32 v52, v52, v52
    v_cvt_pk_bf16_f32 v60, v60, v60
    v_lshlrev_b32 v36, 16, v36
    v_lshlrev_b32 v44, 16, v44
    v_lshlrev_b32 v52, 16, v52
    v_lshlrev_b32 v60, 16, v60
    s_mov_b64 exec, s[86:87]
    ds_write_b32 v26, v32 offset:0
    ds_write_b32 v26, v36 offset:256
    ds_write_b32 v26, v40 offset:64
    ds_write_b32 v26, v44 offset:320
    ds_write_b32 v26, v48 offset:128
    ds_write_b32 v26, v52 offset:384
    ds_write_b32 v26, v56 offset:192
    ds_write_b32 v26, v60 offset:448
    s_mov_b64 exec, -1
    s_waitcnt lgkmcnt(0)
    s_barrier
Lp1j_2:
    s_add_u32 s6, s10, 16
    s_mul_i32 s33, s24, 6
    s_add_u32 s33, s33, s25
    s_lshl_b32 s33, s33, 7
    s_add_u32 s101, s33, 4096
    s_bitcmp1_b32 s8, 1
    s_cbranch_scc1 Lroleb
    s_mov_b32 s16, s36
    s_mov_b32 s17, s37
    s_mov_b32 s18, 0x240000
    s_mov_b32 s19, 0x20000
    v_lshrrev_b32 v5, 3, v1
    v_and_b32 v6, 7, v1
    v_xor_b32 v17, v6, v3
    v_lshlrev_b32 v17, 4, v17
    v_mul_u32_u24 v18, 73728, v5
    v_add_u32 v17, v17, v18
    v_xor_b32 v18, 64, v17
    v_add_u32 v18, 589824, v18
    s_bitcmp1_b32 s3, 0
    s_cselect_b64 vcc, -1, 0
    s_mul_i32 s34, s50, 1152
    s_lshl_b32 s33, s3, 8
    s_add_u32 s35, s34, s33
    v_cndmask_b32 v19, v17, v18, vcc
    s_lshl_b32 s33, s3, 12
    s_add_u32 m0, s33, 73728
    s_nop 0
    buffer_load_dwordx4 v17, s[16:19], s35 offen offset:0 lds
    s_add_u32 m0, s33, 74752
    s_nop 0
    buffer_load_dwordx4 v18, s[16:19], s35 offen offset:0 lds
    s_add_u32 m0, s33, 75648
    s_nop 0
    buffer_load_dwordx4 v17, s[16:19], s35 offen offset:128 lds
    s_add_u32 m0, s33, 76672
    s_nop 0
    buffer_load_dwordx4 v18, s[16:19], s35 offen offset:128 lds
    s_and_b32 s33, s3, 1
    s_lshl_b32 s33, s33, 10
    s_add_u32 m0, s33, 89088
    v_lshlrev_b32 v7, 1, v3
    buffer_load_dwordx4 v19, s[16:19], s34 offen offset:1024 lds
    v_xor_b32 v7, v7, v6
    v_lshlrev_b32 v7, 4, v7
    v_mul_u32_u24 v16, 1152, v5
    v_add_u32 v16, v16, v7
    s_mul_i32 s33, s3, 9216
    s_mul_i32 s34, s46, 36864
    s_mul_i32 s35, s47, 36864
    s_add_u32 s34, s34, s33
    s_add_u32 s35, s35, s33
    s_add_u32 s32, s33, 73728
    s_add_u32 s33, s32, 36864
    s_mov_b64 s[40:41], s[48:49]
Lhop2:
    s_cbranch_execz Lhopret
    s_and_b32 s24, s7, 1
    s_lshl_b32 s24, s24, 2
    s_and_b32 s25, s8, 3
    s_add_u32 s24, s24, s25
    s_lshr_b32 s25, s8, 2
    s_lshr_b32 s26, s7, 1
    s_lshl_b32 s27, s26, 3
    s_add_u32 s27, s27, s25
    s_lshr_b32 s45, s3, 1
    s_and_b32 s46, s3, 1
    s_lshr_b32 s47, s27, 2
    s_mul_i32 s47, s47, 1152
    s_and_b32 s48, s27, 3
    s_lshl_b32 s49, s48, 7
    s_add_u32 s98, s47, s49
    s_mul_i32 s49, s46, 5059584
    s_add_u32 s83, s98, s49
    s_mul_i32 s49, s46, 2552832
    s_add_u32 s98, s98, s49
    s_mul_i32 s11, s3, 6144
    s_mul_i32 s80, s46, -18432
    s_add_u32 s80, s80, 9216
    s_mul_i32 s81, s80, 48
    s_lshl_b32 s82, s80, 5
    s_lshl_b32 s47, s80, 3
    s_sub_u32 s47, s47, 1024
    s_mul_i32 s48, s46, 2939904
    s_mul_i32 s49, s46, 2654208
    v_lshrrev_b32 v9, 3, v1
    v_and_b32 v8, 7, v1
    v_lshlrev_b32 v5, 1, v3
    v_xor_b32 v5, v5, v8
    v_lshlrev_b32 v5, 4, v5
    v_mul_lo_u32 v8, v9, s80
    v_cmp_eq_u32 vcc, 0, v9
    v_add3_u32 v5, v5, v8, s48
    v_add_u32 v6, s47, v5
    v_add_u32 v7, s47, v6
    v_add_u32 v8, s47, v7
    v_subrev_u32 v9, s49, v5
    v_cndmask_b32 v9, v5, v9, vcc
    s_mul_i32 s49, s46, 184320
    s_waitcnt lgkmcnt(0)
    s_cmp_eq_u32 s45, 0
    s_cselect_b32 s16, s28, s30
    s_cselect_b32 s17, s29, s31
    s_sub_u32 s16, s16, s49
    s_subb_u32 s17, s17, 0
    s_add_u32 s18, s49, 5308416
    s_mov_b32 s19, 0x20000
    v_lshlrev_b32 v20, 7, v2
    v_add_u32 v20, 73728, v20
    v_lshrrev_b32 v21, 1, v2
    v_lshlrev_b32 v21, 4, v21
    s_lshl_b32 s42, s3, 5
    v_lshl_add_u32 v27, v3, 3, s42
    v_sub_u32 v28, 632, v27
    v_sub_u32 v29, 640, v27
    v_lshrrev_b32 v24, 7, v27
    v_lshlrev_b32 v24, 11, v24
    v_and_b32 v27, 127, v27
    v_xor_b32 v27, v27, v21
    v_add3_u32 v24, v24, v27, v20
    v_lshrrev_b32 v25, 7, v28
    v_lshlrev_b32 v25, 11, v25
    v_and_b32 v28, 127, v28
    v_xor_b32 v28, v28, v21
    v_add3_u32 v25, v25, v28, v20
    v_lshrrev_b32 v26, 7, v29
    v_lshlrev_b32 v26, 11, v26
    v_and_b32 v29, 127, v29
    v_xor_b32 v29, v29, v21
    v_add3_u32 v26, v26, v29, v20
    s_waitcnt vmcnt(0)
    s_barrier
    s_cmp_lg_u32 s3, 0
    s_cbranch_scc1 Lp1f_5
    v_mov_b32 v44, 0
    v_mov_b32 v45, s6
    s_mov_b64 exec, 1
    buffer_store_dword v45, v44, s[12:15], s101 offen sc1
    s_mov_b64 exec, -1
Lp1f_5:
    ds_read_b64 v[172:173], v24 offset:0
    ds_read_b64 v[182:183], v25 offset:8192
    ds_read_b32 v192, v26 offset:8192
    ds_read_b64 v[174:175], v24 offset:2048
    ds_read_b64 v[184:185], v25 offset:6144
    ds_read_b32 v193, v26 offset:6144
    ds_read_b64 v[176:177], v24 offset:4096
    ds_read_b64 v[186:187], v25 offset:4096
    ds_read_b32 v194, v26 offset:4096
    ds_read_b64 v[178:179], v24 offset:6144
    ds_read_b64 v[188:189], v25 offset:2048
    ds_read_b32 v195, v26 offset:2048
    ds_read_b64 v[180:181], v24 offset:8192
    ds_read_b64 v[190:191], v25 offset:0
    ds_read_b32 v196, v26 offset:0
    v_lshlrev_b32 v10, 6, v2
    v_lshl_add_u32 v10, v3, 3, v10
    v_add_u32 v10, 160768, v10
    v_xor_b32 v27, 64, v21
    v_add_u32 v27, v27, v20
    s_cmp_lg_u32 s3, 0
    s_cbranch_scc1 Lx288_6
    s_mov_b64 exec, 0xffff
    ds_read_b32 v192, v27 offset:8192
    s_mov_b64 exec, -1
Lx288_6:
    ds_read_b64 v[32:33], v10
    ds_read_b64 v[34:35], v10 offset:32
    ds_read_b64 v[36:37], v10 offset:1024
    ds_read_b64 v[38:39], v10 offset:1056
    s_mov_b32 s49, s98
    s_add_u32 m0, s11, 0
    s_nop 0
    buffer_load_dwordx4 v9, s[16:19], s49 offen offset:0 lds
    buffer_load_dwordx4 v6, s[16:19], s49 offen offset:1024 lds
    buffer_load_dwordx4 v7, s[16:19], s49 offen offset:2048 lds
    buffer_load_dwordx4 v8, s[16:19], s49 offen offset:3072 lds
    s_add_u32 s49, s49, s82
    s_add_u32 m0, s11, 4096
    s_nop 0
    buffer_load_dwordx4 v5, s[16:19], s49 offen offset:0 lds
    buffer_load_dwordx4 v6, s[16:19], s49 offen offset:1024 lds
    s_add_u32 s20, s4, 0x720000
    s_addc_u32 s21, s5, 0
    s_mov_b32 s22, 0x240000
    s_mov_b32 s23, 0x20000
    v_min_u32 v28, 47, v1
    v_lshlrev_b32 v28, 7, v28
    s_mul_i32 s44, s3, 6144
    s_add_u32 s44, s44, 4096
    s_bitcmp1_b32 s8, 0
    s_cselect_b32 s42, s33, s32
    s_cselect_b32 s33, s32, s33
    s_cselect_b32 s43, s35, s34
    s_cselect_b32 s35, s34, s35
    s_mov_b32 s32, s42
    s_mov_b32 s34, s43
    s_waitcnt lgkmcnt(0)
    s_barrier
    s_xor_b32 s53, s41, 0x80008000
    s_mov_b32 s52, 0xffff0000
    v_and_b32 v12, 1, v3
    v_lshrrev_b32 v13, 2, v2
    v_lshl_add_u32 v12, v12, 2, v13
    s_mul_i32 s49, s81, 1
    v_lshrrev_b32 v13, 1, v12
    v_lshlrev_b32 v13, 5, v13
    v_lshl_or_b32 v13, v12, 7, v13
    v_and_b32 v12, 3, v2
    v_lshl_or_b32 v13, v12, 3, v13
    s_add_u32 s49, s49, s98
    v_lshrrev_b32 v12, 1, v3
    v_mul_u32_u24 v12, 9216, v12
    v_add_u32 v13, v13, v12
    v_add_u32 v13, 73728, v13
    s_lshl_b32 s42, s3, 5
    s_add_u32 m0, s11, 24576
    v_xor_b32 v22, s42, v13
    v_xor_b32 v23, 64, v22
    s_lshr_b32 s42, s3, 1
    s_lshl_b32 s42, s42, 10
    s_add_u32 s42, s42, 4096
    buffer_load_dwordx4 v5, s[16:19], s49 offen offset:0 lds
    v_add_u32 v23, s42, v23
    v_xor_b32 v40, s53, v36
    v_and_b32 v40, s40, v40
    v_xor_b32 v44, s41, v32
    v_and_b32 v44, s40, v44
    buffer_load_dwordx4 v6, s[16:19], s49 offen offset:1024 lds
    v_xor_b32 v41, s53, v37
    v_and_b32 v41, s40, v41
    v_xor_b32 v45, s41, v33
    v_and_b32 v45, s40, v45
    v_xor_b32 v42, s53, v38
    buffer_load_dwordx4 v7, s[16:19], s49 offen offset:2048 lds
    v_and_b32 v42, s40, v42
    v_xor_b32 v46, s41, v34
    v_and_b32 v46, s40, v46
    v_xor_b32 v43, s53, v39
    v_and_b32 v43, s40, v43
    buffer_load_dwordx4 v8, s[16:19], s49 offen offset:3072 lds
    v_xor_b32 v47, s41, v35
    v_and_b32 v47, s40, v47
    v_lshlrev_b32 v12, 16, v172
    v_lshlrev_b32 v13, 16, v192
    v_mul_f32 v12, 0.5, v12
    s_add_u32 s49, s49, s82
    v_fma_f32 v128, v13, 0.5, v12
    v_fma_f32 v148, v13, 0.5, -v12
    v_mov_b32 v14, v148
    v_mov_b32 v15, v13
    v_and_b32 v12, s52, v172
    s_add_u32 m0, s11, 28672
    v_and_b32 v13, s52, v183
    v_mul_f32 v12, 0.5, v12
    v_fma_f32 v129, v13, 0.5, v12
    v_fma_f32 v149, v13, 0.5, -v12
    v_lshlrev_b32 v12, 16, v173
    buffer_load_dwordx4 v5, s[16:19], s49 offen offset:0 lds
    v_lshlrev_b32 v13, 16, v183
    v_mul_f32 v12, 0.5, v12
    v_fma_f32 v130, v13, 0.5, v12
    v_fma_f32 v150, v13, 0.5, -v12
    v_and_b32 v12, s52, v173
    buffer_load_dwordx4 v6, s[16:19], s49 offen offset:1024 lds
    v_and_b32 v13, s52, v182
    v_mul_f32 v12, 0.5, v12
    v_fma_f32 v131, v13, 0.5, v12
    v_fma_f32 v151, v13, 0.5, -v12
    v_lshlrev_b32 v12, 16, v174
    s_mul_i32 s49, s81, 2
    v_lshlrev_b32 v13, 16, v193
    v_mul_f32 v12, 0.5, v12
    v_fma_f32 v132, v13, 0.5, v12
    v_fma_f32 v152, v13, 0.5, -v12
    v_and_b32 v12, s52, v174
    s_add_u32 s49, s49, s98
    v_and_b32 v13, s52, v185
    v_mul_f32 v12, 0.5, v12
    v_fma_f32 v133, v13, 0.5, v12
    v_fma_f32 v153, v13, 0.5, -v12
    v_lshlrev_b32 v12, 16, v175
    s_add_u32 m0, s11, 49152
    v_lshlrev_b32 v13, 16, v185
    v_mul_f32 v12, 0.5, v12
    v_fma_f32 v134, v13, 0.5, v12
    v_fma_f32 v154, v13, 0.5, -v12
    v_and_b32 v12, s52, v175
    buffer_load_dwordx4 v5, s[16:19], s49 offen offset:0 lds
    v_and_b32 v13, s52, v184
    v_mul_f32 v12, 0.5, v12
    v_fma_f32 v135, v13, 0.5, v12
    v_fma_f32 v155, v13, 0.5, -v12
    v_lshlrev_b32 v12, 16, v176
    buffer_load_dwordx4 v6, s[16:19], s49 offen offset:1024 lds
    v_lshlrev_b32 v13, 16, v194
    v_mul_f32 v12, 0.5, v12
    v_fma_f32 v136, v13, 0.5, v12
    v_fma_f32 v156, v13, 0.5, -v12
    v_and_b32 v12, s52, v176
    buffer_load_dwordx4 v7, s[16:19], s49 offen offset:2048 lds
    v_and_b32 v13, s52, v187
    v_mul_f32 v12, 0.5, v12
    v_fma_f32 v137, v13, 0.5, v12
    v_fma_f32 v157, v13, 0.5, -v12
    v_lshlrev_b32 v12, 16, v177
    buffer_load_dwordx4 v8, s[16:19], s49 offen offset:3072 lds
    v_lshlrev_b32 v13, 16, v187
    v_mul_f32 v12, 0.5, v12
    v_fma_f32 v138, v13, 0.5, v12
    v_fma_f32 v158, v13, 0.5, -v12
    v_and_b32 v12, s52, v177
    s_add_u32 s49, s49, s82
    v_and_b32 v13, s52, v186
    v_mul_f32 v12, 0.5, v12
    v_fma_f32 v139, v13, 0.5, v12
    v_fma_f32 v159, v13, 0.5, -v12
    v_lshlrev_b32 v12, 16, v178
    s_add_u32 m0, s11, 53248
    v_lshlrev_b32 v13, 16, v195
    v_mul_f32 v12, 0.5, v12
    v_fma_f32 v140, v13, 0.5, v12
    v_fma_f32 v160, v13, 0.5, -v12
    v_and_b32 v12, s52, v178
    buffer_load_dwordx4 v5, s[16:19], s49 offen offset:0 lds
    v_and_b32 v13, s52, v189
    v_mul_f32 v12, 0.5, v12
    v_fma_f32 v141, v13, 0.5, v12
    v_fma_f32 v161, v13, 0.5, -v12
    v_lshlrev_b32 v12, 16, v179
    buffer_load_dwordx4 v6, s[16:19], s49 offen offset:1024 lds
    v_lshlrev_b32 v13, 16, v189
    v_mul_f32 v12, 0.5, v12
    v_fma_f32 v142, v13, 0.5, v12
    v_fma_f32 v162, v13, 0.5, -v12
    v_and_b32 v12, s52, v179
    buffer_load_dword v29, v28, s[12:15], s44 offen sc1
    v_and_b32 v13, s52, v188
    v_mul_f32 v12, 0.5, v12
    v_fma_f32 v143, v13, 0.5, v12
    v_fma_f32 v163, v13, 0.5, -v12
    v_lshlrev_b32 v12, 16, v180
    v_lshlrev_b32 v13, 16, v196
    v_mul_f32 v12, 0.5, v12
    v_fma_f32 v144, v13, 0.5, v12
    v_fma_f32 v164, v13, 0.5, -v12
    v_and_b32 v12, s52, v180
    v_and_b32 v13, s52, v191
    v_mul_f32 v12, 0.5, v12
    v_fma_f32 v145, v13, 0.5, v12
    v_fma_f32 v165, v13, 0.5, -v12
    v_lshlrev_b32 v12, 16, v181
    v_lshlrev_b32 v13, 16, v191
    v_mul_f32 v12, 0.5, v12
    v_fma_f32 v146, v13, 0.5, v12
    v_fma_f32 v166, v13, 0.5, -v12
    v_and_b32 v12, s52, v181
    v_and_b32 v13, s52, v190
    v_mul_f32 v12, 0.5, v12
    v_fma_f32 v147, v13, 0.5, v12
    v_fma_f32 v167, v13, 0.5, -v12
    s_mul_i32 s101, s51, 18432
    s_lshl_b32 s40, s3, 10
    s_add_u32 s101, s101, s40
    s_lshl_b32 s53, s51, 7
    s_add_u32 s53, s53, 36864
    s_add_u32 s36, s4, 0x980000
    s_addc_u32 s37, s5, 0
    s_mov_b32 s38, 0x244000
    s_mov_b32 s39, 0x20000
    v_lshlrev_b32 v20, 3, v2
    v_add_u32 v24, 160000, v20
    s_lshl_b32 s51, s3, 7
    v_add_u32 v25, s51, v24
    s_waitcnt vmcnt(0)
    v_cmp_ne_u32 vcc, s6, v29
    s_nop 1
    s_cbranch_vccz Lf1ok_7
    s_mov_b32 s9, 0
Lpoll_8:
    buffer_load_dword v29, v28, s[12:15], s44 offen sc1
    s_waitcnt vmcnt(0)
    v_cmp_ne_u32 vcc, s6, v29
    s_nop 1
    s_cbranch_vccz Lpd_9
    s_add_u32 s9, s9, 1
    s_cmp_gt_u32 s9, 200000
    s_cbranch_scc1 Lpd_9
    s_sleep 1
    s_branch Lpoll_8
Lpd_9:
Lf1ok_7:
    s_add_u32 m0, s32, 0
    s_nop 0
    buffer_load_dwordx4 v16, s[20:23], s34 offen offset:0 sc1 lds
    s_add_u32 m0, s32, 896
    s_nop 0
    buffer_load_dwordx4 v16, s[20:23], s34 offen offset:128 sc1 lds
    s_add_u32 m0, s32, 1792
    s_nop 0
    buffer_load_dwordx4 v16, s[20:23], s34 offen offset:256 sc1 lds
    s_add_u32 m0, s32, 2688
    s_nop 0
    buffer_load_dwordx4 v16, s[20:23], s34 offen offset:384 sc1 lds
    s_add_u32 m0, s32, 3584
    s_nop 0
    buffer_load_dwordx4 v16, s[20:23], s34 offen offset:512 sc1 lds
    s_add_u32 m0, s32, 4480
    s_nop 0
    buffer_load_dwordx4 v16, s[20:23], s34 offen offset:640 sc1 lds
    s_add_u32 m0, s32, 5376
    s_nop 0
    buffer_load_dwordx4 v16, s[20:23], s34 offen offset:768 sc1 lds
    s_add_u32 m0, s32, 6272
    s_nop 0
    buffer_load_dwordx4 v16, s[20:23], s34 offen offset:896 sc1 lds
    s_add_u32 m0, s32, 7168
    s_nop 0
    buffer_load_dwordx4 v16, s[20:23], s34 offen offset:1024 sc1 lds
    s_add_u32 m0, s33, 0
    s_nop 0
    buffer_load_dwordx4 v16, s[20:23], s35 offen offset:0 sc1 lds
    s_add_u32 m0, s33, 896
    s_nop 0
    buffer_load_dwordx4 v16, s[20:23], s35 offen offset:128 sc1 lds
    s_add_u32 m0, s33, 1792
    s_nop 0
    buffer_load_dwordx4 v16, s[20:23], s35 offen offset:256 sc1 lds
    s_add_u32 m0, s33, 2688
    s_nop 0
    buffer_load_dwordx4 v16, s[20:23], s35 offen offset:384 sc1 lds
    s_add_u32 m0, s33, 3584
    s_nop 0
    buffer_load_dwordx4 v16, s[20:23], s35 offen offset:512 sc1 lds
    s_add_u32 m0, s33, 4480
    s_nop 0
    buffer_load_dwordx4 v16, s[20:23], s35 offen offset:640 sc1 lds
    s_add_u32 m0, s33, 5376
    s_nop 0
    buffer_load_dwordx4 v16, s[20:23], s35 offen offset:768 sc1 lds
    s_add_u32 m0, s33, 6272
    s_nop 0
    buffer_load_dwordx4 v16, s[20:23], s35 offen offset:896 sc1 lds
    s_add_u32 m0, s33, 7168
    s_nop 0
    buffer_load_dwordx4 v16, s[20:23], s35 offen offset:1024 sc1 lds
    s_call_b64 s[96:97], LhopdispF
    s_waitcnt vmcnt(0)
    s_barrier
    ds_read_b64_tr_b16 v[48:49], v22 offset:0
    ds_read_b64_tr_b16 v[50:51], v22 offset:18432
    ds_read_b64_tr_b16 v[52:53], v22 offset:36864
    ds_read_b64_tr_b16 v[54:55], v22 offset:55296
    ds_read_b64_tr_b16 v[56:57], v23 offset:0
    ds_read_b64_tr_b16 v[58:59], v23 offset:18432
    ds_read_b64_tr_b16 v[60:61], v23 offset:36864
    ds_read_b64_tr_b16 v[62:63], v23 offset:55296
    ds_read_b64_tr_b16 v[64:65], v22 offset:1024
    ds_read_b64_tr_b16 v[66:67], v22 offset:19456
    ds_read_b64_tr_b16 v[68:69], v22 offset:37888
    ds_read_b64_tr_b16 v[70:71], v22 offset:56320
    s_waitcnt lgkmcnt(8)
    v_mfma_f32_16x16x32_bf16 v[128:131], v[48:51], v[32:35], v[128:131]
    v_mfma_f32_16x16x32_bf16 v[128:131], v[52:55], v[40:43], v[128:131]
    ds_read_b64_tr_b16 v[72:73], v23 offset:1024
    ds_read_b64_tr_b16 v[74:75], v23 offset:19456
    ds_read_b64_tr_b16 v[76:77], v23 offset:37888
    ds_read_b64_tr_b16 v[78:79], v23 offset:56320
    s_waitcnt lgkmcnt(8)
    v_mfma_f32_16x16x32_bf16 v[148:151], v[56:59], v[36:39], v[148:151]
    v_mfma_f32_16x16x32_bf16 v[148:151], v[60:63], v[44:47], v[148:151]
    v_mfma_f32_16x16x32_bf16 v[168:171], v[56:59], v[32:35], 0
    v_mfma_f32_16x16x32_bf16 v[168:171], v[60:63], v[40:43], v[168:171]
    ds_read_b64_tr_b16 v[80:81], v22 offset:2048
    ds_read_b64_tr_b16 v[82:83], v22 offset:20480
    ds_read_b64_tr_b16 v[84:85], v22 offset:38912
    ds_read_b64_tr_b16 v[86:87], v22 offset:57344
    s_waitcnt lgkmcnt(8)
    v_mfma_f32_16x16x32_bf16 v[132:135], v[64:67], v[32:35], v[132:135]
    v_mfma_f32_16x16x32_bf16 v[132:135], v[68:71], v[40:43], v[132:135]
    ds_read_b64_tr_b16 v[88:89], v23 offset:2048
    ds_read_b64_tr_b16 v[90:91], v23 offset:20480
    ds_read_b64_tr_b16 v[92:93], v23 offset:38912
    ds_read_b64_tr_b16 v[94:95], v23 offset:57344
    s_waitcnt lgkmcnt(8)
    v_mfma_f32_16x16x32_bf16 v[152:155], v[72:75], v[36:39], v[152:155]
    v_mfma_f32_16x16x32_bf16 v[152:155], v[76:79], v[44:47], v[152:155]
    ds_read_b64_tr_b16 v[96:97], v22 offset:3072
    ds_read_b64_tr_b16 v[98:99], v22 offset:21504
    ds_read_b64_tr_b16 v[100:101], v22 offset:39936
    ds_read_b64_tr_b16 v[102:103], v22 offset:58368
    s_waitcnt lgkmcnt(8)
    v_mfma_f32_16x16x32_bf16 v[136:139], v[80:83], v[32:35], v[136:139]
    v_mfma_f32_16x16x32_bf16 v[136:139], v[84:87], v[40:43], v[136:139]
    ds_read_b64_tr_b16 v[104:105], v23 offset:3072
    ds_read_b64_tr_b16 v[106:107], v23 offset:21504
    ds_read_b64_tr_b16 v[108:109], v23 offset:39936
    ds_read_b64_tr_b16 v[110:111], v23 offset:58368
    s_waitcnt lgkmcnt(8)
    v_mfma_f32_16x16x32_bf16 v[156:159], v[88:91], v[36:39], v[156:159]
    v_mfma_f32_16x16x32_bf16 v[156:159], v[92:95], v[44:47], v[156:159]
    ds_read_b64_tr_b16 v[112:113], v22 offset:4096
    ds_read_b64_tr_b16 v[114:115], v22 offset:22528
    ds_read_b64_tr_b16 v[116:117], v22 offset:40960
    ds_read_b64_tr_b16 v[118:119], v22 offset:59392
    s_waitcnt lgkmcnt(8)
    v_mfma_f32_16x16x32_bf16 v[140:143], v[96:99], v[32:35], v[140:143]
    v_mfma_f32_16x16x32_bf16 v[140:143], v[100:103], v[40:43], v[140:143]
    ds_read_b64_tr_b16 v[120:121], v23 offset:4096
    ds_read_b64_tr_b16 v[122:123], v23 offset:22528
    ds_read_b64_tr_b16 v[124:125], v23 offset:40960
    ds_read_b64_tr_b16 v[126:127], v23 offset:59392
    s_waitcnt lgkmcnt(8)
    v_mfma_f32_16x16x32_bf16 v[160:163], v[104:107], v[36:39], v[160:163]
    v_mfma_f32_16x16x32_bf16 v[160:163], v[108:111], v[44:47], v[160:163]
    s_waitcnt lgkmcnt(4)
    v_mfma_f32_16x16x32_bf16 v[144:147], v[112:115], v[32:35], v[144:147]
    v_mfma_f32_16x16x32_bf16 v[144:147], v[116:119], v[40:43], v[144:147]
    s_waitcnt lgkmcnt(0)
    v_mfma_f32_16x16x32_bf16 v[164:167], v[120:123], v[36:39], v[164:167]
    v_mfma_f32_16x16x32_bf16 v[164:167], v[124:127], v[44:47], v[164:167]
    s_cmp_lg_u32 s3, 0
    s_cbranch_scc1 Lnyq_11
    s_mov_b64 exec, 0xffff
    v_sub_f32 v14, v128, v14
    v_add_f32 v15, v168, v15
    v_mul_f32 v14, 0.5, v14
    v_fma_f32 v128, v15, 0.5, v14
    v_fma_f32 v148, v15, 0.5, -v14
    s_mov_b64 exec, -1
Lnyq_11:
    v_pk_mul_f32 v[18:19], v[128:129], v[128:129]
    v_pk_fma_f32 v[18:19], v[148:149], v[148:149], v[18:19]
    v_pk_fma_f32 v[18:19], v[130:131], v[130:131], v[18:19]
    v_pk_add_f32 v[16:17], v[128:129], v[130:131]
    v_pk_fma_f32 v[18:19], v[150:151], v[150:151], v[18:19]
    v_pk_fma_f32 v[18:19], v[132:133], v[132:133], v[18:19]
    v_pk_add_f32 v[16:17], v[16:17], v[132:133]
    v_pk_fma_f32 v[18:19], v[152:153], v[152:153], v[18:19]
    v_pk_fma_f32 v[18:19], v[134:135], v[134:135], v[18:19]
    v_pk_add_f32 v[16:17], v[16:17], v[134:135]
    v_pk_fma_f32 v[18:19], v[154:155], v[154:155], v[18:19]
    v_pk_fma_f32 v[18:19], v[136:137], v[136:137], v[18:19]
    v_pk_add_f32 v[16:17], v[16:17], v[136:137]
    v_pk_fma_f32 v[18:19], v[156:157], v[156:157], v[18:19]
    v_pk_fma_f32 v[18:19], v[138:139], v[138:139], v[18:19]
    v_pk_add_f32 v[16:17], v[16:17], v[138:139]
    v_pk_fma_f32 v[18:19], v[158:159], v[158:159], v[18:19]
    v_pk_fma_f32 v[18:19], v[140:141], v[140:141], v[18:19]
    v_pk_add_f32 v[16:17], v[16:17], v[140:141]
    v_pk_fma_f32 v[18:19], v[160:161], v[160:161], v[18:19]
    v_pk_fma_f32 v[18:19], v[142:143], v[142:143], v[18:19]
    v_pk_add_f32 v[16:17], v[16:17], v[142:143]
    v_pk_fma_f32 v[18:19], v[162:163], v[162:163], v[18:19]
    s_cmp_ge_u32 s3, 2
    s_cbranch_scc1 Ly5_10
    v_pk_fma_f32 v[18:19], v[144:145], v[144:145], v[18:19]
    v_pk_add_f32 v[16:17], v[16:17], v[144:145]
    v_pk_fma_f32 v[18:19], v[164:165], v[164:165], v[18:19]
    v_pk_fma_f32 v[18:19], v[146:147], v[146:147], v[18:19]
    v_pk_add_f32 v[16:17], v[16:17], v[146:147]
    v_pk_fma_f32 v[18:19], v[166:167], v[166:167], v[18:19]
Ly5_10:
    v_add_f32 v16, v16, v17
    v_add_f32 v17, v18, v19
    v_mov_b32 v18, v16
    v_mov_b32 v19, v17
    s_nop 0
    v_permlane32_swap_b32 v18, v16
    v_permlane32_swap_b32 v19, v17
    s_nop 0
    v_pk_add_f32 v[16:17], v[16:17], v[18:19]
    v_mov_b32 v18, v16
    v_mov_b32 v19, v17
    s_nop 0
    v_permlane16_swap_b32 v18, v16
    v_permlane16_swap_b32 v19, v17
    s_nop 0
    v_pk_add_f32 v[16:17], v[16:17], v[18:19]
    v_pk_add_f32 v[16:17], v[16:17], v[16:17]
    ds_write_b64 v25, v[16:17]
    v_pk_add_f32 v[200:201], v[128:129], v[148:149] neg_lo:[0,1] neg_hi:[0,1]
    v_pk_add_f32 v[204:205], v[128:129], v[148:149]
    v_pk_add_f32 v[202:203], v[130:131], v[150:151] neg_lo:[0,1] neg_hi:[0,1]
    v_pk_add_f32 v[206:207], v[130:131], v[150:151]
    v_pk_add_f32 v[208:209], v[132:133], v[152:153] neg_lo:[0,1] neg_hi:[0,1]
    v_pk_add_f32 v[212:213], v[132:133], v[152:153]
    v_pk_add_f32 v[210:211], v[134:135], v[154:155] neg_lo:[0,1] neg_hi:[0,1]
    v_pk_add_f32 v[214:215], v[134:135], v[154:155]
    s_waitcnt lgkmcnt(0)
    s_barrier
    ds_read_b64 v[102:103], v24 offset:0
    ds_read_b64 v[104:105], v24 offset:128
    ds_read_b64 v[106:107], v24 offset:256
    ds_read_b64 v[108:109], v24 offset:384
    s_mul_i32 s49, s81, 3
    s_add_u32 s49, s49, s98
    s_add_u32 m0, s11, 73728
    s_nop 0
    buffer_load_dwordx4 v5, s[16:19], s49 offen offset:0 lds
    buffer_load_dwordx4 v6, s[16:19], s49 offen offset:1024 lds
    buffer_load_dwordx4 v7, s[16:19], s49 offen offset:2048 lds
    buffer_load_dwordx4 v8, s[16:19], s49 offen offset:3072 lds
    s_add_u32 s49, s49, s82
    s_add_u32 m0, s11, 77824
    s_nop 0
    buffer_load_dwordx4 v5, s[16:19], s49 offen offset:0 lds
    buffer_load_dwordx4 v6, s[16:19], s49 offen offset:1024 lds
    v_pk_add_f32 v[216:217], v[136:137], v[156:157] neg_lo:[0,1] neg_hi:[0,1]
    v_pk_add_f32 v[220:221], v[136:137], v[156:157]
    v_pk_add_f32 v[218:219], v[138:139], v[158:159] neg_lo:[0,1] neg_hi:[0,1]
    v_pk_add_f32 v[222:223], v[138:139], v[158:159]
    v_pk_add_f32 v[224:225], v[140:141], v[160:161] neg_lo:[0,1] neg_hi:[0,1]
    v_pk_add_f32 v[228:229], v[140:141], v[160:161]
    v_pk_add_f32 v[226:227], v[142:143], v[162:163] neg_lo:[0,1] neg_hi:[0,1]
    v_pk_add_f32 v[230:231], v[142:143], v[162:163]
    v_pk_add_f32 v[232:233], v[144:145], v[164:165] neg_lo:[0,1] neg_hi:[0,1]
    v_pk_add_f32 v[236:237], v[144:145], v[164:165]
    v_pk_add_f32 v[234:235], v[146:147], v[166:167] neg_lo:[0,1] neg_hi:[0,1]
    v_pk_add_f32 v[238:239], v[146:147], v[166:167]
    s_waitcnt lgkmcnt(0)
    v_pk_add_f32 v[102:103], v[102:103], v[104:105]
    v_pk_add_f32 v[106:107], v[106:107], v[108:109]
    v_pk_add_f32 v[102:103], v[102:103], v[106:107]
    v_mul_f32 v102, 0x3ae38e39, v102
    v_mul_f32 v103, 0x3ae38e39, v103
    v_fma_f32 v103, -v102, v102, v103
    v_max_f32 v103, 0, v103
    v_cvt_pk_bf16_f32 v103, v103, v103
    v_lshlrev_b32 v103, 16, v103
    v_add_f32 v103, 0x3727c5ac, v103
    v_cvt_pk_bf16_f32 v103, v103, v103
    v_lshlrev_b32 v103, 16, v103
    v_sqrt_f32 v103, v103
    s_nop 0
    v_cvt_pk_bf16_f32 v103, v103, v103
    v_lshlrev_b32 v103, 16, v103
    v_rcp_f32 v103, v103
    s_nop 0
    v_mul_f32 v103, 0x3fb8aa3b, v103
    v_mul_f32 v104, v102, v103
    v_mov_b32 v107, v102
    v_rcp_f32 v106, v103
    v_mov_b32 v102, v103
    v_sub_f32 v104, 0, v104
    v_mov_b32 v105, v104
    v_pk_fma_f32 v[200:201], v[200:201], v[102:103], v[104:105]
    v_cvt_pk_bf16_f32 v108, v200, v201
    v_pk_fma_f32 v[202:203], v[202:203], v[102:103], v[104:105]
    v_cvt_pk_bf16_f32 v109, v202, v203
    v_pk_fma_f32 v[204:205], v[204:205], v[102:103], v[104:105]
    v_cvt_pk_bf16_f32 v110, v204, v205
    v_pk_fma_f32 v[206:207], v[206:207], v[102:103], v[104:105]
    v_cvt_pk_bf16_f32 v111, v206, v207
    s_add_u32 s51, s101, 0
    buffer_store_dwordx4 v[108:111], v4, s[36:39], s51 offen sc1
    v_pk_fma_f32 v[208:209], v[208:209], v[102:103], v[104:105]
    v_cvt_pk_bf16_f32 v112, v208, v209
    v_pk_fma_f32 v[210:211], v[210:211], v[102:103], v[104:105]
    v_cvt_pk_bf16_f32 v113, v210, v211
    v_pk_fma_f32 v[212:213], v[212:213], v[102:103], v[104:105]
    v_cvt_pk_bf16_f32 v114, v212, v213
    v_pk_fma_f32 v[214:215], v[214:215], v[102:103], v[104:105]
    v_cvt_pk_bf16_f32 v115, v214, v215
    s_add_u32 s51, s101, 4096
    buffer_store_dwordx4 v[112:115], v4, s[36:39], s51 offen sc1
    v_pk_fma_f32 v[216:217], v[216:217], v[102:103], v[104:105]
    v_cvt_pk_bf16_f32 v116, v216, v217
    v_pk_fma_f32 v[218:219], v[218:219], v[102:103], v[104:105]
    v_cvt_pk_bf16_f32 v117, v218, v219
    v_pk_fma_f32 v[220:221], v[220:221], v[102:103], v[104:105]
    v_cvt_pk_bf16_f32 v118, v220, v221
    v_pk_fma_f32 v[222:223], v[222:223], v[102:103], v[104:105]
    v_cvt_pk_bf16_f32 v119, v222, v223
    s_add_u32 s51, s101, 8192
    buffer_store_dwordx4 v[116:119], v4, s[36:39], s51 offen sc1
    s_waitcnt vmcnt(2)
    s_barrier
    s_cmp_lg_u32 s3, 3
    s_cbranch_scc1 Lp2e_14
    v_mov_b32 v100, 0
    v_mov_b32 v101, s6
    v_add_u32 v101, 1, v101
    s_mov_b64 exec, 1
    buffer_store_dword v101, v100, s[12:15], s53 offen sc1
    s_mov_b64 exec, -1
Lp2e_14:
    v_pk_fma_f32 v[224:225], v[224:225], v[102:103], v[104:105]
    v_cvt_pk_bf16_f32 v120, v224, v225
    v_pk_fma_f32 v[226:227], v[226:227], v[102:103], v[104:105]
    v_cvt_pk_bf16_f32 v121, v226, v227
    v_pk_fma_f32 v[228:229], v[228:229], v[102:103], v[104:105]
    v_cvt_pk_bf16_f32 v122, v228, v229
    v_pk_fma_f32 v[230:231], v[230:231], v[102:103], v[104:105]
    v_cvt_pk_bf16_f32 v123, v230, v231
    s_add_u32 s51, s101, 12288
    buffer_store_dwordx4 v[120:123], v4, s[36:39], s51 offen sc1
    s_cmp_ge_u32 s3, 2
    s_cbranch_scc1 Ln5_12
    v_pk_fma_f32 v[232:233], v[232:233], v[102:103], v[104:105]
    v_cvt_pk_bf16_f32 v124, v232, v233
    v_pk_fma_f32 v[234:235], v[234:235], v[102:103], v[104:105]
    v_cvt_pk_bf16_f32 v125, v234, v235
    v_pk_fma_f32 v[236:237], v[236:237], v[102:103], v[104:105]
    v_cvt_pk_bf16_f32 v126, v236, v237
    v_pk_fma_f32 v[238:239], v[238:239], v[102:103], v[104:105]
    v_cvt_pk_bf16_f32 v127, v238, v239
    s_add_u32 s51, s101, 16384
    buffer_store_dwordx4 v[124:127], v4, s[36:39], s51 offen sc1
    s_branch Lh5_13
Ln5_12:
    s_add_u32 s51, s53, 2322432
    s_mov_b64 exec, 0xffff
    buffer_store_dwordx2 v[106:107], v20, s[36:39], s51 offen sc1
    s_mov_b64 exec, -1
Lh5_13:
    s_mul_i32 s49, s81, 4
    s_add_u32 s49, s49, s98
    s_add_u32 m0, s11, 98304
    s_nop 0
    buffer_load_dwordx4 v5, s[16:19], s49 offen offset:0 lds
    buffer_load_dwordx4 v6, s[16:19], s49 offen offset:1024 lds
    buffer_load_dwordx4 v7, s[16:19], s49 offen offset:2048 lds
    buffer_load_dwordx4 v8, s[16:19], s49 offen offset:3072 lds
Lhop3:
    s_cbranch_execz Lhopret
    s_add_u32 s49, s49, s82
    s_add_u32 m0, s11, 102400
    s_nop 0
    buffer_load_dwordx4 v5, s[16:19], s49 offen offset:0 lds
    buffer_load_dwordx4 v6, s[16:19], s49 offen offset:1024 lds
    s_lshr_b32 s30, s25, 1
    s_lshl_b32 s29, s26, 2
    s_add_u32 s29, s29, s30
    s_mul_i32 s29, s29, 331776
    s_add_u32 s20, s4, 0x200000
    s_addc_u32 s21, s5, 0
    s_add_u32 s20, s20, s29
    s_addc_u32 s21, s21, 0
    s_mov_b32 s22, 331776
    s_mov_b32 s23, 0x20000
    s_add_u32 s32, s4, 0x980000
    s_addc_u32 s33, s5, 0
    s_mov_b32 s34, 0x244000
    s_mov_b32 s35, 0x20000
    s_add_u32 s36, s4, 0xc00000
    s_addc_u32 s37, s5, 0
    s_mov_b32 s38, 0x1200000
    s_mov_b32 s39, 0x20000
    s_lshl_b32 s28, s24, 2
    s_add_u32 s28, s28, s3
    s_lshl_b32 s28, s28, 2
    s_mul_i32 s31, s3, 9216
    s_mul_i32 s40, s28, 18432
    s_mul_i32 s41, s28, 147456
    s_mul_i32 s47, s26, 36864
    s_add_u32 s41, s41, s47
    s_lshl_b32 s48, s25, 9
    s_add_u32 s41, s41, s48
    s_and_b32 s49, s25, 1
    s_lshl_b32 s29, s49, 2
    s_add_u32 s29, s29, s3
    s_lshl_b32 s48, s24, 3
    s_add_u32 s29, s29, s48
    s_mul_i32 s42, s29, 294912
    s_add_u32 s42, s42, s47
    s_lshl_b32 s47, s24, 2
    s_add_u32 s47, s47, s26
    s_lshl_b32 s47, s47, 12
    s_add_u32 s47, s47, 262144
    s_lshl_b32 s44, s3, 10
    s_add_u32 s44, s44, s47
    s_lshl_b32 s48, s25, 7
    s_add_u32 s44, s44, s48
    s_lshl_b32 s49, s49, 1
    s_add_u32 s49, s49, s45
    s_lshl_b32 s49, s49, 10
    s_add_u32 s47, s47, s49
    s_mul_i32 s99, s27, 36864
    v_bfe_u32 v10, v1, 4, 1
    v_mul_u32_u24 v10, 147456, v10
    v_lshrrev_b32 v11, 5, v1
    v_lshl_add_u32 v11, v11, 4, v2
    v_lshl_add_u32 v10, v11, 4, v10
    v_add_u32 v11, 294912, v10
    v_and_b32 v13, 7, v1
    v_lshlrev_b32 v13, 7, v13
    v_add_u32 v16, 18432, v4
    v_add_u32 v17, 36864, v4
    v_add_u32 v18, 55296, v4
    v_add_u32 v19, 147456, v4
    v_add_u32 v20, s31, v4
    v_add_u32 v21, 65536, v4
    v_add_u32 v22, 131072, v4
    v_mov_b32 v23, 0
    v_mov_b32 v24, s6
    v_lshrrev_b32 v12, 2, v1
    v_bfe_u32 v14, v12, 1, 2
    v_lshlrev_b32 v12, 7, v12
    v_lshl_or_b32 v12, v14, 5, v12
    v_and_b32 v14, 3, v1
    v_lshl_or_b32 v12, v14, 3, v12
    v_and_b32 v15, 3, v1
    v_lshlrev_b32 v15, 7, v15
    s_lshl_b32 s85, s28, 7
    s_add_u32 s85, s85, 36864
    buffer_load_dword v14, v15, s[12:15], s85 offen sc1
    s_waitcnt vmcnt(7)
    s_barrier
    s_cmp_lg_u32 s3, 0
    s_cbranch_scc1 Lp2f_15
    v_mov_b32 v100, 0
    v_mov_b32 v101, s6
    v_add_u32 v101, 2, v101
    s_mov_b64 exec, 1
    buffer_store_dword v101, v100, s[12:15], s53 offen sc1
    s_mov_b64 exec, -1
    s_waitcnt vmcnt(1)
    s_branch Lp2f_15x
Lp2f_15:
    s_waitcnt vmcnt(0)
Lp2f_15x:
    v_subrev_u32 v14, s6, v14
    v_subrev_u32 v14, 1, v14
    v_cmp_lt_u32 vcc, 8, v14
    s_nop 1
    s_cbranch_vccz Lhn
Lffn:
    s_mov_b32 s9, 0
Lpoll_18:
    buffer_load_dword v14, v15, s[12:15], s85 offen sc1
    s_waitcnt vmcnt(0)
    v_subrev_u32 v14, s6, v14
    v_subrev_u32 v14, 1, v14
    v_cmp_lt_u32 vcc, 8, v14
    s_nop 1
    s_cbranch_vccz Lpd_19
    s_add_u32 s9, s9, 1
    s_cmp_gt_u32 s9, 200000
    s_cbranch_scc1 Lpd_19
    s_sleep 3
    s_branch Lpoll_18
Lpd_19:
Lhn:
    s_add_u32 s50, s40, 0
    buffer_load_dwordx4 a[0:3], v4, s[32:35], s50 offen offset:0 sc1
    buffer_load_dwordx4 a[16:19], v4, s[32:35], s50 offen offset:1024 sc1
    buffer_load_dwordx4 a[32:35], v4, s[32:35], s50 offen offset:2048 sc1
    buffer_load_dwordx4 a[4:7], v16, s[32:35], s50 offen offset:0 sc1
    buffer_load_dwordx4 a[20:23], v16, s[32:35], s50 offen offset:1024 sc1
    buffer_load_dwordx4 a[36:39], v16, s[32:35], s50 offen offset:2048 sc1
    buffer_load_dwordx4 a[8:11], v17, s[32:35], s50 offen offset:0 sc1
    buffer_load_dwordx4 a[24:27], v17, s[32:35], s50 offen offset:1024 sc1
    buffer_load_dwordx4 a[40:43], v17, s[32:35], s50 offen offset:2048 sc1
    buffer_load_dwordx4 a[12:15], v18, s[32:35], s50 offen offset:0 sc1
    buffer_load_dwordx4 a[28:31], v18, s[32:35], s50 offen offset:1024 sc1
    buffer_load_dwordx4 a[44:47], v18, s[32:35], s50 offen offset:2048 sc1
    s_barrier
    buffer_load_dword v14, v15, s[12:15], s85 offen sc1
    v_xor_b32 v25, 0, v12
    ds_read_b64_tr_b16 v[192:193], v25 offset:0
    ds_read_b64_tr_b16 v[194:195], v25 offset:6144
    ds_read_b64_tr_b16 v[196:197], v25 offset:2048
    ds_read_b64_tr_b16 v[198:199], v25 offset:8192
    ds_read_b64_tr_b16 v[200:201], v25 offset:4096
    ds_read_b64_tr_b16 v[202:203], v25 offset:10240
    ds_read_b64_tr_b16 v[204:205], v25 offset:12288
    ds_read_b64_tr_b16 v[206:207], v25 offset:18432
    ds_read_b64_tr_b16 v[208:209], v25 offset:14336
    ds_read_b64_tr_b16 v[210:211], v25 offset:20480
    ds_read_b64_tr_b16 v[212:213], v25 offset:16384
    ds_read_b64_tr_b16 v[214:215], v25 offset:22528
    v_xor_b32 v26, 32, v12
    ds_read_b64_tr_b16 v[216:217], v26 offset:0
    ds_read_b64_tr_b16 v[218:219], v26 offset:6144
    ds_read_b64_tr_b16 v[220:221], v26 offset:2048
    ds_read_b64_tr_b16 v[222:223], v26 offset:8192
    s_waitcnt vmcnt(10) lgkmcnt(10)
    v_mfma_f32_16x16x32_bf16 v[32:35], v[192:195], a[0:3], 0
    s_mul_i32 s49, s81, 5
    s_add_u32 s49, s49, s98
    v_mfma_f32_16x16x32_bf16 v[32:35], v[196:199], a[16:19], v[32:35]
    s_add_u32 m0, s11, 122880
    v_mfma_f32_16x16x32_bf16 v[32:35], v[200:203], a[32:35], v[32:35]
    s_waitcnt vmcnt(7)
    v_mfma_f32_16x16x32_bf16 v[36:39], v[192:195], a[4:7], 0
    buffer_load_dwordx4 v5, s[16:19], s49 offen offset:0 lds
    v_mfma_f32_16x16x32_bf16 v[36:39], v[196:199], a[20:23], v[36:39]
    buffer_load_dwordx4 v6, s[16:19], s49 offen offset:1024 lds
    v_mfma_f32_16x16x32_bf16 v[36:39], v[200:203], a[36:39], v[36:39]
    s_waitcnt vmcnt(6)
    v_mfma_f32_16x16x32_bf16 v[40:43], v[192:195], a[8:11], 0
    buffer_load_dwordx4 v7, s[16:19], s49 offen offset:2048 lds
    v_mfma_f32_16x16x32_bf16 v[40:43], v[196:199], a[24:27], v[40:43]
    buffer_load_dwordx4 v8, s[16:19], s49 offen offset:3072 lds
    v_mfma_f32_16x16x32_bf16 v[40:43], v[200:203], a[40:43], v[40:43]
    s_waitcnt vmcnt(5)
    s_add_u32 s49, s49, s82
    s_add_u32 m0, s11, 126976
    v_mfma_f32_16x16x32_bf16 v[44:47], v[192:195], a[12:15], 0
    ds_read_b64_tr_b16 v[192:193], v26 offset:4096
    v_mfma_f32_16x16x32_bf16 v[44:47], v[196:199], a[28:31], v[44:47]
    buffer_load_dwordx4 v5, s[16:19], s49 offen offset:0 lds
    v_mfma_f32_16x16x32_bf16 v[44:47], v[200:203], a[44:47], v[44:47]
    s_waitcnt lgkmcnt(5)
    ds_read_b64_tr_b16 v[194:195], v26 offset:10240
    v_mfma_f32_16x16x32_bf16 v[48:51], v[204:207], a[0:3], 0
    buffer_load_dwordx4 v6, s[16:19], s49 offen offset:1024 lds
    v_mfma_f32_16x16x32_bf16 v[48:51], v[208:211], a[16:19], v[48:51]
    ds_read_b64_tr_b16 v[196:197], v26 offset:12288
    v_mfma_f32_16x16x32_bf16 v[48:51], v[212:215], a[32:35], v[48:51]
    v_mfma_f32_16x16x32_bf16 v[52:55], v[204:207], a[4:7], 0
    ds_read_b64_tr_b16 v[198:199], v26 offset:18432
    v_mfma_f32_16x16x32_bf16 v[52:55], v[208:211], a[20:23], v[52:55]
    v_mfma_f32_16x16x32_bf16 v[52:55], v[212:215], a[36:39], v[52:55]
    ds_read_b64_tr_b16 v[200:201], v26 offset:14336
    v_mfma_f32_16x16x32_bf16 v[56:59], v[204:207], a[8:11], 0
    v_mfma_f32_16x16x32_bf16 v[56:59], v[208:211], a[24:27], v[56:59]
    ds_read_b64_tr_b16 v[202:203], v26 offset:20480
    v_mfma_f32_16x16x32_bf16 v[56:59], v[212:215], a[40:43], v[56:59]
    v_mfma_f32_16x16x32_bf16 v[60:63], v[204:207], a[12:15], 0
    ds_read_b64_tr_b16 v[204:205], v26 offset:16384
    v_mfma_f32_16x16x32_bf16 v[60:63], v[208:211], a[28:31], v[60:63]
    v_mfma_f32_16x16x32_bf16 v[60:63], v[212:215], a[44:47], v[60:63]
    s_waitcnt lgkmcnt(5)
    ds_read_b64_tr_b16 v[206:207], v26 offset:22528
    v_xor_b32 v27, 64, v12
    v_mfma_f32_16x16x32_bf16 v[64:67], v[216:219], a[0:3], 0
    v_mfma_f32_16x16x32_bf16 v[64:67], v[220:223], a[16:19], v[64:67]
    s_add_u32 s9, s6, 2
    ds_read_b64_tr_b16 v[208:209], v27 offset:0
    v_mfma_f32_16x16x32_bf16 v[64:67], v[192:195], a[32:35], v[64:67]
    v_mfma_f32_16x16x32_bf16 v[68:71], v[216:219], a[4:7], 0
    s_waitcnt vmcnt(6)
    ds_read_b64_tr_b16 v[210:211], v27 offset:6144
    v_subrev_u32 v14, s9, v14
    v_mfma_f32_16x16x32_bf16 v[68:71], v[220:223], a[20:23], v[68:71]
    v_cmp_lt_u32 vcc, 7, v14
    v_mfma_f32_16x16x32_bf16 v[68:71], v[192:195], a[36:39], v[68:71]
    ds_read_b64_tr_b16 v[212:213], v27 offset:2048
    v_mfma_f32_16x16x32_bf16 v[72:75], v[216:219], a[8:11], 0
    v_mfma_f32_16x16x32_bf16 v[72:75], v[220:223], a[24:27], v[72:75]
    s_cbranch_vccnz Lslow_20
Lback_21:
    ds_read_b64_tr_b16 v[214:215], v27 offset:8192
    v_mfma_f32_16x16x32_bf16 v[72:75], v[192:195], a[40:43], v[72:75]
    v_mfma_f32_16x16x32_bf16 v[76:79], v[216:219], a[12:15], 0
    s_add_u32 s50, s40, 3072
    ds_read_b64_tr_b16 v[216:217], v27 offset:4096
    v_mfma_f32_16x16x32_bf16 v[76:79], v[220:223], a[28:31], v[76:79]
    buffer_load_dwordx4 a[48:51], v4, s[32:35], s50 offen offset:0 sc1
    v_mfma_f32_16x16x32_bf16 v[76:79], v[192:195], a[44:47], v[76:79]
    s_waitcnt lgkmcnt(5)
    ds_read_b64_tr_b16 v[218:219], v27 offset:10240
    v_mfma_f32_16x16x32_bf16 v[80:83], v[196:199], a[0:3], 0
    buffer_load_dwordx4 a[64:67], v4, s[32:35], s50 offen offset:1024 sc1
    v_mfma_f32_16x16x32_bf16 v[80:83], v[200:203], a[16:19], v[80:83]
    ds_read_b64_tr_b16 v[220:221], v27 offset:12288
    v_mfma_f32_16x16x32_bf16 v[80:83], v[204:207], a[32:35], v[80:83]
    buffer_load_dwordx4 a[80:83], v4, s[32:35], s50 offen offset:2048 sc1
    v_mfma_f32_16x16x32_bf16 v[84:87], v[196:199], a[4:7], 0
    ds_read_b64_tr_b16 v[222:223], v27 offset:18432
    v_mfma_f32_16x16x32_bf16 v[84:87], v[200:203], a[20:23], v[84:87]
    v_mfma_f32_16x16x32_bf16 v[84:87], v[204:207], a[36:39], v[84:87]
    ds_read_b64_tr_b16 v[192:193], v27 offset:14336
    v_mfma_f32_16x16x32_bf16 v[88:91], v[196:199], a[8:11], 0
    buffer_load_dwordx4 a[52:55], v16, s[32:35], s50 offen offset:0 sc1
    v_mfma_f32_16x16x32_bf16 v[88:91], v[200:203], a[24:27], v[88:91]
    ds_read_b64_tr_b16 v[194:195], v27 offset:20480
    v_mfma_f32_16x16x32_bf16 v[88:91], v[204:207], a[40:43], v[88:91]
    buffer_load_dwordx4 a[68:71], v16, s[32:35], s50 offen offset:1024 sc1
    v_mfma_f32_16x16x32_bf16 v[92:95], v[196:199], a[12:15], 0
    ds_read_b64_tr_b16 v[196:197], v27 offset:16384
    v_mfma_f32_16x16x32_bf16 v[92:95], v[200:203], a[28:31], v[92:95]
    v_mfma_f32_16x16x32_bf16 v[92:95], v[204:207], a[44:47], v[92:95]
    s_waitcnt lgkmcnt(5)
    ds_read_b64_tr_b16 v[198:199], v27 offset:22528
    v_xor_b32 v28, 96, v12
    v_mfma_f32_16x16x32_bf16 v[96:99], v[208:211], a[0:3], 0
    buffer_load_dwordx4 a[84:87], v16, s[32:35], s50 offen offset:2048 sc1
    v_mfma_f32_16x16x32_bf16 v[96:99], v[212:215], a[16:19], v[96:99]
    ds_read_b64_tr_b16 v[200:201], v28 offset:0
    v_mfma_f32_16x16x32_bf16 v[96:99], v[216:219], a[32:35], v[96:99]
    buffer_load_dwordx4 a[56:59], v17, s[32:35], s50 offen offset:0 sc1
    v_mfma_f32_16x16x32_bf16 v[100:103], v[208:211], a[4:7], 0
    ds_read_b64_tr_b16 v[202:203], v28 offset:6144
    v_mfma_f32_16x16x32_bf16 v[100:103], v[212:215], a[20:23], v[100:103]
    v_mfma_f32_16x16x32_bf16 v[100:103], v[216:219], a[36:39], v[100:103]
    ds_read_b64_tr_b16 v[204:205], v28 offset:2048
    v_mfma_f32_16x16x32_bf16 v[104:107], v[208:211], a[8:11], 0
    buffer_load_dwordx4 a[72:75], v17, s[32:35], s50 offen offset:1024 sc1
    v_mfma_f32_16x16x32_bf16 v[104:107], v[212:215], a[24:27], v[104:107]
    ds_read_b64_tr_b16 v[206:207], v28 offset:8192
    v_mfma_f32_16x16x32_bf16 v[104:107], v[216:219], a[40:43], v[104:107]
    buffer_load_dwordx4 a[88:91], v17, s[32:35], s50 offen offset:2048 sc1
    v_mfma_f32_16x16x32_bf16 v[108:111], v[208:211], a[12:15], 0
    ds_read_b64_tr_b16 v[208:209], v28 offset:4096
    v_mfma_f32_16x16x32_bf16 v[108:111], v[212:215], a[28:31], v[108:111]
    v_mfma_f32_16x16x32_bf16 v[108:111], v[216:219], a[44:47], v[108:111]
    s_waitcnt lgkmcnt(5)
    ds_read_b64_tr_b16 v[210:211], v28 offset:10240
    v_mfma_f32_16x16x32_bf16 v[112:115], v[220:223], a[0:3], 0
    buffer_load_dwordx4 a[60:63], v18, s[32:35], s50 offen offset:0 sc1
    v_mfma_f32_16x16x32_bf16 v[112:115], v[192:195], a[16:19], v[112:115]
    ds_read_b64_tr_b16 v[212:213], v28 offset:12288
    v_mfma_f32_16x16x32_bf16 v[112:115], v[196:199], a[32:35], v[112:115]
    buffer_load_dwordx4 a[76:79], v18, s[32:35], s50 offen offset:1024 sc1
    v_mfma_f32_16x16x32_bf16 v[116:119], v[220:223], a[4:7], 0
    ds_read_b64_tr_b16 v[214:215], v28 offset:18432
    v_mfma_f32_16x16x32_bf16 v[116:119], v[192:195], a[20:23], v[116:119]
    v_mfma_f32_16x16x32_bf16 v[116:119], v[196:199], a[36:39], v[116:119]
    ds_read_b64_tr_b16 v[216:217], v28 offset:14336
    v_mfma_f32_16x16x32_bf16 v[120:123], v[220:223], a[8:11], 0
    buffer_load_dwordx4 a[92:95], v18, s[32:35], s50 offen offset:2048 sc1
    v_mfma_f32_16x16x32_bf16 v[120:123], v[192:195], a[24:27], v[120:123]
    s_add_u32 s50, s40, 6144
    ds_read_b64_tr_b16 v[218:219], v28 offset:20480
    v_mfma_f32_16x16x32_bf16 v[120:123], v[196:199], a[40:43], v[120:123]
    buffer_load_dwordx4 a[96:99], v4, s[32:35], s50 offen offset:0 sc1
    v_mfma_f32_16x16x32_bf16 v[124:127], v[220:223], a[12:15], 0
    ds_read_b64_tr_b16 v[220:221], v28 offset:16384
    v_mfma_f32_16x16x32_bf16 v[124:127], v[192:195], a[28:31], v[124:127]
    v_mfma_f32_16x16x32_bf16 v[124:127], v[196:199], a[44:47], v[124:127]
    s_waitcnt lgkmcnt(5)
    ds_read_b64_tr_b16 v[222:223], v28 offset:22528
    v_mfma_f32_16x16x32_bf16 v[128:131], v[200:203], a[0:3], 0
    buffer_load_dwordx4 a[112:115], v4, s[32:35], s50 offen offset:1024 sc1
    v_mfma_f32_16x16x32_bf16 v[128:131], v[204:207], a[16:19], v[128:131]
    ds_read_b64_tr_b16 v[192:193], v25 offset:24576
    v_mfma_f32_16x16x32_bf16 v[128:131], v[208:211], a[32:35], v[128:131]
    v_mfma_f32_16x16x32_bf16 v[132:135], v[200:203], a[4:7], 0
    ds_read_b64_tr_b16 v[194:195], v25 offset:30720
    v_mfma_f32_16x16x32_bf16 v[132:135], v[204:207], a[20:23], v[132:135]
    buffer_load_dwordx4 a[128:131], v4, s[32:35], s50 offen offset:2048 sc1
    v_mfma_f32_16x16x32_bf16 v[132:135], v[208:211], a[36:39], v[132:135]
    ds_read_b64_tr_b16 v[196:197], v25 offset:26624
    v_mfma_f32_16x16x32_bf16 v[136:139], v[200:203], a[8:11], 0
    v_mfma_f32_16x16x32_bf16 v[136:139], v[204:207], a[24:27], v[136:139]
    ds_read_b64_tr_b16 v[198:199], v25 offset:32768
    v_mfma_f32_16x16x32_bf16 v[136:139], v[208:211], a[40:43], v[136:139]
    v_mfma_f32_16x16x32_bf16 v[140:143], v[200:203], a[12:15], 0
    ds_read_b64_tr_b16 v[200:201], v25 offset:28672
    v_mfma_f32_16x16x32_bf16 v[140:143], v[204:207], a[28:31], v[140:143]
    buffer_load_dwordx4 a[100:103], v16, s[32:35], s50 offen offset:0 sc1
    v_mfma_f32_16x16x32_bf16 v[140:143], v[208:211], a[44:47], v[140:143]
    s_waitcnt lgkmcnt(5)
    ds_read_b64_tr_b16 v[202:203], v25 offset:34816
    v_mfma_f32_16x16x32_bf16 v[144:147], v[212:215], a[0:3], 0
    v_mfma_f32_16x16x32_bf16 v[144:147], v[216:219], a[16:19], v[144:147]
    ds_read_b64_tr_b16 v[204:205], v25 offset:36864
    v_mfma_f32_16x16x32_bf16 v[144:147], v[220:223], a[32:35], v[144:147]
    buffer_load_dwordx4 a[116:119], v16, s[32:35], s50 offen offset:1024 sc1
    v_mfma_f32_16x16x32_bf16 v[148:151], v[212:215], a[4:7], 0
    ds_read_b64_tr_b16 v[206:207], v25 offset:43008
    v_mfma_f32_16x16x32_bf16 v[148:151], v[216:219], a[20:23], v[148:151]
    v_mfma_f32_16x16x32_bf16 v[148:151], v[220:223], a[36:39], v[148:151]
    ds_read_b64_tr_b16 v[208:209], v25 offset:38912
    v_mfma_f32_16x16x32_bf16 v[152:155], v[212:215], a[8:11], 0
    v_mfma_f32_16x16x32_bf16 v[152:155], v[216:219], a[24:27], v[152:155]
    ds_read_b64_tr_b16 v[210:211], v25 offset:45056
    v_mfma_f32_16x16x32_bf16 v[152:155], v[220:223], a[40:43], v[152:155]
    buffer_load_dwordx4 a[132:135], v16, s[32:35], s50 offen offset:2048 sc1
    v_mfma_f32_16x16x32_bf16 v[156:159], v[212:215], a[12:15], 0
    ds_read_b64_tr_b16 v[212:213], v25 offset:40960
    v_mfma_f32_16x16x32_bf16 v[156:159], v[216:219], a[28:31], v[156:159]
    v_mfma_f32_16x16x32_bf16 v[156:159], v[220:223], a[44:47], v[156:159]
    s_waitcnt vmcnt(15) lgkmcnt(5)
    ds_read_b64_tr_b16 v[214:215], v25 offset:47104
    v_mfma_f32_16x16x32_bf16 v[32:35], v[192:195], a[48:51], v[32:35]
    buffer_load_dwordx4 a[104:107], v17, s[32:35], s50 offen offset:0 sc1
    v_mfma_f32_16x16x32_bf16 v[32:35], v[196:199], a[64:67], v[32:35]
    ds_read_b64_tr_b16 v[216:217], v26 offset:24576
    v_mfma_f32_16x16x32_bf16 v[32:35], v[200:203], a[80:83], v[32:35]
    s_waitcnt vmcnt(13)
    v_mfma_f32_16x16x32_bf16 v[36:39], v[192:195], a[52:55], v[36:39]
    ds_read_b64_tr_b16 v[218:219], v26 offset:30720
    v_mfma_f32_16x16x32_bf16 v[36:39], v[196:199], a[68:71], v[36:39]
    v_mfma_f32_16x16x32_bf16 v[36:39], v[200:203], a[84:87], v[36:39]
    s_waitcnt vmcnt(10)
    ds_read_b64_tr_b16 v[220:221], v26 offset:26624
    v_mfma_f32_16x16x32_bf16 v[40:43], v[192:195], a[56:59], v[40:43]
    buffer_load_dwordx4 a[120:123], v17, s[32:35], s50 offen offset:1024 sc1
    v_mfma_f32_16x16x32_bf16 v[40:43], v[196:199], a[72:75], v[40:43]
    ds_read_b64_tr_b16 v[222:223], v26 offset:32768
    v_mfma_f32_16x16x32_bf16 v[40:43], v[200:203], a[88:91], v[40:43]
    s_waitcnt vmcnt(8)
    v_mfma_f32_16x16x32_bf16 v[44:47], v[192:195], a[60:63], v[44:47]
    ds_read_b64_tr_b16 v[192:193], v26 offset:28672
    v_mfma_f32_16x16x32_bf16 v[44:47], v[196:199], a[76:79], v[44:47]
    buffer_load_dwordx4 a[136:139], v17, s[32:35], s50 offen offset:2048 sc1
    v_mfma_f32_16x16x32_bf16 v[44:47], v[200:203], a[92:95], v[44:47]
    s_waitcnt lgkmcnt(5)
    ds_read_b64_tr_b16 v[194:195], v26 offset:34816
    v_mfma_f32_16x16x32_bf16 v[48:51], v[204:207], a[48:51], v[48:51]
    v_mfma_f32_16x16x32_bf16 v[48:51], v[208:211], a[64:67], v[48:51]
    ds_read_b64_tr_b16 v[196:197], v26 offset:36864
    v_mfma_f32_16x16x32_bf16 v[48:51], v[212:215], a[80:83], v[48:51]
    v_mfma_f32_16x16x32_bf16 v[52:55], v[204:207], a[52:55], v[52:55]
    ds_read_b64_tr_b16 v[198:199], v26 offset:43008
    v_mfma_f32_16x16x32_bf16 v[52:55], v[208:211], a[68:71], v[52:55]
    buffer_load_dwordx4 a[108:111], v18, s[32:35], s50 offen offset:0 sc1
    v_mfma_f32_16x16x32_bf16 v[52:55], v[212:215], a[84:87], v[52:55]
    ds_read_b64_tr_b16 v[200:201], v26 offset:38912
    v_mfma_f32_16x16x32_bf16 v[56:59], v[204:207], a[56:59], v[56:59]
    v_mfma_f32_16x16x32_bf16 v[56:59], v[208:211], a[72:75], v[56:59]
    ds_read_b64_tr_b16 v[202:203], v26 offset:45056
    v_mfma_f32_16x16x32_bf16 v[56:59], v[212:215], a[88:91], v[56:59]
    buffer_load_dwordx4 a[124:127], v18, s[32:35], s50 offen offset:1024 sc1
    v_mfma_f32_16x16x32_bf16 v[60:63], v[204:207], a[60:63], v[60:63]
    ds_read_b64_tr_b16 v[204:205], v26 offset:40960
    v_mfma_f32_16x16x32_bf16 v[60:63], v[208:211], a[76:79], v[60:63]
    v_mfma_f32_16x16x32_bf16 v[60:63], v[212:215], a[92:95], v[60:63]
    s_waitcnt lgkmcnt(5)
    ds_read_b64_tr_b16 v[206:207], v26 offset:47104
    v_mfma_f32_16x16x32_bf16 v[64:67], v[216:219], a[48:51], v[64:67]
    v_mfma_f32_16x16x32_bf16 v[64:67], v[220:223], a[64:67], v[64:67]
    ds_read_b64_tr_b16 v[208:209], v27 offset:24576
    v_mfma_f32_16x16x32_bf16 v[64:67], v[192:195], a[80:83], v[64:67]
    buffer_load_dwordx4 a[140:143], v18, s[32:35], s50 offen offset:2048 sc1
    v_mfma_f32_16x16x32_bf16 v[68:71], v[216:219], a[52:55], v[68:71]
    s_add_u32 s50, s40, 9216
    ds_read_b64_tr_b16 v[210:211], v27 offset:30720
    v_mfma_f32_16x16x32_bf16 v[68:71], v[220:223], a[68:71], v[68:71]
    buffer_load_dwordx4 a[144:147], v4, s[32:35], s50 offen offset:0 sc1
    v_mfma_f32_16x16x32_bf16 v[68:71], v[192:195], a[84:87], v[68:71]
    ds_read_b64_tr_b16 v[212:213], v27 offset:26624
    v_mfma_f32_16x16x32_bf16 v[72:75], v[216:219], a[56:59], v[72:75]
    v_mfma_f32_16x16x32_bf16 v[72:75], v[220:223], a[72:75], v[72:75]
    ds_read_b64_tr_b16 v[214:215], v27 offset:32768
    v_mfma_f32_16x16x32_bf16 v[72:75], v[192:195], a[88:91], v[72:75]
    buffer_load_dwordx4 a[160:163], v4, s[32:35], s50 offen offset:1024 sc1
    v_mfma_f32_16x16x32_bf16 v[76:79], v[216:219], a[60:63], v[76:79]
    ds_read_b64_tr_b16 v[216:217], v27 offset:28672
    v_mfma_f32_16x16x32_bf16 v[76:79], v[220:223], a[76:79], v[76:79]
    v_mfma_f32_16x16x32_bf16 v[76:79], v[192:195], a[92:95], v[76:79]
    s_waitcnt lgkmcnt(5)
    ds_read_b64_tr_b16 v[218:219], v27 offset:34816
    v_mfma_f32_16x16x32_bf16 v[80:83], v[196:199], a[48:51], v[80:83]
    buffer_load_dwordx4 a[176:179], v4, s[32:35], s50 offen offset:2048 sc1
    v_mfma_f32_16x16x32_bf16 v[80:83], v[200:203], a[64:67], v[80:83]
    ds_read_b64_tr_b16 v[220:221], v27 offset:36864
    v_mfma_f32_16x16x32_bf16 v[80:83], v[204:207], a[80:83], v[80:83]
    v_mfma_f32_16x16x32_bf16 v[84:87], v[196:199], a[52:55], v[84:87]
    ds_read_b64_tr_b16 v[222:223], v27 offset:43008
    v_mfma_f32_16x16x32_bf16 v[84:87], v[200:203], a[68:71], v[84:87]
    v_mfma_f32_16x16x32_bf16 v[84:87], v[204:207], a[84:87], v[84:87]
    ds_read_b64_tr_b16 v[192:193], v27 offset:38912
    v_mfma_f32_16x16x32_bf16 v[88:91], v[196:199], a[56:59], v[88:91]
    buffer_load_dwordx4 a[148:151], v16, s[32:35], s50 offen offset:0 sc1
    v_mfma_f32_16x16x32_bf16 v[88:91], v[200:203], a[72:75], v[88:91]
    ds_read_b64_tr_b16 v[194:195], v27 offset:45056
    v_mfma_f32_16x16x32_bf16 v[88:91], v[204:207], a[88:91], v[88:91]
    v_mfma_f32_16x16x32_bf16 v[92:95], v[196:199], a[60:63], v[92:95]
    ds_read_b64_tr_b16 v[196:197], v27 offset:40960
    v_mfma_f32_16x16x32_bf16 v[92:95], v[200:203], a[76:79], v[92:95]
    buffer_load_dwordx4 a[164:167], v16, s[32:35], s50 offen offset:1024 sc1
    v_mfma_f32_16x16x32_bf16 v[92:95], v[204:207], a[92:95], v[92:95]
    s_waitcnt lgkmcnt(5)
    ds_read_b64_tr_b16 v[198:199], v27 offset:47104
    v_mfma_f32_16x16x32_bf16 v[96:99], v[208:211], a[48:51], v[96:99]
    v_mfma_f32_16x16x32_bf16 v[96:99], v[212:215], a[64:67], v[96:99]
    ds_read_b64_tr_b16 v[200:201], v28 offset:24576
    v_mfma_f32_16x16x32_bf16 v[96:99], v[216:219], a[80:83], v[96:99]
    v_mfma_f32_16x16x32_bf16 v[100:103], v[208:211], a[52:55], v[100:103]
    ds_read_b64_tr_b16 v[202:203], v28 offset:30720
    v_mfma_f32_16x16x32_bf16 v[100:103], v[212:215], a[68:71], v[100:103]
    buffer_load_dwordx4 a[180:183], v16, s[32:35], s50 offen offset:2048 sc1
    v_mfma_f32_16x16x32_bf16 v[100:103], v[216:219], a[84:87], v[100:103]
    ds_read_b64_tr_b16 v[204:205], v28 offset:26624
    v_mfma_f32_16x16x32_bf16 v[104:107], v[208:211], a[56:59], v[104:107]
    v_mfma_f32_16x16x32_bf16 v[104:107], v[212:215], a[72:75], v[104:107]
    ds_read_b64_tr_b16 v[206:207], v28 offset:32768
    v_mfma_f32_16x16x32_bf16 v[104:107], v[216:219], a[88:91], v[104:107]
    buffer_load_dwordx4 a[152:155], v17, s[32:35], s50 offen offset:0 sc1
    v_mfma_f32_16x16x32_bf16 v[108:111], v[208:211], a[60:63], v[108:111]
    ds_read_b64_tr_b16 v[208:209], v28 offset:28672
    v_mfma_f32_16x16x32_bf16 v[108:111], v[212:215], a[76:79], v[108:111]
    v_mfma_f32_16x16x32_bf16 v[108:111], v[216:219], a[92:95], v[108:111]
    s_waitcnt lgkmcnt(5)
    ds_read_b64_tr_b16 v[210:211], v28 offset:34816
    v_mfma_f32_16x16x32_bf16 v[112:115], v[220:223], a[48:51], v[112:115]
    v_mfma_f32_16x16x32_bf16 v[112:115], v[192:195], a[64:67], v[112:115]
    ds_read_b64_tr_b16 v[212:213], v28 offset:36864
    v_mfma_f32_16x16x32_bf16 v[112:115], v[196:199], a[80:83], v[112:115]
    buffer_load_dwordx4 a[168:171], v17, s[32:35], s50 offen offset:1024 sc1
    v_mfma_f32_16x16x32_bf16 v[116:119], v[220:223], a[52:55], v[116:119]
    ds_read_b64_tr_b16 v[214:215], v28 offset:43008
    v_mfma_f32_16x16x32_bf16 v[116:119], v[192:195], a[68:71], v[116:119]
    v_mfma_f32_16x16x32_bf16 v[116:119], v[196:199], a[84:87], v[116:119]
    ds_read_b64_tr_b16 v[216:217], v28 offset:38912
    v_mfma_f32_16x16x32_bf16 v[120:123], v[220:223], a[56:59], v[120:123]
    buffer_load_dwordx4 a[184:187], v17, s[32:35], s50 offen offset:2048 sc1
    v_mfma_f32_16x16x32_bf16 v[120:123], v[192:195], a[72:75], v[120:123]
    ds_read_b64_tr_b16 v[218:219], v28 offset:45056
    v_mfma_f32_16x16x32_bf16 v[120:123], v[196:199], a[88:91], v[120:123]
    v_mfma_f32_16x16x32_bf16 v[124:127], v[220:223], a[60:63], v[124:127]
    ds_read_b64_tr_b16 v[220:221], v28 offset:40960
    v_mfma_f32_16x16x32_bf16 v[124:127], v[192:195], a[76:79], v[124:127]
    v_mfma_f32_16x16x32_bf16 v[124:127], v[196:199], a[92:95], v[124:127]
    s_waitcnt lgkmcnt(5)
    ds_read_b64_tr_b16 v[222:223], v28 offset:47104
    v_xor_b32 v29, 49152, v12
    v_mfma_f32_16x16x32_bf16 v[128:131], v[200:203], a[48:51], v[128:131]
    buffer_load_dwordx4 a[156:159], v18, s[32:35], s50 offen offset:0 sc1
    v_mfma_f32_16x16x32_bf16 v[128:131], v[204:207], a[64:67], v[128:131]
    ds_read_b64_tr_b16 v[192:193], v29 offset:0
    v_mfma_f32_16x16x32_bf16 v[128:131], v[208:211], a[80:83], v[128:131]
    v_mfma_f32_16x16x32_bf16 v[132:135], v[200:203], a[52:55], v[132:135]
    ds_read_b64_tr_b16 v[194:195], v29 offset:6144
    v_mfma_f32_16x16x32_bf16 v[132:135], v[204:207], a[68:71], v[132:135]
    buffer_load_dwordx4 a[172:175], v18, s[32:35], s50 offen offset:1024 sc1
    v_mfma_f32_16x16x32_bf16 v[132:135], v[208:211], a[84:87], v[132:135]
    ds_read_b64_tr_b16 v[196:197], v29 offset:2048
    v_mfma_f32_16x16x32_bf16 v[136:139], v[200:203], a[56:59], v[136:139]
    v_mfma_f32_16x16x32_bf16 v[136:139], v[204:207], a[72:75], v[136:139]
    ds_read_b64_tr_b16 v[198:199], v29 offset:8192
    v_mfma_f32_16x16x32_bf16 v[136:139], v[208:211], a[88:91], v[136:139]
    v_mfma_f32_16x16x32_bf16 v[140:143], v[200:203], a[60:63], v[140:143]
    ds_read_b64_tr_b16 v[200:201], v29 offset:4096
    v_mfma_f32_16x16x32_bf16 v[140:143], v[204:207], a[76:79], v[140:143]
    buffer_load_dwordx4 a[188:191], v18, s[32:35], s50 offen offset:2048 sc1
    v_mfma_f32_16x16x32_bf16 v[140:143], v[208:211], a[92:95], v[140:143]
    s_waitcnt lgkmcnt(5)
    ds_read_b64_tr_b16 v[202:203], v29 offset:10240
    v_mfma_f32_16x16x32_bf16 v[144:147], v[212:215], a[48:51], v[144:147]
    v_mfma_f32_16x16x32_bf16 v[144:147], v[216:219], a[64:67], v[144:147]
    s_lshl_b32 s53, s3, 11
    ds_read_b64_tr_b16 v[204:205], v29 offset:12288
    v_mfma_f32_16x16x32_bf16 v[144:147], v[220:223], a[80:83], v[144:147]
    v_mfma_f32_16x16x32_bf16 v[148:151], v[212:215], a[52:55], v[148:151]
    s_add_u32 s53, s53, 61440
    ds_read_b64_tr_b16 v[206:207], v29 offset:18432
    v_lshlrev_b32 v31, 7, v2
    v_mfma_f32_16x16x32_bf16 v[148:151], v[216:219], a[68:71], v[148:151]
    buffer_load_dwordx2 v[14:15], v31, s[12:15], s53 offen sc1
    v_mfma_f32_16x16x32_bf16 v[148:151], v[220:223], a[84:87], v[148:151]
    s_add_u32 s50, s40, 12288
    ds_read_b64_tr_b16 v[208:209], v29 offset:14336
    v_mfma_f32_16x16x32_bf16 v[152:155], v[212:215], a[56:59], v[152:155]
    buffer_load_dwordx4 a[192:195], v4, s[32:35], s50 offen offset:0 sc1
    v_mfma_f32_16x16x32_bf16 v[152:155], v[216:219], a[72:75], v[152:155]
    ds_read_b64_tr_b16 v[210:211], v29 offset:20480
    v_mfma_f32_16x16x32_bf16 v[152:155], v[220:223], a[88:91], v[152:155]
    v_mfma_f32_16x16x32_bf16 v[156:159], v[212:215], a[60:63], v[156:159]
    ds_read_b64_tr_b16 v[212:213], v29 offset:16384
    v_mfma_f32_16x16x32_bf16 v[156:159], v[216:219], a[76:79], v[156:159]
    buffer_load_dwordx4 a[208:211], v4, s[32:35], s50 offen offset:1024 sc1
    v_mfma_f32_16x16x32_bf16 v[156:159], v[220:223], a[92:95], v[156:159]
    s_waitcnt vmcnt(24) lgkmcnt(5)
    ds_read_b64_tr_b16 v[214:215], v29 offset:22528
    v_xor_b32 v25, 49184, v12
    v_mfma_f32_16x16x32_bf16 v[32:35], v[192:195], a[96:99], v[32:35]
    v_mfma_f32_16x16x32_bf16 v[32:35], v[196:199], a[112:115], v[32:35]
    ds_read_b64_tr_b16 v[216:217], v25 offset:0
    v_mfma_f32_16x16x32_bf16 v[32:35], v[200:203], a[128:131], v[32:35]
    s_waitcnt vmcnt(21)
    v_mfma_f32_16x16x32_bf16 v[36:39], v[192:195], a[100:103], v[36:39]
    ds_read_b64_tr_b16 v[218:219], v25 offset:6144
    v_mfma_f32_16x16x32_bf16 v[36:39], v[196:199], a[116:119], v[36:39]
    buffer_load_dwordx4 a[224:227], v4, s[32:35], s50 offen offset:2048 sc1
    v_mfma_f32_16x16x32_bf16 v[36:39], v[200:203], a[132:135], v[36:39]
    s_waitcnt vmcnt(19)
    ds_read_b64_tr_b16 v[220:221], v25 offset:2048
    v_mfma_f32_16x16x32_bf16 v[40:43], v[192:195], a[104:107], v[40:43]
    v_mfma_f32_16x16x32_bf16 v[40:43], v[196:199], a[120:123], v[40:43]
    ds_read_b64_tr_b16 v[222:223], v25 offset:8192
    v_mfma_f32_16x16x32_bf16 v[40:43], v[200:203], a[136:139], v[40:43]
    s_waitcnt vmcnt(16)
    v_mfma_f32_16x16x32_bf16 v[44:47], v[192:195], a[108:111], v[44:47]
    ds_read_b64_tr_b16 v[192:193], v25 offset:4096
    v_mfma_f32_16x16x32_bf16 v[44:47], v[196:199], a[124:127], v[44:47]
    buffer_load_dwordx4 a[196:199], v16, s[32:35], s50 offen offset:0 sc1
    v_mfma_f32_16x16x32_bf16 v[44:47], v[200:203], a[140:143], v[44:47]
    s_waitcnt lgkmcnt(5)
    ds_read_b64_tr_b16 v[194:195], v25 offset:10240
    v_mfma_f32_16x16x32_bf16 v[48:51], v[204:207], a[96:99], v[48:51]
    v_mfma_f32_16x16x32_bf16 v[48:51], v[208:211], a[112:115], v[48:51]
    ds_read_b64_tr_b16 v[196:197], v25 offset:12288
    v_mfma_f32_16x16x32_bf16 v[48:51], v[212:215], a[128:131], v[48:51]
    buffer_load_dwordx4 a[212:215], v16, s[32:35], s50 offen offset:1024 sc1
    v_mfma_f32_16x16x32_bf16 v[52:55], v[204:207], a[100:103], v[52:55]
    ds_read_b64_tr_b16 v[198:199], v25 offset:18432
    v_mfma_f32_16x16x32_bf16 v[52:55], v[208:211], a[116:119], v[52:55]
    v_mfma_f32_16x16x32_bf16 v[52:55], v[212:215], a[132:135], v[52:55]
    ds_read_b64_tr_b16 v[200:201], v25 offset:14336
    v_mfma_f32_16x16x32_bf16 v[56:59], v[204:207], a[104:107], v[56:59]
    buffer_load_dwordx4 a[228:231], v16, s[32:35], s50 offen offset:2048 sc1
    v_mfma_f32_16x16x32_bf16 v[56:59], v[208:211], a[120:123], v[56:59]
    ds_read_b64_tr_b16 v[202:203], v25 offset:20480
    v_mfma_f32_16x16x32_bf16 v[56:59], v[212:215], a[136:139], v[56:59]
    v_mfma_f32_16x16x32_bf16 v[60:63], v[204:207], a[108:111], v[60:63]
    ds_read_b64_tr_b16 v[204:205], v25 offset:16384
    v_mfma_f32_16x16x32_bf16 v[60:63], v[208:211], a[124:127], v[60:63]
    v_mfma_f32_16x16x32_bf16 v[60:63], v[212:215], a[140:143], v[60:63]
    s_waitcnt lgkmcnt(5)
    ds_read_b64_tr_b16 v[206:207], v25 offset:22528
    v_xor_b32 v26, 49216, v12
    v_mfma_f32_16x16x32_bf16 v[64:67], v[216:219], a[96:99], v[64:67]
    buffer_load_dwordx4 a[200:203], v17, s[32:35], s50 offen offset:0 sc1
    v_mfma_f32_16x16x32_bf16 v[64:67], v[220:223], a[112:115], v[64:67]
    ds_read_b64_tr_b16 v[208:209], v26 offset:0
    v_mfma_f32_16x16x32_bf16 v[64:67], v[192:195], a[128:131], v[64:67]
    v_mfma_f32_16x16x32_bf16 v[68:71], v[216:219], a[100:103], v[68:71]
Lhop4:
    s_cbranch_execz Lhop8
    ds_read_b64_tr_b16 v[210:211], v26 offset:6144
    v_mfma_f32_16x16x32_bf16 v[68:71], v[220:223], a[116:119], v[68:71]
    buffer_load_dwordx4 a[216:219], v17, s[32:35], s50 offen offset:1024 sc1
    v_mfma_f32_16x16x32_bf16 v[68:71], v[192:195], a[132:135], v[68:71]
    ds_read_b64_tr_b16 v[212:213], v26 offset:2048
    v_mfma_f32_16x16x32_bf16 v[72:75], v[216:219], a[104:107], v[72:75]
    v_mfma_f32_16x16x32_bf16 v[72:75], v[220:223], a[120:123], v[72:75]
    ds_read_b64_tr_b16 v[214:215], v26 offset:8192
    v_mfma_f32_16x16x32_bf16 v[72:75], v[192:195], a[136:139], v[72:75]
    v_mfma_f32_16x16x32_bf16 v[76:79], v[216:219], a[108:111], v[76:79]
    ds_read_b64_tr_b16 v[216:217], v26 offset:4096
    v_mfma_f32_16x16x32_bf16 v[76:79], v[220:223], a[124:127], v[76:79]
    buffer_load_dwordx4 a[232:235], v17, s[32:35], s50 offen offset:2048 sc1
    v_mfma_f32_16x16x32_bf16 v[76:79], v[192:195], a[140:143], v[76:79]
    s_waitcnt lgkmcnt(5)
    ds_read_b64_tr_b16 v[218:219], v26 offset:10240
    v_mfma_f32_16x16x32_bf16 v[80:83], v[196:199], a[96:99], v[80:83]
    v_mfma_f32_16x16x32_bf16 v[80:83], v[200:203], a[112:115], v[80:83]
    ds_read_b64_tr_b16 v[220:221], v26 offset:12288
    v_mfma_f32_16x16x32_bf16 v[80:83], v[204:207], a[128:131], v[80:83]
    buffer_load_dwordx4 a[204:207], v18, s[32:35], s50 offen offset:0 sc1
    v_mfma_f32_16x16x32_bf16 v[84:87], v[196:199], a[100:103], v[84:87]
    ds_read_b64_tr_b16 v[222:223], v26 offset:18432
    v_mfma_f32_16x16x32_bf16 v[84:87], v[200:203], a[116:119], v[84:87]
    v_mfma_f32_16x16x32_bf16 v[84:87], v[204:207], a[132:135], v[84:87]
    ds_read_b64_tr_b16 v[192:193], v26 offset:14336
    v_mfma_f32_16x16x32_bf16 v[88:91], v[196:199], a[104:107], v[88:91]
    v_mfma_f32_16x16x32_bf16 v[88:91], v[200:203], a[120:123], v[88:91]
    ds_read_b64_tr_b16 v[194:195], v26 offset:20480
    v_mfma_f32_16x16x32_bf16 v[88:91], v[204:207], a[136:139], v[88:91]
    buffer_load_dwordx4 a[220:223], v18, s[32:35], s50 offen offset:1024 sc1
    v_mfma_f32_16x16x32_bf16 v[92:95], v[196:199], a[108:111], v[92:95]
    ds_read_b64_tr_b16 v[196:197], v26 offset:16384
    v_mfma_f32_16x16x32_bf16 v[92:95], v[200:203], a[124:127], v[92:95]
    v_mfma_f32_16x16x32_bf16 v[92:95], v[204:207], a[140:143], v[92:95]
    s_waitcnt lgkmcnt(5)
    ds_read_b64_tr_b16 v[198:199], v26 offset:22528
    v_xor_b32 v27, 49248, v12
    v_mfma_f32_16x16x32_bf16 v[96:99], v[208:211], a[96:99], v[96:99]
    buffer_load_dwordx4 a[236:239], v18, s[32:35], s50 offen offset:2048 sc1
    v_mfma_f32_16x16x32_bf16 v[96:99], v[212:215], a[112:115], v[96:99]
    s_add_u32 s50, s40, 15360
    ds_read_b64_tr_b16 v[200:201], v27 offset:0
    v_mfma_f32_16x16x32_bf16 v[96:99], v[216:219], a[128:131], v[96:99]
    buffer_load_dwordx4 a[240:243], v4, s[32:35], s50 offen offset:0 sc1
    v_mfma_f32_16x16x32_bf16 v[100:103], v[208:211], a[100:103], v[100:103]
    ds_read_b64_tr_b16 v[202:203], v27 offset:6144
    v_mfma_f32_16x16x32_bf16 v[100:103], v[212:215], a[116:119], v[100:103]
    v_mfma_f32_16x16x32_bf16 v[100:103], v[216:219], a[132:135], v[100:103]
    ds_read_b64_tr_b16 v[204:205], v27 offset:2048
    v_mfma_f32_16x16x32_bf16 v[104:107], v[208:211], a[104:107], v[104:107]
    buffer_load_dwordx4 v[224:227], v4, s[32:35], s50 offen offset:1024 sc1
    v_mfma_f32_16x16x32_bf16 v[104:107], v[212:215], a[120:123], v[104:107]
    ds_read_b64_tr_b16 v[206:207], v27 offset:8192
    v_mfma_f32_16x16x32_bf16 v[104:107], v[216:219], a[136:139], v[104:107]
    v_mfma_f32_16x16x32_bf16 v[108:111], v[208:211], a[108:111], v[108:111]
    ds_read_b64_tr_b16 v[208:209], v27 offset:4096
    v_mfma_f32_16x16x32_bf16 v[108:111], v[212:215], a[124:127], v[108:111]
    buffer_load_dwordx4 v[240:243], v4, s[32:35], s50 offen offset:2048 sc1
    v_mfma_f32_16x16x32_bf16 v[108:111], v[216:219], a[140:143], v[108:111]
    s_waitcnt lgkmcnt(5)
    ds_read_b64_tr_b16 v[210:211], v27 offset:10240
    v_mfma_f32_16x16x32_bf16 v[112:115], v[220:223], a[96:99], v[112:115]
    v_mfma_f32_16x16x32_bf16 v[112:115], v[192:195], a[112:115], v[112:115]
    ds_read_b64_tr_b16 v[212:213], v27 offset:12288
    v_mfma_f32_16x16x32_bf16 v[112:115], v[196:199], a[128:131], v[112:115]
    v_mfma_f32_16x16x32_bf16 v[116:119], v[220:223], a[100:103], v[116:119]
    ds_read_b64_tr_b16 v[214:215], v27 offset:18432
    v_mfma_f32_16x16x32_bf16 v[116:119], v[192:195], a[116:119], v[116:119]
    buffer_load_dwordx4 a[244:247], v16, s[32:35], s50 offen offset:0 sc1
    v_mfma_f32_16x16x32_bf16 v[116:119], v[196:199], a[132:135], v[116:119]
    ds_read_b64_tr_b16 v[216:217], v27 offset:14336
    v_mfma_f32_16x16x32_bf16 v[120:123], v[220:223], a[104:107], v[120:123]
    v_mfma_f32_16x16x32_bf16 v[120:123], v[192:195], a[120:123], v[120:123]
    ds_read_b64_tr_b16 v[218:219], v27 offset:20480
    v_mfma_f32_16x16x32_bf16 v[120:123], v[196:199], a[136:139], v[120:123]
    buffer_load_dwordx4 v[228:231], v16, s[32:35], s50 offen offset:1024 sc1
    v_mfma_f32_16x16x32_bf16 v[124:127], v[220:223], a[108:111], v[124:127]
    ds_read_b64_tr_b16 v[220:221], v27 offset:16384
    v_mfma_f32_16x16x32_bf16 v[124:127], v[192:195], a[124:127], v[124:127]
    v_mfma_f32_16x16x32_bf16 v[124:127], v[196:199], a[140:143], v[124:127]
    s_waitcnt lgkmcnt(5)
    ds_read_b64_tr_b16 v[222:223], v27 offset:22528
    v_mfma_f32_16x16x32_bf16 v[128:131], v[200:203], a[96:99], v[128:131]
    v_mfma_f32_16x16x32_bf16 v[128:131], v[204:207], a[112:115], v[128:131]
    ds_read_b64_tr_b16 v[192:193], v29 offset:24576
    v_mfma_f32_16x16x32_bf16 v[128:131], v[208:211], a[128:131], v[128:131]
    buffer_load_dwordx4 v[244:247], v16, s[32:35], s50 offen offset:2048 sc1
    v_mfma_f32_16x16x32_bf16 v[132:135], v[200:203], a[100:103], v[132:135]
    ds_read_b64_tr_b16 v[194:195], v29 offset:30720
    v_mfma_f32_16x16x32_bf16 v[132:135], v[204:207], a[116:119], v[132:135]
    v_mfma_f32_16x16x32_bf16 v[132:135], v[208:211], a[132:135], v[132:135]
    ds_read_b64_tr_b16 v[196:197], v29 offset:26624
    v_mfma_f32_16x16x32_bf16 v[136:139], v[200:203], a[104:107], v[136:139]
    buffer_load_dwordx4 a[248:251], v17, s[32:35], s50 offen offset:0 sc1
    v_mfma_f32_16x16x32_bf16 v[136:139], v[204:207], a[120:123], v[136:139]
    ds_read_b64_tr_b16 v[198:199], v29 offset:32768
    v_mfma_f32_16x16x32_bf16 v[136:139], v[208:211], a[136:139], v[136:139]
    v_mfma_f32_16x16x32_bf16 v[140:143], v[200:203], a[108:111], v[140:143]
    ds_read_b64_tr_b16 v[200:201], v29 offset:28672
    v_mfma_f32_16x16x32_bf16 v[140:143], v[204:207], a[124:127], v[140:143]
    s_waitcnt vmcnt(19)
    v_xor_b32 v14, s6, v14
    v_xor_b32 v15, s6, v15
    v_mfma_f32_16x16x32_bf16 v[140:143], v[208:211], a[140:143], v[140:143]
    s_waitcnt lgkmcnt(5)
    ds_read_b64_tr_b16 v[202:203], v29 offset:34816
    v_or_b32 v14, v14, v15
    v_mfma_f32_16x16x32_bf16 v[144:147], v[212:215], a[96:99], v[144:147]
    buffer_load_dwordx4 v[232:235], v17, s[32:35], s50 offen offset:1024 sc1
    v_mfma_f32_16x16x32_bf16 v[144:147], v[216:219], a[112:115], v[144:147]
    ds_read_b64_tr_b16 v[204:205], v29 offset:36864
    v_cmp_ne_u32 vcc, 0, v14
    v_mfma_f32_16x16x32_bf16 v[144:147], v[220:223], a[128:131], v[144:147]
    v_mfma_f32_16x16x32_bf16 v[148:151], v[212:215], a[100:103], v[148:151]
    s_cbranch_vccnz Lslow_22
Lback_23:
    ds_read_b64_tr_b16 v[206:207], v29 offset:43008
    v_mfma_f32_16x16x32_bf16 v[148:151], v[216:219], a[116:119], v[148:151]
    buffer_load_dwordx4 v[248:251], v17, s[32:35], s50 offen offset:2048 sc1
    v_mfma_f32_16x16x32_bf16 v[148:151], v[220:223], a[132:135], v[148:151]
    ds_read_b64_tr_b16 v[208:209], v29 offset:38912
    v_mfma_f32_16x16x32_bf16 v[152:155], v[212:215], a[104:107], v[152:155]
    v_mfma_f32_16x16x32_bf16 v[152:155], v[216:219], a[120:123], v[152:155]
    ds_read_b64_tr_b16 v[210:211], v29 offset:45056
    v_mfma_f32_16x16x32_bf16 v[152:155], v[220:223], a[136:139], v[152:155]
    v_mfma_f32_16x16x32_bf16 v[156:159], v[212:215], a[108:111], v[156:159]
    ds_read_b64_tr_b16 v[212:213], v29 offset:40960
    v_mfma_f32_16x16x32_bf16 v[156:159], v[216:219], a[124:127], v[156:159]
    buffer_load_dwordx4 a[252:255], v18, s[32:35], s50 offen offset:0 sc1
    v_mfma_f32_16x16x32_bf16 v[156:159], v[220:223], a[140:143], v[156:159]
    s_waitcnt vmcnt(32) lgkmcnt(5)
    ds_read_b64_tr_b16 v[214:215], v29 offset:47104
    v_xor_b32 v28, 98304, v12
    v_mfma_f32_16x16x32_bf16 v[32:35], v[192:195], a[144:147], v[32:35]
    v_mfma_f32_16x16x32_bf16 v[32:35], v[196:199], a[160:163], v[32:35]
    ds_read_b64_tr_b16 v[216:217], v28 offset:0
    v_mfma_f32_16x16x32_bf16 v[32:35], v[200:203], a[176:179], v[32:35]
    s_waitcnt vmcnt(29)
    s_waitcnt vmcnt(59)
    s_barrier
    s_or_b32 s48, s2, s3
    s_cbranch_scc0 Lep
Lepb:
    v_mfma_f32_16x16x32_bf16 v[36:39], v[192:195], a[148:151], v[36:39]
    ds_read_b64_tr_b16 v[218:219], v28 offset:6144
    v_mfma_f32_16x16x32_bf16 v[36:39], v[196:199], a[164:167], v[36:39]
    buffer_load_dwordx4 v[236:239], v18, s[32:35], s50 offen offset:1024 sc1
    v_mfma_f32_16x16x32_bf16 v[36:39], v[200:203], a[180:183], v[36:39]
    s_waitcnt vmcnt(27)
    ds_read_b64_tr_b16 v[220:221], v28 offset:2048
    v_mfma_f32_16x16x32_bf16 v[40:43], v[192:195], a[152:155], v[40:43]
    v_mfma_f32_16x16x32_bf16 v[40:43], v[196:199], a[168:171], v[40:43]
    ds_read_b64_tr_b16 v[222:223], v28 offset:8192
    v_mfma_f32_16x16x32_bf16 v[40:43], v[200:203], a[184:187], v[40:43]
    s_waitcnt vmcnt(24)
    v_mfma_f32_16x16x32_bf16 v[44:47], v[192:195], a[156:159], v[44:47]
    ds_read_b64_tr_b16 v[192:193], v28 offset:4096
    v_mfma_f32_16x16x32_bf16 v[44:47], v[196:199], a[172:175], v[44:47]
    buffer_load_dwordx4 v[252:255], v18, s[32:35], s50 offen offset:2048 sc1
    v_mfma_f32_16x16x32_bf16 v[44:47], v[200:203], a[188:191], v[44:47]
    s_waitcnt lgkmcnt(5)
    s_and_b32 s48, s8, 15
    ds_read_b64_tr_b16 v[194:195], v28 offset:10240
    v_mfma_f32_16x16x32_bf16 v[48:51], v[204:207], a[144:147], v[48:51]
    s_mul_i32 s48, s48, 165888
    s_mul_i32 s84, s46, 2211840
    s_sub_u32 s84, s83, s84
    v_mfma_f32_16x16x32_bf16 v[48:51], v[208:211], a[160:163], v[48:51]
    s_add_u32 s84, s84, s48
    s_and_b32 s48, s27, 3
    ds_read_b64_tr_b16 v[196:197], v28 offset:12288
    v_mfma_f32_16x16x32_bf16 v[48:51], v[212:215], a[176:179], v[48:51]
    s_lshl_b32 s48, s48, 7
    s_sub_u32 s84, s84, s48
    v_lshrrev_b32 v17, 2, v1
    v_mfma_f32_16x16x32_bf16 v[52:55], v[204:207], a[148:151], v[52:55]
    ds_read_b64_tr_b16 v[198:199], v28 offset:18432
    v_min_u32 v17, 8, v17
    v_mfma_f32_16x16x32_bf16 v[52:55], v[208:211], a[164:167], v[52:55]
    v_mul_u32_u24 v17, 9216, v17
    v_and_b32 v18, 3, v1
    v_mfma_f32_16x16x32_bf16 v[52:55], v[212:215], a[180:183], v[52:55]
    ds_read_b64_tr_b16 v[200:201], v28 offset:14336
    v_lshl_add_u32 v17, v18, 7, v17
    v_mfma_f32_16x16x32_bf16 v[56:59], v[204:207], a[152:155], v[56:59]
    buffer_load_dword v30, v17, s[16:19], s84 offen offset:512
    v_mfma_f32_16x16x32_bf16 v[56:59], v[208:211], a[168:171], v[56:59]
    s_add_u32 s84, s84, 82944
    ds_read_b64_tr_b16 v[202:203], v28 offset:20480
    v_mfma_f32_16x16x32_bf16 v[56:59], v[212:215], a[184:187], v[56:59]
    buffer_load_dword v30, v17, s[16:19], s84 offen offset:512
    v_mfma_f32_16x16x32_bf16 v[60:63], v[204:207], a[156:159], v[60:63]
    ds_read_b64_tr_b16 v[204:205], v28 offset:16384
    v_mfma_f32_16x16x32_bf16 v[60:63], v[208:211], a[172:175], v[60:63]
    v_mfma_f32_16x16x32_bf16 v[60:63], v[212:215], a[188:191], v[60:63]
    s_waitcnt vmcnt(23) lgkmcnt(5)
    ds_read_b64_tr_b16 v[206:207], v28 offset:22528
    v_mfma_f32_16x16x32_bf16 v[32:35], v[216:219], a[192:195], v[32:35]
    v_mfma_f32_16x16x32_bf16 v[32:35], v[220:223], a[208:211], v[32:35]
    ds_read_b64_tr_b16 v[208:209], v28 offset:24576
    v_mfma_f32_16x16x32_bf16 v[32:35], v[192:195], a[224:227], v[32:35]
    s_waitcnt vmcnt(20)
    v_mfma_f32_16x16x32_bf16 v[36:39], v[216:219], a[196:199], v[36:39]
    ds_read_b64_tr_b16 v[210:211], v28 offset:30720
    v_mfma_f32_16x16x32_bf16 v[36:39], v[220:223], a[212:215], v[36:39]
    v_mfma_f32_16x16x32_bf16 v[36:39], v[192:195], a[228:231], v[36:39]
    s_waitcnt vmcnt(17)
    ds_read_b64_tr_b16 v[212:213], v28 offset:26624
    v_mfma_f32_16x16x32_bf16 v[40:43], v[216:219], a[200:203], v[40:43]
    v_mfma_f32_16x16x32_bf16 v[40:43], v[220:223], a[216:219], v[40:43]
    ds_read_b64_tr_b16 v[214:215], v28 offset:32768
    v_mfma_f32_16x16x32_bf16 v[40:43], v[192:195], a[232:235], v[40:43]
    s_waitcnt vmcnt(14)
    v_mfma_f32_16x16x32_bf16 v[44:47], v[216:219], a[204:207], v[44:47]
    ds_read_b64_tr_b16 v[216:217], v28 offset:28672
    v_mfma_f32_16x16x32_bf16 v[44:47], v[220:223], a[220:223], v[44:47]
    v_mfma_f32_16x16x32_bf16 v[44:47], v[192:195], a[236:239], v[44:47]
    s_waitcnt lgkmcnt(5)
    ds_read_b64_tr_b16 v[218:219], v28 offset:34816
    v_mfma_f32_16x16x32_bf16 v[48:51], v[196:199], a[192:195], v[48:51]
    v_mfma_f32_16x16x32_bf16 v[48:51], v[200:203], a[208:211], v[48:51]
    ds_read_b64_tr_b16 v[220:221], v28 offset:36864
    v_mfma_f32_16x16x32_bf16 v[48:51], v[204:207], a[224:227], v[48:51]
    v_mfma_f32_16x16x32_bf16 v[52:55], v[196:199], a[196:199], v[52:55]
    ds_read_b64_tr_b16 v[222:223], v28 offset:43008
    v_mfma_f32_16x16x32_bf16 v[52:55], v[200:203], a[212:215], v[52:55]
    v_mfma_f32_16x16x32_bf16 v[52:55], v[204:207], a[228:231], v[52:55]
    ds_read_b64_tr_b16 v[192:193], v28 offset:38912
    v_mfma_f32_16x16x32_bf16 v[56:59], v[196:199], a[200:203], v[56:59]
    v_mfma_f32_16x16x32_bf16 v[56:59], v[200:203], a[216:219], v[56:59]
    ds_read_b64_tr_b16 v[194:195], v28 offset:45056
    v_mfma_f32_16x16x32_bf16 v[56:59], v[204:207], a[232:235], v[56:59]
    v_mfma_f32_16x16x32_bf16 v[60:63], v[196:199], a[204:207], v[60:63]
    ds_read_b64_tr_b16 v[196:197], v28 offset:40960
    v_mfma_f32_16x16x32_bf16 v[60:63], v[200:203], a[220:223], v[60:63]
    v_mfma_f32_16x16x32_bf16 v[60:63], v[204:207], a[236:239], v[60:63]
    s_waitcnt vmcnt(11) lgkmcnt(5)
    ds_read_b64_tr_b16 v[198:199], v28 offset:47104
    v_mfma_f32_16x16x32_bf16 v[32:35], v[208:211], a[240:243], v[32:35]
    v_mfma_f32_16x16x32_bf16 v[32:35], v[212:215], v[224:227], v[32:35]
    ds_read_b64_tr_b16 v[200:201], v25 offset:24576
    v_mfma_f32_16x16x32_bf16 v[32:35], v[216:219], v[240:243], v[32:35]
    s_waitcnt vmcnt(8)
    v_mfma_f32_16x16x32_bf16 v[36:39], v[208:211], a[244:247], v[36:39]
    ds_read_b64_tr_b16 v[202:203], v25 offset:30720
    v_mfma_f32_16x16x32_bf16 v[36:39], v[212:215], v[228:231], v[36:39]
    v_mfma_f32_16x16x32_bf16 v[36:39], v[216:219], v[244:247], v[36:39]
    s_waitcnt vmcnt(5)
    ds_read_b64_tr_b16 v[204:205], v25 offset:26624
    v_mfma_f32_16x16x32_bf16 v[40:43], v[208:211], a[248:251], v[40:43]
    v_mfma_f32_16x16x32_bf16 v[40:43], v[212:215], v[232:235], v[40:43]
    ds_read_b64_tr_b16 v[206:207], v25 offset:32768
    v_mfma_f32_16x16x32_bf16 v[40:43], v[216:219], v[248:251], v[40:43]
    s_waitcnt vmcnt(2)
    v_mfma_f32_16x16x32_bf16 v[44:47], v[208:211], a[252:255], v[44:47]
    ds_read_b64_tr_b16 v[208:209], v25 offset:28672
    v_mfma_f32_16x16x32_bf16 v[44:47], v[212:215], v[236:239], v[44:47]
    v_mfma_f32_16x16x32_bf16 v[44:47], v[216:219], v[252:255], v[44:47]
    s_waitcnt lgkmcnt(5)
    ds_read_b64_tr_b16 v[210:211], v25 offset:34816
    v_xor_b32 v26, 98336, v12
    v_mfma_f32_16x16x32_bf16 v[48:51], v[220:223], a[240:243], v[48:51]
    v_mfma_f32_16x16x32_bf16 v[48:51], v[192:195], v[224:227], v[48:51]
    ds_read_b64_tr_b16 v[212:213], v26 offset:0
    v_mfma_f32_16x16x32_bf16 v[48:51], v[196:199], v[240:243], v[48:51]
    v_mfma_f32_16x16x32_bf16 v[52:55], v[220:223], a[244:247], v[52:55]
    ds_read_b64_tr_b16 v[214:215], v26 offset:6144
    v_mfma_f32_16x16x32_bf16 v[52:55], v[192:195], v[228:231], v[52:55]
    v_mfma_f32_16x16x32_bf16 v[52:55], v[196:199], v[244:247], v[52:55]
    ds_read_b64_tr_b16 v[216:217], v26 offset:2048
    v_mfma_f32_16x16x32_bf16 v[56:59], v[220:223], a[248:251], v[56:59]
    v_mfma_f32_16x16x32_bf16 v[56:59], v[192:195], v[232:235], v[56:59]
    ds_read_b64_tr_b16 v[218:219], v26 offset:8192
    v_mfma_f32_16x16x32_bf16 v[56:59], v[196:199], v[248:251], v[56:59]
    v_exp_f32 v16, -v32
    v_mfma_f32_16x16x32_bf16 v[60:63], v[220:223], a[252:255], v[60:63]
    ds_read_b64_tr_b16 v[220:221], v26 offset:4096
    v_add_f32 v16, 1.0, v16
    v_mfma_f32_16x16x32_bf16 v[60:63], v[192:195], v[236:239], v[60:63]
    v_rcp_f32 v16, v16
    v_mfma_f32_16x16x32_bf16 v[60:63], v[196:199], v[252:255], v[60:63]
    s_waitcnt lgkmcnt(5)
    ds_read_b64_tr_b16 v[222:223], v26 offset:10240
    v_mul_f32 v32, v32, v16
    v_mfma_f32_16x16x32_bf16 v[64:67], v[200:203], a[144:147], v[64:67]
    v_exp_f32 v17, -v33
    v_mfma_f32_16x16x32_bf16 v[64:67], v[204:207], a[160:163], v[64:67]
    ds_read_b64_tr_b16 v[192:193], v26 offset:24576
    v_add_f32 v17, 1.0, v17
    v_mfma_f32_16x16x32_bf16 v[64:67], v[208:211], a[176:179], v[64:67]
    v_rcp_f32 v17, v17
    v_mfma_f32_16x16x32_bf16 v[68:71], v[200:203], a[148:151], v[68:71]
    ds_read_b64_tr_b16 v[194:195], v26 offset:30720
    v_mul_f32 v33, v33, v17
    v_mfma_f32_16x16x32_bf16 v[68:71], v[204:207], a[164:167], v[68:71]
    v_exp_f32 v18, -v34
    v_mfma_f32_16x16x32_bf16 v[68:71], v[208:211], a[180:183], v[68:71]
    ds_read_b64_tr_b16 v[196:197], v26 offset:26624
    v_add_f32 v18, 1.0, v18
    v_mfma_f32_16x16x32_bf16 v[72:75], v[200:203], a[152:155], v[72:75]
    v_rcp_f32 v18, v18
    v_mfma_f32_16x16x32_bf16 v[72:75], v[204:207], a[168:171], v[72:75]
    ds_read_b64_tr_b16 v[198:199], v26 offset:32768
    v_mul_f32 v34, v34, v18
    v_mfma_f32_16x16x32_bf16 v[72:75], v[208:211], a[184:187], v[72:75]
    v_exp_f32 v16, -v35
    v_mfma_f32_16x16x32_bf16 v[76:79], v[200:203], a[156:159], v[76:79]
    ds_read_b64_tr_b16 v[200:201], v26 offset:28672
    v_add_f32 v16, 1.0, v16
    v_mfma_f32_16x16x32_bf16 v[76:79], v[204:207], a[172:175], v[76:79]
    v_rcp_f32 v16, v16
    v_mfma_f32_16x16x32_bf16 v[76:79], v[208:211], a[188:191], v[76:79]
    s_waitcnt lgkmcnt(5)
    ds_read_b64_tr_b16 v[202:203], v26 offset:34816
    v_mul_f32 v35, v35, v16
    v_mfma_f32_16x16x32_bf16 v[76:79], v[212:215], a[204:207], v[76:79]
    v_exp_f32 v17, -v36
    v_mfma_f32_16x16x32_bf16 v[76:79], v[216:219], a[220:223], v[76:79]
    ds_read_b64_tr_b16 v[204:205], v25 offset:36864
    v_add_f32 v17, 1.0, v17
    v_mfma_f32_16x16x32_bf16 v[76:79], v[220:223], a[236:239], v[76:79]
    v_rcp_f32 v17, v17
    v_mfma_f32_16x16x32_bf16 v[72:75], v[212:215], a[200:203], v[72:75]
    ds_read_b64_tr_b16 v[206:207], v25 offset:43008
    v_mul_f32 v36, v36, v17
    v_mfma_f32_16x16x32_bf16 v[72:75], v[216:219], a[216:219], v[72:75]
    v_exp_f32 v18, -v37
    v_mfma_f32_16x16x32_bf16 v[72:75], v[220:223], a[232:235], v[72:75]
    ds_read_b64_tr_b16 v[208:209], v25 offset:38912
    v_add_f32 v18, 1.0, v18
    v_mfma_f32_16x16x32_bf16 v[68:71], v[212:215], a[196:199], v[68:71]
    v_rcp_f32 v18, v18
    v_mfma_f32_16x16x32_bf16 v[68:71], v[216:219], a[212:215], v[68:71]
    ds_read_b64_tr_b16 v[210:211], v25 offset:45056
    v_mul_f32 v37, v37, v18
    v_mfma_f32_16x16x32_bf16 v[68:71], v[220:223], a[228:231], v[68:71]
    v_exp_f32 v16, -v38
    v_mfma_f32_16x16x32_bf16 v[64:67], v[212:215], a[192:195], v[64:67]
    ds_read_b64_tr_b16 v[212:213], v25 offset:40960
    v_add_f32 v16, 1.0, v16
    v_mfma_f32_16x16x32_bf16 v[64:67], v[216:219], a[208:211], v[64:67]
    v_rcp_f32 v16, v16
    v_mfma_f32_16x16x32_bf16 v[64:67], v[220:223], a[224:227], v[64:67]
    s_waitcnt lgkmcnt(5)
    ds_read_b64_tr_b16 v[214:215], v25 offset:47104
    v_mul_f32 v38, v38, v16
    v_mfma_f32_16x16x32_bf16 v[64:67], v[192:195], a[240:243], v[64:67]
    v_exp_f32 v17, -v39
    v_mfma_f32_16x16x32_bf16 v[64:67], v[196:199], v[224:227], v[64:67]
    ds_read_b64_tr_b16 v[216:217], v26 offset:12288
    v_add_f32 v17, 1.0, v17
    v_mfma_f32_16x16x32_bf16 v[64:67], v[200:203], v[240:243], v[64:67]
    v_rcp_f32 v17, v17
    v_mfma_f32_16x16x32_bf16 v[68:71], v[192:195], a[244:247], v[68:71]
    ds_read_b64_tr_b16 v[218:219], v26 offset:18432
    v_mul_f32 v39, v39, v17
    v_mfma_f32_16x16x32_bf16 v[68:71], v[196:199], v[228:231], v[68:71]
    v_exp_f32 v18, -v40
    v_mfma_f32_16x16x32_bf16 v[68:71], v[200:203], v[244:247], v[68:71]
    ds_read_b64_tr_b16 v[220:221], v26 offset:14336
    v_add_f32 v18, 1.0, v18
    v_mfma_f32_16x16x32_bf16 v[72:75], v[192:195], a[248:251], v[72:75]
    v_rcp_f32 v18, v18
    v_mfma_f32_16x16x32_bf16 v[72:75], v[196:199], v[232:235], v[72:75]
    ds_read_b64_tr_b16 v[222:223], v26 offset:20480
    v_mul_f32 v40, v40, v18
    v_mfma_f32_16x16x32_bf16 v[72:75], v[200:203], v[248:251], v[72:75]
    v_exp_f32 v16, -v41
    v_mfma_f32_16x16x32_bf16 v[76:79], v[192:195], a[252:255], v[76:79]
    ds_read_b64_tr_b16 v[192:193], v26 offset:16384
    v_add_f32 v16, 1.0, v16
    v_mfma_f32_16x16x32_bf16 v[76:79], v[196:199], v[236:239], v[76:79]
    v_rcp_f32 v16, v16
    v_mfma_f32_16x16x32_bf16 v[76:79], v[200:203], v[252:255], v[76:79]
    s_waitcnt lgkmcnt(5)
    ds_read_b64_tr_b16 v[194:195], v26 offset:22528
    v_mul_f32 v41, v41, v16
    v_mfma_f32_16x16x32_bf16 v[80:83], v[204:207], a[144:147], v[80:83]
    v_exp_f32 v17, -v42
    v_mfma_f32_16x16x32_bf16 v[80:83], v[208:211], a[160:163], v[80:83]
    ds_read_b64_tr_b16 v[196:197], v26 offset:36864
    v_add_f32 v17, 1.0, v17
    v_mfma_f32_16x16x32_bf16 v[80:83], v[212:215], a[176:179], v[80:83]
    v_rcp_f32 v17, v17
    v_mfma_f32_16x16x32_bf16 v[84:87], v[204:207], a[148:151], v[84:87]
    ds_read_b64_tr_b16 v[198:199], v26 offset:43008
    v_mul_f32 v42, v42, v17
    v_mfma_f32_16x16x32_bf16 v[84:87], v[208:211], a[164:167], v[84:87]
    v_exp_f32 v18, -v43
    v_mfma_f32_16x16x32_bf16 v[84:87], v[212:215], a[180:183], v[84:87]
    ds_read_b64_tr_b16 v[200:201], v26 offset:38912
    v_add_f32 v18, 1.0, v18
    v_mfma_f32_16x16x32_bf16 v[88:91], v[204:207], a[152:155], v[88:91]
    v_rcp_f32 v18, v18
    v_mfma_f32_16x16x32_bf16 v[88:91], v[208:211], a[168:171], v[88:91]
    ds_read_b64_tr_b16 v[202:203], v26 offset:45056
    v_mul_f32 v43, v43, v18
    v_mfma_f32_16x16x32_bf16 v[88:91], v[212:215], a[184:187], v[88:91]
    v_exp_f32 v16, -v44
    v_mfma_f32_16x16x32_bf16 v[92:95], v[204:207], a[156:159], v[92:95]
    ds_read_b64_tr_b16 v[204:205], v26 offset:40960
    v_add_f32 v16, 1.0, v16
    v_mfma_f32_16x16x32_bf16 v[92:95], v[208:211], a[172:175], v[92:95]
    v_rcp_f32 v16, v16
    v_mfma_f32_16x16x32_bf16 v[92:95], v[212:215], a[188:191], v[92:95]
    s_waitcnt lgkmcnt(5)
    ds_read_b64_tr_b16 v[206:207], v26 offset:47104
    v_xor_b32 v27, 49216, v12
    v_mfma_f32_16x16x32_bf16 v[92:95], v[216:219], a[204:207], v[92:95]
    v_exp_f32 v17, -v45
    v_mfma_f32_16x16x32_bf16 v[92:95], v[220:223], a[220:223], v[92:95]
    ds_read_b64_tr_b16 v[208:209], v27 offset:24576
    v_mul_f32 v44, v44, v16
    v_mfma_f32_16x16x32_bf16 v[92:95], v[192:195], a[236:239], v[92:95]
    v_exp_f32 v18, -v46
    v_mfma_f32_16x16x32_bf16 v[88:91], v[216:219], a[200:203], v[88:91]
    ds_read_b64_tr_b16 v[210:211], v27 offset:30720
    v_add_f32 v17, 1.0, v17
    v_mfma_f32_16x16x32_bf16 v[88:91], v[220:223], a[216:219], v[88:91]
    v_rcp_f32 v17, v17
    v_mfma_f32_16x16x32_bf16 v[88:91], v[192:195], a[232:235], v[88:91]
    ds_read_b64_tr_b16 v[212:213], v27 offset:26624
    v_mul_f32 v45, v45, v17
    v_mfma_f32_16x16x32_bf16 v[84:87], v[216:219], a[196:199], v[84:87]
    v_exp_f32 v16, -v47
    v_mfma_f32_16x16x32_bf16 v[84:87], v[220:223], a[212:215], v[84:87]
    ds_read_b64_tr_b16 v[214:215], v27 offset:32768
    v_add_f32 v18, 1.0, v18
    v_mfma_f32_16x16x32_bf16 v[84:87], v[192:195], a[228:231], v[84:87]
    v_rcp_f32 v18, v18
    v_mfma_f32_16x16x32_bf16 v[80:83], v[216:219], a[192:195], v[80:83]
    ds_read_b64_tr_b16 v[216:217], v27 offset:28672
    v_mul_f32 v46, v46, v18
    v_mfma_f32_16x16x32_bf16 v[80:83], v[220:223], a[208:211], v[80:83]
    v_add_f32 v16, 1.0, v16
    v_mul_f32 v48, v48, v32
    v_mfma_f32_16x16x32_bf16 v[80:83], v[192:195], a[224:227], v[80:83]
    s_waitcnt lgkmcnt(5)
    ds_read_b64_tr_b16 v[218:219], v27 offset:34816
    v_xor_b32 v29, 98368, v12
    v_mfma_f32_16x16x32_bf16 v[80:83], v[196:199], a[240:243], v[80:83]
    v_rcp_f32 v16, v16
    v_mfma_f32_16x16x32_bf16 v[80:83], v[200:203], v[224:227], v[80:83]
    ds_read_b64_tr_b16 v[220:221], v29 offset:0
    v_mul_f32 v47, v47, v16
    v_mfma_f32_16x16x32_bf16 v[80:83], v[204:207], v[240:243], v[80:83]
    v_exp_f32 v16, -v64
    v_mfma_f32_16x16x32_bf16 v[84:87], v[196:199], a[244:247], v[84:87]
    ds_read_b64_tr_b16 v[222:223], v29 offset:6144
    v_mul_f32 v49, v49, v33
    v_mfma_f32_16x16x32_bf16 v[84:87], v[200:203], v[228:231], v[84:87]
    v_exp_f32 v17, -v65
    v_mfma_f32_16x16x32_bf16 v[84:87], v[204:207], v[244:247], v[84:87]
    ds_read_b64_tr_b16 v[192:193], v29 offset:2048
    v_mul_f32 v50, v50, v34
    v_mfma_f32_16x16x32_bf16 v[88:91], v[196:199], a[248:251], v[88:91]
    v_exp_f32 v18, -v66
    v_mfma_f32_16x16x32_bf16 v[88:91], v[200:203], v[232:235], v[88:91]
    ds_read_b64_tr_b16 v[194:195], v29 offset:8192
    v_mul_f32 v51, v51, v35
    v_mfma_f32_16x16x32_bf16 v[88:91], v[204:207], v[248:251], v[88:91]
    v_mul_f32 v52, v52, v36
    v_mul_f32 v53, v53, v37
    v_mfma_f32_16x16x32_bf16 v[92:95], v[196:199], a[252:255], v[92:95]
    ds_read_b64_tr_b16 v[196:197], v29 offset:4096
    v_mul_f32 v54, v54, v38
    v_mfma_f32_16x16x32_bf16 v[92:95], v[200:203], v[236:239], v[92:95]
    s_add_u32 s52, s41, 0
    v_mul_f32 v55, v55, v39
    v_cvt_pk_bf16_f32 v32, v48, v49
    v_mfma_f32_16x16x32_bf16 v[92:95], v[204:207], v[252:255], v[92:95]
    s_waitcnt lgkmcnt(5)
    ds_read_b64_tr_b16 v[198:199], v29 offset:10240
    v_cvt_pk_bf16_f32 v33, v50, v51
    v_mfma_f32_16x16x32_bf16 v[96:99], v[208:211], a[144:147], v[96:99]
    v_cvt_pk_bf16_f32 v34, v52, v53
    v_cvt_pk_bf16_f32 v35, v54, v55
    v_mfma_f32_16x16x32_bf16 v[96:99], v[212:215], a[160:163], v[96:99]
    ds_read_b64_tr_b16 v[200:201], v29 offset:24576
    v_mul_f32 v56, v56, v40
    v_mfma_f32_16x16x32_bf16 v[96:99], v[216:219], a[176:179], v[96:99]
    v_permlane16_swap_b32 v32, v34
    v_mfma_f32_16x16x32_bf16 v[100:103], v[208:211], a[148:151], v[100:103]
    ds_read_b64_tr_b16 v[202:203], v29 offset:30720
    v_mul_f32 v57, v57, v41
    v_mfma_f32_16x16x32_bf16 v[100:103], v[212:215], a[164:167], v[100:103]
    v_permlane16_swap_b32 v33, v35
    v_mfma_f32_16x16x32_bf16 v[100:103], v[216:219], a[180:183], v[100:103]
    ds_read_b64_tr_b16 v[204:205], v29 offset:26624
    v_mul_f32 v58, v58, v42
    v_mfma_f32_16x16x32_bf16 v[104:107], v[208:211], a[152:155], v[104:107]
    v_mul_f32 v59, v59, v43
    v_mul_f32 v60, v60, v44
    v_mfma_f32_16x16x32_bf16 v[104:107], v[212:215], a[168:171], v[104:107]
    ds_read_b64_tr_b16 v[206:207], v29 offset:32768
    v_mul_f32 v61, v61, v45
    v_mfma_f32_16x16x32_bf16 v[104:107], v[216:219], a[184:187], v[104:107]
    v_mul_f32 v62, v62, v46
    v_mul_f32 v63, v63, v47
    v_mfma_f32_16x16x32_bf16 v[108:111], v[208:211], a[156:159], v[108:111]
    s_add_u32 s100, s41, 0
    ds_read_b64_tr_b16 v[208:209], v29 offset:28672
    v_cvt_pk_bf16_f32 v40, v56, v57
    v_mfma_f32_16x16x32_bf16 v[108:111], v[212:215], a[172:175], v[108:111]
    v_cvt_pk_bf16_f32 v41, v58, v59
    v_cvt_pk_bf16_f32 v42, v60, v61
    v_mfma_f32_16x16x32_bf16 v[108:111], v[216:219], a[188:191], v[108:111]
    s_waitcnt lgkmcnt(5)
    ds_read_b64_tr_b16 v[210:211], v29 offset:34816
    v_cvt_pk_bf16_f32 v43, v62, v63
    v_mfma_f32_16x16x32_bf16 v[108:111], v[220:223], a[204:207], v[108:111]
    v_permlane16_swap_b32 v40, v42
    v_mfma_f32_16x16x32_bf16 v[108:111], v[192:195], a[220:223], v[108:111]
    ds_read_b64_tr_b16 v[212:213], v27 offset:36864
    v_add_f32 v16, 1.0, v16
    v_mfma_f32_16x16x32_bf16 v[108:111], v[196:199], a[236:239], v[108:111]
    v_permlane16_swap_b32 v41, v43
    v_mfma_f32_16x16x32_bf16 v[104:107], v[220:223], a[200:203], v[104:107]
    ds_read_b64_tr_b16 v[214:215], v27 offset:43008
    v_add_f32 v17, 1.0, v17
    v_mfma_f32_16x16x32_bf16 v[104:107], v[192:195], a[216:219], v[104:107]
    v_rcp_f32 v16, v16
    v_mfma_f32_16x16x32_bf16 v[104:107], v[196:199], a[232:235], v[104:107]
    ds_read_b64_tr_b16 v[216:217], v27 offset:38912
    v_mul_f32 v64, v64, v16
    v_mfma_f32_16x16x32_bf16 v[100:103], v[220:223], a[196:199], v[100:103]
    v_rcp_f32 v17, v17
    v_mfma_f32_16x16x32_bf16 v[100:103], v[192:195], a[212:215], v[100:103]
    ds_read_b64_tr_b16 v[218:219], v27 offset:45056
    v_mul_f32 v65, v65, v17
    v_mfma_f32_16x16x32_bf16 v[100:103], v[196:199], a[228:231], v[100:103]
    v_exp_f32 v16, -v67
    v_mfma_f32_16x16x32_bf16 v[96:99], v[220:223], a[192:195], v[96:99]
    ds_read_b64_tr_b16 v[220:221], v27 offset:40960
    v_add_f32 v18, 1.0, v18
    v_mfma_f32_16x16x32_bf16 v[96:99], v[192:195], a[208:211], v[96:99]
    v_rcp_f32 v18, v18
    v_mfma_f32_16x16x32_bf16 v[96:99], v[196:199], a[224:227], v[96:99]
    s_waitcnt lgkmcnt(5)
    ds_read_b64_tr_b16 v[222:223], v27 offset:47104
    v_mul_f32 v66, v66, v18
    v_mfma_f32_16x16x32_bf16 v[96:99], v[200:203], a[240:243], v[96:99]
    s_add_u32 s32, s4, 0x80000
    s_addc_u32 s33, s5, 0
    v_add_f32 v16, 1.0, v16
    v_mfma_f32_16x16x32_bf16 v[96:99], v[204:207], v[224:227], v[96:99]
    s_add_u32 s49, s99, 0
    ds_read_b64_tr_b16 v[192:193], v29 offset:12288
    v_mul_f32 v80, v80, v64
    v_mfma_f32_16x16x32_bf16 v[96:99], v[208:211], v[240:243], v[96:99]
    v_rcp_f32 v16, v16
    v_mfma_f32_16x16x32_bf16 v[100:103], v[200:203], a[244:247], v[100:103]
    s_add_u32 m0, s31, 36864
    ds_read_b64_tr_b16 v[194:195], v29 offset:18432
    v_mul_f32 v67, v67, v16
    v_mfma_f32_16x16x32_bf16 v[100:103], v[204:207], v[228:231], v[100:103]
    buffer_load_dwordx4 v20, s[32:35], s49 offen offset:0 sc1 lds
    v_mfma_f32_16x16x32_bf16 v[100:103], v[208:211], v[244:247], v[100:103]
    ds_read_b64_tr_b16 v[196:197], v29 offset:14336
    v_mul_f32 v81, v81, v65
    v_mfma_f32_16x16x32_bf16 v[104:107], v[200:203], a[248:251], v[104:107]
    buffer_store_dwordx4 v[32:35], v10, s[36:39], s52 offen sc1
    v_mul_f32 v82, v82, v66
    v_mfma_f32_16x16x32_bf16 v[104:107], v[204:207], v[232:235], v[104:107]
    ds_read_b64_tr_b16 v[198:199], v29 offset:20480
    v_mul_f32 v83, v83, v67
    v_mfma_f32_16x16x32_bf16 v[104:107], v[208:211], v[248:251], v[104:107]
    buffer_load_dwordx4 v20, s[32:35], s49 offen offset:1024 sc1 lds
    v_mfma_f32_16x16x32_bf16 v[108:111], v[200:203], a[252:255], v[108:111]
    ds_read_b64_tr_b16 v[200:201], v29 offset:16384
    v_cvt_pk_bf16_f32 v64, v80, v81
    v_mfma_f32_16x16x32_bf16 v[108:111], v[204:207], v[236:239], v[108:111]
    v_exp_f32 v17, -v68
    v_mfma_f32_16x16x32_bf16 v[108:111], v[208:211], v[252:255], v[108:111]
    s_waitcnt lgkmcnt(5)
    ds_read_b64_tr_b16 v[202:203], v29 offset:22528
    v_add_f32 v17, 1.0, v17
    v_mfma_f32_16x16x32_bf16 v[112:115], v[212:215], a[144:147], v[112:115]
    v_rcp_f32 v17, v17
    v_mfma_f32_16x16x32_bf16 v[112:115], v[216:219], a[160:163], v[112:115]
    ds_read_b64_tr_b16 v[204:205], v29 offset:36864
    v_mul_f32 v68, v68, v17
Lhop5:
    s_cbranch_execz Lhop9
    v_mfma_f32_16x16x32_bf16 v[112:115], v[220:223], a[176:179], v[112:115]
    buffer_load_dwordx4 v20, s[32:35], s49 offen offset:2048 sc1 lds
    v_mfma_f32_16x16x32_bf16 v[116:119], v[212:215], a[148:151], v[116:119]
    ds_read_b64_tr_b16 v[206:207], v29 offset:43008
    v_mul_f32 v84, v84, v68
    v_mfma_f32_16x16x32_bf16 v[116:119], v[216:219], a[164:167], v[116:119]
    v_exp_f32 v18, -v69
    v_mfma_f32_16x16x32_bf16 v[116:119], v[220:223], a[180:183], v[116:119]
    ds_read_b64_tr_b16 v[208:209], v29 offset:38912
    v_add_f32 v18, 1.0, v18
    v_mfma_f32_16x16x32_bf16 v[120:123], v[212:215], a[152:155], v[120:123]
    v_rcp_f32 v18, v18
    v_mfma_f32_16x16x32_bf16 v[120:123], v[216:219], a[168:171], v[120:123]
    ds_read_b64_tr_b16 v[210:211], v29 offset:45056
    v_mul_f32 v69, v69, v18
    v_mfma_f32_16x16x32_bf16 v[120:123], v[220:223], a[184:187], v[120:123]
    buffer_load_dwordx4 v20, s[32:35], s49 offen offset:3072 sc1 lds
    v_mfma_f32_16x16x32_bf16 v[124:127], v[212:215], a[156:159], v[124:127]
    s_add_u32 s49, s99, 4096
    s_add_u32 m0, s31, 40960
    ds_read_b64_tr_b16 v[212:213], v29 offset:40960
    v_mfma_f32_16x16x32_bf16 v[124:127], v[216:219], a[172:175], v[124:127]
    buffer_store_dwordx4 v[40:43], v11, s[36:39], s100 offen sc1
    v_mul_f32 v85, v85, v69
    v_mfma_f32_16x16x32_bf16 v[124:127], v[220:223], a[188:191], v[124:127]
    s_waitcnt lgkmcnt(5)
    ds_read_b64_tr_b16 v[214:215], v29 offset:47104
    v_xor_b32 v28, 49248, v12
    v_mfma_f32_16x16x32_bf16 v[124:127], v[192:195], a[204:207], v[124:127]
    s_add_u32 s52, s41, 4096
    v_exp_f32 v16, -v70
    v_mfma_f32_16x16x32_bf16 v[124:127], v[196:199], a[220:223], v[124:127]
    ds_read_b64_tr_b16 v[216:217], v28 offset:24576
    v_add_f32 v16, 1.0, v16
    v_mfma_f32_16x16x32_bf16 v[124:127], v[200:203], a[236:239], v[124:127]
    buffer_load_dwordx4 v20, s[32:35], s49 offen offset:0 sc1 lds
    v_mfma_f32_16x16x32_bf16 v[120:123], v[192:195], a[200:203], v[120:123]
    ds_read_b64_tr_b16 v[218:219], v28 offset:30720
    v_cvt_pk_bf16_f32 v65, v82, v83
    v_mfma_f32_16x16x32_bf16 v[120:123], v[196:199], a[216:219], v[120:123]
    v_rcp_f32 v16, v16
    v_mfma_f32_16x16x32_bf16 v[120:123], v[200:203], a[232:235], v[120:123]
    ds_read_b64_tr_b16 v[220:221], v28 offset:26624
    v_mul_f32 v70, v70, v16
    v_mfma_f32_16x16x32_bf16 v[116:119], v[192:195], a[196:199], v[116:119]
    v_exp_f32 v17, -v71
    v_mfma_f32_16x16x32_bf16 v[116:119], v[196:199], a[212:215], v[116:119]
    ds_read_b64_tr_b16 v[222:223], v28 offset:32768
    v_add_f32 v17, 1.0, v17
    v_mfma_f32_16x16x32_bf16 v[116:119], v[200:203], a[228:231], v[116:119]
    buffer_load_dwordx4 v20, s[32:35], s49 offen offset:1024 sc1 lds
    v_mfma_f32_16x16x32_bf16 v[112:115], v[192:195], a[192:195], v[112:115]
    ds_read_b64_tr_b16 v[192:193], v28 offset:28672
    v_mul_f32 v86, v86, v70
    v_mfma_f32_16x16x32_bf16 v[112:115], v[196:199], a[208:211], v[112:115]
    v_rcp_f32 v17, v17
    v_mfma_f32_16x16x32_bf16 v[112:115], v[200:203], a[224:227], v[112:115]
    s_waitcnt lgkmcnt(5)
    ds_read_b64_tr_b16 v[194:195], v28 offset:34816
    v_xor_b32 v25, 98400, v12
    v_mfma_f32_16x16x32_bf16 v[112:115], v[204:207], a[240:243], v[112:115]
    v_exp_f32 v18, -v72
    v_mfma_f32_16x16x32_bf16 v[112:115], v[208:211], v[224:227], v[112:115]
    ds_read_b64_tr_b16 v[196:197], v25 offset:0
    v_mul_f32 v71, v71, v17
    v_mfma_f32_16x16x32_bf16 v[112:115], v[212:215], v[240:243], v[112:115]
    buffer_load_dwordx4 v20, s[32:35], s49 offen offset:2048 sc1 lds
    v_mfma_f32_16x16x32_bf16 v[116:119], v[204:207], a[244:247], v[116:119]
    ds_read_b64_tr_b16 v[198:199], v25 offset:6144
    v_add_f32 v18, 1.0, v18
    v_mfma_f32_16x16x32_bf16 v[116:119], v[208:211], v[228:231], v[116:119]
    v_rcp_f32 v18, v18
    v_mfma_f32_16x16x32_bf16 v[116:119], v[212:215], v[244:247], v[116:119]
    ds_read_b64_tr_b16 v[200:201], v25 offset:2048
    v_mul_f32 v72, v72, v18
    v_mfma_f32_16x16x32_bf16 v[120:123], v[204:207], a[248:251], v[120:123]
    v_exp_f32 v16, -v73
    v_mfma_f32_16x16x32_bf16 v[120:123], v[208:211], v[232:235], v[120:123]
    ds_read_b64_tr_b16 v[202:203], v25 offset:8192
    v_add_f32 v16, 1.0, v16
    v_mfma_f32_16x16x32_bf16 v[120:123], v[212:215], v[248:251], v[120:123]
    buffer_load_dwordx4 v20, s[32:35], s49 offen offset:3072 sc1 lds
    v_mfma_f32_16x16x32_bf16 v[124:127], v[204:207], a[252:255], v[124:127]
    s_add_u32 s49, s99, 8192
    s_add_u32 m0, s31, 45056
    ds_read_b64_tr_b16 v[204:205], v25 offset:4096
    v_mfma_f32_16x16x32_bf16 v[124:127], v[208:211], v[236:239], v[124:127]
    v_rcp_f32 v16, v16
    v_mfma_f32_16x16x32_bf16 v[124:127], v[212:215], v[252:255], v[124:127]
    s_waitcnt lgkmcnt(5)
    ds_read_b64_tr_b16 v[206:207], v25 offset:10240
    v_mul_f32 v73, v73, v16
    v_mfma_f32_16x16x32_bf16 v[128:131], v[216:219], a[144:147], v[128:131]
    v_exp_f32 v17, -v74
    v_mfma_f32_16x16x32_bf16 v[128:131], v[220:223], a[160:163], v[128:131]
    ds_read_b64_tr_b16 v[208:209], v25 offset:24576
    v_add_f32 v17, 1.0, v17
    v_mfma_f32_16x16x32_bf16 v[128:131], v[192:195], a[176:179], v[128:131]
    buffer_load_dwordx4 v20, s[32:35], s49 offen offset:0 sc1 lds
    v_mfma_f32_16x16x32_bf16 v[132:135], v[216:219], a[148:151], v[132:135]
    ds_read_b64_tr_b16 v[210:211], v25 offset:30720
    v_mul_f32 v87, v87, v71
    v_mfma_f32_16x16x32_bf16 v[132:135], v[220:223], a[164:167], v[132:135]
    v_rcp_f32 v17, v17
    v_mfma_f32_16x16x32_bf16 v[132:135], v[192:195], a[180:183], v[132:135]
    ds_read_b64_tr_b16 v[212:213], v25 offset:26624
    v_mul_f32 v74, v74, v17
    v_mfma_f32_16x16x32_bf16 v[136:139], v[216:219], a[152:155], v[136:139]
    v_exp_f32 v18, -v75
    v_mfma_f32_16x16x32_bf16 v[136:139], v[220:223], a[168:171], v[136:139]
    s_mul_i32 s49, s81, 3
    ds_read_b64_tr_b16 v[214:215], v25 offset:32768
    v_add_f32 v18, 1.0, v18
    v_mfma_f32_16x16x32_bf16 v[136:139], v[192:195], a[184:187], v[136:139]
    v_rcp_f32 v18, v18
    v_mfma_f32_16x16x32_bf16 v[140:143], v[216:219], a[156:159], v[140:143]
    s_add_u32 s49, s49, s98
    s_add_u32 s49, s49, 512
    ds_read_b64_tr_b16 v[216:217], v25 offset:28672
    v_mfma_f32_16x16x32_bf16 v[140:143], v[220:223], a[172:175], v[140:143]
    s_add_u32 m0, s11, 0
    v_exp_f32 v16, -v76
    v_mfma_f32_16x16x32_bf16 v[140:143], v[192:195], a[188:191], v[140:143]
    s_waitcnt lgkmcnt(5)
    ds_read_b64_tr_b16 v[218:219], v25 offset:34816
    v_mul_f32 v75, v75, v18
    v_mfma_f32_16x16x32_bf16 v[140:143], v[196:199], a[204:207], v[140:143]
    buffer_load_dwordx4 v5, s[16:19], s49 offen offset:0 lds
    v_mfma_f32_16x16x32_bf16 v[140:143], v[200:203], a[220:223], v[140:143]
    ds_read_b64_tr_b16 v[220:221], v28 offset:36864
    v_add_f32 v16, 1.0, v16
    v_mfma_f32_16x16x32_bf16 v[140:143], v[204:207], a[236:239], v[140:143]
    v_rcp_f32 v16, v16
    v_mfma_f32_16x16x32_bf16 v[136:139], v[196:199], a[200:203], v[136:139]
    ds_read_b64_tr_b16 v[222:223], v28 offset:43008
    v_mul_f32 v76, v76, v16
    v_mfma_f32_16x16x32_bf16 v[136:139], v[200:203], a[216:219], v[136:139]
    v_exp_f32 v17, -v77
    v_mfma_f32_16x16x32_bf16 v[136:139], v[204:207], a[232:235], v[136:139]
    ds_read_b64_tr_b16 v[192:193], v28 offset:38912
    v_add_f32 v17, 1.0, v17
    v_mfma_f32_16x16x32_bf16 v[132:135], v[196:199], a[196:199], v[132:135]
    buffer_load_dwordx4 v6, s[16:19], s49 offen offset:1024 lds
    v_mfma_f32_16x16x32_bf16 v[132:135], v[200:203], a[212:215], v[132:135]
    ds_read_b64_tr_b16 v[194:195], v28 offset:45056
    v_cvt_pk_bf16_f32 v66, v84, v85
    v_mfma_f32_16x16x32_bf16 v[132:135], v[204:207], a[228:231], v[132:135]
    v_rcp_f32 v17, v17
    v_mfma_f32_16x16x32_bf16 v[128:131], v[196:199], a[192:195], v[128:131]
    ds_read_b64_tr_b16 v[196:197], v28 offset:40960
    v_mul_f32 v77, v77, v17
    v_mfma_f32_16x16x32_bf16 v[128:131], v[200:203], a[208:211], v[128:131]
    v_exp_f32 v18, -v78
    v_mfma_f32_16x16x32_bf16 v[128:131], v[204:207], a[224:227], v[128:131]
    s_waitcnt lgkmcnt(5)
    ds_read_b64_tr_b16 v[198:199], v28 offset:47104
    v_add_f32 v18, 1.0, v18
    v_mfma_f32_16x16x32_bf16 v[128:131], v[208:211], a[240:243], v[128:131]
    buffer_load_dwordx4 v7, s[16:19], s49 offen offset:2048 lds
    v_mfma_f32_16x16x32_bf16 v[128:131], v[212:215], v[224:227], v[128:131]
    ds_read_b64_tr_b16 v[200:201], v25 offset:12288
    v_cvt_pk_bf16_f32 v67, v86, v87
    v_mfma_f32_16x16x32_bf16 v[128:131], v[216:219], v[240:243], v[128:131]
    v_rcp_f32 v18, v18
    v_mfma_f32_16x16x32_bf16 v[132:135], v[208:211], a[244:247], v[132:135]
    ds_read_b64_tr_b16 v[202:203], v25 offset:18432
    v_mul_f32 v78, v78, v18
    v_mfma_f32_16x16x32_bf16 v[132:135], v[212:215], v[228:231], v[132:135]
    v_exp_f32 v16, -v79
    v_mfma_f32_16x16x32_bf16 v[132:135], v[216:219], v[244:247], v[132:135]
    ds_read_b64_tr_b16 v[204:205], v25 offset:14336
    v_add_f32 v16, 1.0, v16
    v_mfma_f32_16x16x32_bf16 v[136:139], v[208:211], a[248:251], v[136:139]
    v_rcp_f32 v16, v16
    v_mfma_f32_16x16x32_bf16 v[136:139], v[212:215], v[232:235], v[136:139]
    ds_read_b64_tr_b16 v[206:207], v25 offset:20480
    v_mul_f32 v79, v79, v16
    v_mfma_f32_16x16x32_bf16 v[136:139], v[216:219], v[248:251], v[136:139]
    buffer_load_dwordx4 v8, s[16:19], s49 offen offset:3072 lds
    v_mfma_f32_16x16x32_bf16 v[140:143], v[208:211], a[252:255], v[140:143]
    s_add_u32 s49, s49, s82
    s_add_u32 m0, s11, 4096
    ds_read_b64_tr_b16 v[208:209], v25 offset:16384
    v_mfma_f32_16x16x32_bf16 v[140:143], v[212:215], v[236:239], v[140:143]
    v_permlane16_swap_b32 v64, v66
    v_mfma_f32_16x16x32_bf16 v[140:143], v[216:219], v[252:255], v[140:143]
    s_waitcnt lgkmcnt(5)
    ds_read_b64_tr_b16 v[210:211], v25 offset:22528
    v_mul_f32 v88, v88, v72
    v_mfma_f32_16x16x32_bf16 v[144:147], v[220:223], a[144:147], v[144:147]
    v_permlane16_swap_b32 v65, v67
    v_mfma_f32_16x16x32_bf16 v[144:147], v[192:195], a[160:163], v[144:147]
    ds_read_b64_tr_b16 v[212:213], v25 offset:36864
    v_mul_f32 v89, v89, v73
    v_mfma_f32_16x16x32_bf16 v[144:147], v[196:199], a[176:179], v[144:147]
    buffer_load_dwordx4 v5, s[16:19], s49 offen offset:0 lds
    v_mfma_f32_16x16x32_bf16 v[148:151], v[220:223], a[148:151], v[148:151]
    ds_read_b64_tr_b16 v[214:215], v25 offset:43008
    v_mul_f32 v90, v90, v74
    v_mfma_f32_16x16x32_bf16 v[148:151], v[192:195], a[164:167], v[148:151]
    buffer_store_dwordx4 v[64:67], v10, s[36:39], s52 offen sc1
    v_mul_f32 v91, v91, v75
    v_mfma_f32_16x16x32_bf16 v[148:151], v[196:199], a[180:183], v[148:151]
    ds_read_b64_tr_b16 v[216:217], v25 offset:38912
    v_mul_f32 v92, v92, v76
    v_mfma_f32_16x16x32_bf16 v[152:155], v[220:223], a[152:155], v[152:155]
    v_exp_f32 v16, -v96
    v_mfma_f32_16x16x32_bf16 v[152:155], v[192:195], a[168:171], v[152:155]
    ds_read_b64_tr_b16 v[218:219], v25 offset:45056
    v_mul_f32 v93, v93, v77
    v_mfma_f32_16x16x32_bf16 v[152:155], v[196:199], a[184:187], v[152:155]
    v_exp_f32 v17, -v97
    v_mfma_f32_16x16x32_bf16 v[156:159], v[220:223], a[156:159], v[156:159]
    ds_read_b64_tr_b16 v[220:221], v25 offset:40960
    v_mul_f32 v94, v94, v78
    v_mfma_f32_16x16x32_bf16 v[156:159], v[192:195], a[172:175], v[156:159]
    s_waitcnt vmcnt(6)
    s_barrier
    v_mul_f32 v95, v95, v79
    v_mfma_f32_16x16x32_bf16 v[156:159], v[196:199], a[188:191], v[156:159]
    s_waitcnt lgkmcnt(5)
    ds_read_b64_tr_b16 v[222:223], v25 offset:47104
    v_cvt_pk_bf16_f32 v72, v88, v89
    v_mfma_f32_16x16x32_bf16 v[156:159], v[200:203], a[204:207], v[156:159]
    buffer_load_dwordx4 v6, s[16:19], s49 offen offset:1024 lds
    v_mfma_f32_16x16x32_bf16 v[156:159], v[204:207], a[220:223], v[156:159]
    s_add_u32 s100, s41, 4096
    ds_read_b128 v[192:195], v4 offset:36864
    v_cvt_pk_bf16_f32 v73, v90, v91
    v_mfma_f32_16x16x32_bf16 v[156:159], v[208:211], a[236:239], v[156:159]
    v_exp_f32 v18, -v98
    v_mfma_f32_16x16x32_bf16 v[152:155], v[200:203], a[200:203], v[152:155]
    s_lshl_b32 s48, s3, 12
    ds_read_b128 v[196:199], v4 offset:37888
    v_cvt_pk_bf16_f32 v74, v92, v93
    v_mfma_f32_16x16x32_bf16 v[152:155], v[204:207], a[216:219], v[152:155]
    v_cvt_pk_bf16_f32 v75, v94, v95
    v_add_f32 v16, 1.0, v16
    v_mfma_f32_16x16x32_bf16 v[152:155], v[208:211], a[232:235], v[152:155]
    s_add_u32 s49, s48, 241664
    v_permlane16_swap_b32 v72, v74
    v_mfma_f32_16x16x32_bf16 v[148:151], v[200:203], a[196:199], v[148:151]
    v_permlane16_swap_b32 v73, v75
    v_mfma_f32_16x16x32_bf16 v[148:151], v[204:207], a[212:215], v[148:151]
    s_add_u32 m0, s48, 147456
    v_rcp_f32 v16, v16
    v_mfma_f32_16x16x32_bf16 v[148:151], v[208:211], a[228:231], v[148:151]
    buffer_load_dwordx4 v4, s[20:23], s49 offen offset:0 sc1 lds
    v_mfma_f32_16x16x32_bf16 v[144:147], v[200:203], a[192:195], v[144:147]
    ds_read_b128 v[200:203], v4 offset:38912
    v_mul_f32 v96, v96, v16
    v_mfma_f32_16x16x32_bf16 v[144:147], v[204:207], a[208:211], v[144:147]
    buffer_store_dwordx4 v[72:75], v11, s[36:39], s100 offen sc1
    v_add_f32 v17, 1.0, v17
    v_mfma_f32_16x16x32_bf16 v[144:147], v[208:211], a[224:227], v[144:147]
    s_waitcnt lgkmcnt(3)
    ds_read_b128 v[204:207], v4 offset:39936
    v_add_f32 v18, 1.0, v18
    v_mfma_f32_16x16x32_bf16 v[144:147], v[212:215], a[240:243], v[144:147]
    v_rcp_f32 v17, v17
    v_mfma_f32_16x16x32_bf16 v[144:147], v[216:219], v[224:227], v[144:147]
    ds_read_b128 v[208:211], v4 offset:40960
    v_mul_f32 v97, v97, v17
    v_mfma_f32_16x16x32_bf16 v[144:147], v[220:223], v[240:243], v[144:147]
    buffer_load_dwordx4 v4, s[20:23], s49 offen offset:1024 sc1 lds
    v_mfma_f32_16x16x32_bf16 v[148:151], v[212:215], a[244:247], v[148:151]
    v_rcp_f32 v18, v18
    v_mfma_f32_16x16x32_bf16 v[148:151], v[216:219], v[228:231], v[148:151]
    v_exp_f32 v16, -v99
    v_mfma_f32_16x16x32_bf16 v[148:151], v[220:223], v[244:247], v[148:151]
    v_exp_f32 v17, -v100
    v_mfma_f32_16x16x32_bf16 v[152:155], v[212:215], a[248:251], v[152:155]
    v_mul_f32 v98, v98, v18
    v_add_f32 v16, 1.0, v16
    v_mfma_f32_16x16x32_bf16 v[152:155], v[216:219], v[232:235], v[152:155]
    v_rcp_f32 v16, v16
    v_mfma_f32_16x16x32_bf16 v[152:155], v[220:223], v[248:251], v[152:155]
    buffer_load_dwordx4 v4, s[20:23], s49 offen offset:2048 sc1 lds
    v_mfma_f32_16x16x32_bf16 v[156:159], v[212:215], a[252:255], v[156:159]
    ds_read_b128 v[212:215], v4 offset:41984
    v_mul_f32 v99, v99, v16
    v_mfma_f32_16x16x32_bf16 v[156:159], v[216:219], v[236:239], v[156:159]
    v_exp_f32 v18, -v101
    v_mfma_f32_16x16x32_bf16 v[156:159], v[220:223], v[252:255], v[156:159]
    s_waitcnt lgkmcnt(3)
    ds_read_b128 v[216:219], v4 offset:43008
    v_add_f32 v17, 1.0, v17
    v_mfma_f32_16x16x32_bf16 v[32:35], v[192:195], a[0:3], 0
    v_rcp_f32 v17, v17
    v_mfma_f32_16x16x32_bf16 v[32:35], v[196:199], a[16:19], v[32:35]
    ds_read_b128 v[220:223], v4 offset:44032
    v_mul_f32 v100, v100, v17
    v_mfma_f32_16x16x32_bf16 v[32:35], v[200:203], a[32:35], v[32:35]
    s_barrier
    v_exp_f32 v16, -v102
    v_mfma_f32_16x16x32_bf16 v[36:39], v[192:195], a[4:7], 0
    buffer_load_dwordx4 v4, s[20:23], s49 offen offset:3072 sc1 lds
    v_mfma_f32_16x16x32_bf16 v[36:39], v[196:199], a[20:23], v[36:39]
    v_exp_f32 v17, -v103
    v_mfma_f32_16x16x32_bf16 v[36:39], v[200:203], a[36:39], v[36:39]
    s_mov_b32 s49, s98
    v_add_f32 v18, 1.0, v18
    v_add_f32 v16, 1.0, v16
    v_mfma_f32_16x16x32_bf16 v[40:43], v[192:195], a[8:11], 0
    v_rcp_f32 v18, v18
    v_mfma_f32_16x16x32_bf16 v[40:43], v[196:199], a[24:27], v[40:43]
    s_add_u32 s49, s49, 512
    v_rcp_f32 v16, v16
    v_mfma_f32_16x16x32_bf16 v[40:43], v[200:203], a[40:43], v[40:43]
    v_mul_f32 v101, v101, v18
    v_mul_f32 v102, v102, v16
    v_mfma_f32_16x16x32_bf16 v[44:47], v[192:195], a[12:15], 0
    s_add_u32 m0, s11, 73728
    ds_read_b128 v[192:195], v4 offset:45056
    v_add_f32 v17, 1.0, v17
    v_mfma_f32_16x16x32_bf16 v[44:47], v[196:199], a[28:31], v[44:47]
    buffer_load_dwordx4 v9, s[16:19], s49 offen offset:0 lds
    v_mfma_f32_16x16x32_bf16 v[44:47], v[200:203], a[44:47], v[44:47]
    s_waitcnt lgkmcnt(3)
    ds_read_b128 v[196:199], v4 offset:46080
    v_mul_f32 v112, v112, v96
    v_mfma_f32_16x16x32_bf16 v[44:47], v[204:207], a[60:63], v[44:47]
    v_rcp_f32 v17, v17
    v_mfma_f32_16x16x32_bf16 v[44:47], v[208:211], a[76:79], v[44:47]
    ds_read_b128 v[200:203], v4 offset:47104
    v_mul_f32 v103, v103, v17
    v_mfma_f32_16x16x32_bf16 v[44:47], v[212:215], a[92:95], v[44:47]
    buffer_load_dwordx4 v6, s[16:19], s49 offen offset:1024 lds
    v_mfma_f32_16x16x32_bf16 v[40:43], v[204:207], a[56:59], v[40:43]
    v_exp_f32 v18, -v104
    v_mfma_f32_16x16x32_bf16 v[40:43], v[208:211], a[72:75], v[40:43]
    v_exp_f32 v16, -v105
    v_mfma_f32_16x16x32_bf16 v[40:43], v[212:215], a[88:91], v[40:43]
    v_exp_f32 v17, -v106
    v_mfma_f32_16x16x32_bf16 v[36:39], v[204:207], a[52:55], v[36:39]
    buffer_load_dwordx4 v7, s[16:19], s49 offen offset:2048 lds
    v_mfma_f32_16x16x32_bf16 v[36:39], v[208:211], a[68:71], v[36:39]
    v_add_f32 v18, 1.0, v18
    v_add_f32 v16, 1.0, v16
    v_mfma_f32_16x16x32_bf16 v[36:39], v[212:215], a[84:87], v[36:39]
    v_rcp_f32 v18, v18
    v_mfma_f32_16x16x32_bf16 v[32:35], v[204:207], a[48:51], v[32:35]
    ds_read_b128 v[204:207], v4 offset:48128
    v_mul_f32 v104, v104, v18
    v_mfma_f32_16x16x32_bf16 v[32:35], v[208:211], a[64:67], v[32:35]
    v_rcp_f32 v16, v16
    v_mfma_f32_16x16x32_bf16 v[32:35], v[212:215], a[80:83], v[32:35]
    s_waitcnt lgkmcnt(3)
    ds_read_b128 v[208:211], v4 offset:49152
    v_mul_f32 v105, v105, v16
    v_mfma_f32_16x16x32_bf16 v[32:35], v[216:219], a[96:99], v[32:35]
    buffer_load_dwordx4 v8, s[16:19], s49 offen offset:3072 lds
    v_mfma_f32_16x16x32_bf16 v[32:35], v[220:223], a[112:115], v[32:35]
    s_add_u32 s49, s49, s82
    ds_read_b128 v[212:215], v4 offset:50176
    v_add_f32 v17, 1.0, v17
    v_mfma_f32_16x16x32_bf16 v[32:35], v[192:195], a[128:131], v[32:35]
    v_rcp_f32 v17, v17
    v_mfma_f32_16x16x32_bf16 v[36:39], v[216:219], a[100:103], v[36:39]
    s_add_u32 m0, s11, 77824
    v_exp_f32 v18, -v107
    v_mfma_f32_16x16x32_bf16 v[36:39], v[220:223], a[116:119], v[36:39]
    v_exp_f32 v16, -v108
    v_mfma_f32_16x16x32_bf16 v[36:39], v[192:195], a[132:135], v[36:39]
    buffer_load_dwordx4 v5, s[16:19], s49 offen offset:0 lds
    v_mfma_f32_16x16x32_bf16 v[40:43], v[216:219], a[104:107], v[40:43]
    v_mul_f32 v106, v106, v17
    v_add_f32 v18, 1.0, v18
    v_mfma_f32_16x16x32_bf16 v[40:43], v[220:223], a[120:123], v[40:43]
    v_rcp_f32 v18, v18
    v_mfma_f32_16x16x32_bf16 v[40:43], v[192:195], a[136:139], v[40:43]
    v_exp_f32 v17, -v109
    v_mfma_f32_16x16x32_bf16 v[44:47], v[216:219], a[108:111], v[44:47]
    ds_read_b128 v[216:219], v4 offset:51200
    v_mul_f32 v107, v107, v18
    v_mfma_f32_16x16x32_bf16 v[44:47], v[220:223], a[124:127], v[44:47]
    buffer_load_dwordx4 v6, s[16:19], s49 offen offset:1024 lds
    v_mfma_f32_16x16x32_bf16 v[44:47], v[192:195], a[140:143], v[44:47]
    s_waitcnt lgkmcnt(3)
    ds_read_b128 v[220:223], v4 offset:52224
    v_add_f32 v16, 1.0, v16
    v_mfma_f32_16x16x32_bf16 v[44:47], v[196:199], a[156:159], v[44:47]
    v_rcp_f32 v16, v16
    v_mfma_f32_16x16x32_bf16 v[44:47], v[200:203], a[172:175], v[44:47]
    s_mul_i32 s49, s81, 1
    ds_read_b128 v[192:195], v4 offset:53248
    v_mul_f32 v108, v108, v16
    v_mfma_f32_16x16x32_bf16 v[44:47], v[204:207], a[188:191], v[44:47]
    v_exp_f32 v18, -v110
    v_mfma_f32_16x16x32_bf16 v[40:43], v[196:199], a[152:155], v[40:43]
    s_add_u32 s49, s49, s98
    v_exp_f32 v16, -v111
    v_mfma_f32_16x16x32_bf16 v[40:43], v[200:203], a[168:171], v[40:43]
    v_add_f32 v17, 1.0, v17
    v_add_f32 v18, 1.0, v18
    v_mfma_f32_16x16x32_bf16 v[40:43], v[204:207], a[184:187], v[40:43]
    s_add_u32 s49, s49, 512
    v_rcp_f32 v17, v17
    v_mfma_f32_16x16x32_bf16 v[36:39], v[196:199], a[148:151], v[36:39]
    v_rcp_f32 v18, v18
    v_mfma_f32_16x16x32_bf16 v[36:39], v[200:203], a[164:167], v[36:39]
    s_add_u32 m0, s11, 98304
    v_mul_f32 v109, v109, v17
    v_mul_f32 v110, v110, v18
    v_mfma_f32_16x16x32_bf16 v[36:39], v[204:207], a[180:183], v[36:39]
    buffer_load_dwordx4 v5, s[16:19], s49 offen offset:0 lds
    v_mfma_f32_16x16x32_bf16 v[32:35], v[196:199], a[144:147], v[32:35]
    ds_read_b128 v[196:199], v4 offset:54272
    v_add_f32 v16, 1.0, v16
    v_mfma_f32_16x16x32_bf16 v[32:35], v[200:203], a[160:163], v[32:35]
    v_rcp_f32 v16, v16
    v_mfma_f32_16x16x32_bf16 v[32:35], v[204:207], a[176:179], v[32:35]
    s_waitcnt lgkmcnt(3)
    ds_read_b128 v[200:203], v4 offset:55296
    v_mul_f32 v111, v111, v16
    v_mfma_f32_16x16x32_bf16 v[32:35], v[208:211], a[192:195], v[32:35]
    buffer_load_dwordx4 v6, s[16:19], s49 offen offset:1024 lds
    v_mfma_f32_16x16x32_bf16 v[32:35], v[212:215], a[208:211], v[32:35]
    ds_read_b128 v[204:207], v4 offset:56320
    v_mul_f32 v113, v113, v97
    v_mfma_f32_16x16x32_bf16 v[32:35], v[216:219], a[224:227], v[32:35]
    v_exp_f32 v16, -v128
    v_mfma_f32_16x16x32_bf16 v[36:39], v[208:211], a[196:199], v[36:39]
    v_exp_f32 v17, -v129
    v_mfma_f32_16x16x32_bf16 v[36:39], v[212:215], a[212:215], v[36:39]
    buffer_load_dwordx4 v7, s[16:19], s49 offen offset:2048 lds
    v_mfma_f32_16x16x32_bf16 v[36:39], v[216:219], a[228:231], v[36:39]
    v_exp_f32 v18, -v130
    v_mfma_f32_16x16x32_bf16 v[40:43], v[208:211], a[200:203], v[40:43]
    v_mul_f32 v114, v114, v98
    v_mul_f32 v115, v115, v99
    v_mfma_f32_16x16x32_bf16 v[40:43], v[212:215], a[216:219], v[40:43]
    v_mul_f32 v116, v116, v100
    v_mul_f32 v117, v117, v101
    v_mfma_f32_16x16x32_bf16 v[40:43], v[216:219], a[232:235], v[40:43]
    v_mul_f32 v118, v118, v102
    v_mul_f32 v119, v119, v103
    v_mfma_f32_16x16x32_bf16 v[44:47], v[208:211], a[204:207], v[44:47]
    s_add_u32 s52, s41, 8192
    ds_read_b128 v[208:211], v4 offset:57344
    v_cvt_pk_bf16_f32 v96, v112, v113
    v_mfma_f32_16x16x32_bf16 v[44:47], v[212:215], a[220:223], v[44:47]
    buffer_load_dwordx4 v8, s[16:19], s49 offen offset:3072 lds
    v_mfma_f32_16x16x32_bf16 v[44:47], v[216:219], a[236:239], v[44:47]
    s_waitcnt lgkmcnt(3)
    ds_read_b128 v[212:215], v4 offset:58368
    v_cvt_pk_bf16_f32 v97, v114, v115
    v_mfma_f32_16x16x32_bf16 v[44:47], v[220:223], a[252:255], v[44:47]
    v_cvt_pk_bf16_f32 v98, v116, v117
    v_cvt_pk_bf16_f32 v99, v118, v119
    v_mfma_f32_16x16x32_bf16 v[44:47], v[192:195], v[236:239], v[44:47]
    s_add_u32 s49, s49, s82
    ds_read_b128 v[216:219], v4 offset:59392
    v_mul_f32 v120, v120, v104
    v_mfma_f32_16x16x32_bf16 v[44:47], v[196:199], v[252:255], v[44:47]
    v_permlane16_swap_b32 v96, v98
    v_mfma_f32_16x16x32_bf16 v[40:43], v[220:223], a[248:251], v[40:43]
    s_add_u32 m0, s11, 102400
    v_permlane16_swap_b32 v97, v99
    v_mfma_f32_16x16x32_bf16 v[40:43], v[192:195], v[232:235], v[40:43]
    buffer_load_dwordx4 v5, s[16:19], s49 offen offset:0 lds
    v_mfma_f32_16x16x32_bf16 v[40:43], v[196:199], v[248:251], v[40:43]
    buffer_store_dwordx4 v[96:99], v10, s[36:39], s52 offen sc1
    v_mul_f32 v121, v121, v105
    v_mfma_f32_16x16x32_bf16 v[36:39], v[220:223], a[244:247], v[36:39]
    v_mul_f32 v122, v122, v106
    v_mul_f32 v123, v123, v107
    v_mfma_f32_16x16x32_bf16 v[36:39], v[192:195], v[228:231], v[36:39]
    v_mul_f32 v124, v124, v108
    v_mul_f32 v125, v125, v109
    v_mfma_f32_16x16x32_bf16 v[36:39], v[196:199], v[244:247], v[36:39]
    buffer_load_dwordx4 v6, s[16:19], s49 offen offset:1024 lds
    v_mfma_f32_16x16x32_bf16 v[32:35], v[220:223], a[240:243], v[32:35]
    s_mul_i32 s49, s81, 2
    s_add_u32 s49, s49, s98
    ds_read_b128 v[220:223], v4 offset:60416
    v_mfma_f32_16x16x32_bf16 v[32:35], v[192:195], v[224:227], v[32:35]
    s_add_u32 s49, s49, 512
    s_add_u32 m0, s11, 122880
    v_mul_f32 v126, v126, v110
    v_mfma_f32_16x16x32_bf16 v[32:35], v[196:199], v[240:243], v[32:35]
    s_waitcnt lgkmcnt(3)
    ds_read_b128 v[192:195], v4 offset:61440
    v_mul_f32 v127, v127, v111
    v_mfma_f32_16x16x32_bf16 v[48:51], v[200:203], a[0:3], 0
    buffer_load_dwordx4 v5, s[16:19], s49 offen offset:0 lds
    v_mfma_f32_16x16x32_bf16 v[48:51], v[204:207], a[16:19], v[48:51]
    s_add_u32 s100, s41, 8192
    ds_read_b128 v[196:199], v4 offset:62464
    v_cvt_pk_bf16_f32 v104, v120, v121
    v_mfma_f32_16x16x32_bf16 v[48:51], v[208:211], a[32:35], v[48:51]
    v_cvt_pk_bf16_f32 v105, v122, v123
    v_cvt_pk_bf16_f32 v106, v124, v125
    v_mfma_f32_16x16x32_bf16 v[52:55], v[200:203], a[4:7], 0
    buffer_load_dwordx4 v6, s[16:19], s49 offen offset:1024 lds
    v_mfma_f32_16x16x32_bf16 v[52:55], v[204:207], a[20:23], v[52:55]
    v_permlane16_swap_b32 v104, v106
    v_mfma_f32_16x16x32_bf16 v[52:55], v[208:211], a[36:39], v[52:55]
    v_cvt_pk_bf16_f32 v107, v126, v127
    v_add_f32 v16, 1.0, v16
    v_mfma_f32_16x16x32_bf16 v[56:59], v[200:203], a[8:11], 0
    v_rcp_f32 v16, v16
    v_mfma_f32_16x16x32_bf16 v[56:59], v[204:207], a[24:27], v[56:59]
    v_permlane16_swap_b32 v105, v107
    v_mfma_f32_16x16x32_bf16 v[56:59], v[208:211], a[40:43], v[56:59]
    buffer_load_dwordx4 v7, s[16:19], s49 offen offset:2048 lds
    v_mfma_f32_16x16x32_bf16 v[60:63], v[200:203], a[12:15], 0
    ds_read_b128 v[200:203], v4 offset:63488
    v_mul_f32 v128, v128, v16
    v_mfma_f32_16x16x32_bf16 v[60:63], v[204:207], a[28:31], v[60:63]
    buffer_store_dwordx4 v[104:107], v11, s[36:39], s100 offen sc1
    v_add_f32 v17, 1.0, v17
    v_mfma_f32_16x16x32_bf16 v[60:63], v[208:211], a[44:47], v[60:63]
    s_waitcnt lgkmcnt(3)
    ds_read_b128 v[204:207], v4 offset:64512
    v_add_f32 v18, 1.0, v18
    v_mfma_f32_16x16x32_bf16 v[60:63], v[212:215], a[60:63], v[60:63]
    v_rcp_f32 v17, v17
    v_mfma_f32_16x16x32_bf16 v[60:63], v[216:219], a[76:79], v[60:63]
    ds_read_b128 v[208:211], v21 offset:0
    v_mul_f32 v129, v129, v17
    v_mfma_f32_16x16x32_bf16 v[60:63], v[220:223], a[92:95], v[60:63]
    buffer_load_dwordx4 v8, s[16:19], s49 offen offset:3072 lds
    v_mfma_f32_16x16x32_bf16 v[56:59], v[212:215], a[56:59], v[56:59]
    s_add_u32 s49, s49, s82
    v_rcp_f32 v18, v18
    v_mfma_f32_16x16x32_bf16 v[56:59], v[216:219], a[72:75], v[56:59]
    v_exp_f32 v16, -v131
    v_mfma_f32_16x16x32_bf16 v[56:59], v[220:223], a[88:91], v[56:59]
    s_add_u32 m0, s11, 126976
    v_exp_f32 v17, -v132
    v_mfma_f32_16x16x32_bf16 v[52:55], v[212:215], a[52:55], v[52:55]
    v_mul_f32 v130, v130, v18
    v_add_f32 v16, 1.0, v16
    v_mfma_f32_16x16x32_bf16 v[52:55], v[216:219], a[68:71], v[52:55]
    buffer_load_dwordx4 v5, s[16:19], s49 offen offset:0 lds
    v_mfma_f32_16x16x32_bf16 v[52:55], v[220:223], a[84:87], v[52:55]
    v_rcp_f32 v16, v16
    v_mfma_f32_16x16x32_bf16 v[48:51], v[212:215], a[48:51], v[48:51]
    ds_read_b128 v[212:215], v21 offset:1024
    v_mul_f32 v131, v131, v16
    v_mfma_f32_16x16x32_bf16 v[48:51], v[216:219], a[64:67], v[48:51]
    v_exp_f32 v18, -v133
    v_mfma_f32_16x16x32_bf16 v[48:51], v[220:223], a[80:83], v[48:51]
    s_waitcnt lgkmcnt(3)
    ds_read_b128 v[216:219], v21 offset:2048
    v_add_f32 v17, 1.0, v17
    v_mfma_f32_16x16x32_bf16 v[48:51], v[192:195], a[96:99], v[48:51]
    buffer_load_dwordx4 v6, s[16:19], s49 offen offset:1024 lds
    v_mfma_f32_16x16x32_bf16 v[48:51], v[196:199], a[112:115], v[48:51]
    ds_read_b128 v[220:223], v21 offset:3072
    v_add_f32 v18, 1.0, v18
    v_mfma_f32_16x16x32_bf16 v[48:51], v[200:203], a[128:131], v[48:51]
    v_rcp_f32 v17, v17
    v_mfma_f32_16x16x32_bf16 v[52:55], v[192:195], a[100:103], v[52:55]
    v_rcp_f32 v18, v18
    v_mfma_f32_16x16x32_bf16 v[52:55], v[196:199], a[116:119], v[52:55]
    v_exp_f32 v16, -v134
    v_mfma_f32_16x16x32_bf16 v[52:55], v[200:203], a[132:135], v[52:55]
    v_mul_f32 v132, v132, v17
    v_mul_f32 v133, v133, v18
    v_mfma_f32_16x16x32_bf16 v[56:59], v[192:195], a[104:107], v[56:59]
    v_exp_f32 v17, -v135
    v_mfma_f32_16x16x32_bf16 v[56:59], v[196:199], a[120:123], v[56:59]
    v_exp_f32 v18, -v136
    v_mfma_f32_16x16x32_bf16 v[56:59], v[200:203], a[136:139], v[56:59]
    v_add_f32 v16, 1.0, v16
    v_add_f32 v17, 1.0, v17
    v_mfma_f32_16x16x32_bf16 v[60:63], v[192:195], a[108:111], v[60:63]
    ds_read_b128 v[192:195], v21 offset:4096
    v_add_f32 v18, 1.0, v18
    v_mfma_f32_16x16x32_bf16 v[60:63], v[196:199], a[124:127], v[60:63]
    v_rcp_f32 v16, v16
    v_mfma_f32_16x16x32_bf16 v[60:63], v[200:203], a[140:143], v[60:63]
    s_waitcnt lgkmcnt(3)
    ds_read_b128 v[196:199], v21 offset:5120
    v_mul_f32 v134, v134, v16
    v_mfma_f32_16x16x32_bf16 v[60:63], v[204:207], a[156:159], v[60:63]
    v_rcp_f32 v17, v17
    v_mfma_f32_16x16x32_bf16 v[60:63], v[208:211], a[172:175], v[60:63]
    ds_read_b128 v[200:203], v21 offset:6144
    v_mul_f32 v135, v135, v17
    v_mfma_f32_16x16x32_bf16 v[60:63], v[212:215], a[188:191], v[60:63]
    v_rcp_f32 v18, v18
    v_mfma_f32_16x16x32_bf16 v[56:59], v[204:207], a[152:155], v[56:59]
    v_exp_f32 v16, -v137
    v_mfma_f32_16x16x32_bf16 v[56:59], v[208:211], a[168:171], v[56:59]
    v_exp_f32 v17, -v138
    v_mfma_f32_16x16x32_bf16 v[56:59], v[212:215], a[184:187], v[56:59]
    v_mul_f32 v136, v136, v18
    v_add_f32 v16, 1.0, v16
    v_mfma_f32_16x16x32_bf16 v[52:55], v[204:207], a[148:151], v[52:55]
    v_rcp_f32 v16, v16
    v_mfma_f32_16x16x32_bf16 v[52:55], v[208:211], a[164:167], v[52:55]
    v_exp_f32 v18, -v139
    v_mfma_f32_16x16x32_bf16 v[52:55], v[212:215], a[180:183], v[52:55]
    s_waitcnt vmcnt(7)
    s_barrier
    v_mul_f32 v137, v137, v16
    v_mfma_f32_16x16x32_bf16 v[48:51], v[204:207], a[144:147], v[48:51]
    ds_read_b128 v[204:207], v21 offset:7168
    v_xor_b32 v26, 49152, v12
    v_mfma_f32_16x16x32_bf16 v[48:51], v[208:211], a[160:163], v[48:51]
Lhop6:
    s_cbranch_execz Lhop10
    v_exp_f32 v16, -v140
    v_mfma_f32_16x16x32_bf16 v[48:51], v[212:215], a[176:179], v[48:51]
    s_waitcnt lgkmcnt(3)
    ds_read_b64_tr_b16 v[208:209], v26 offset:24576
    v_add_f32 v17, 1.0, v17
    v_mfma_f32_16x16x32_bf16 v[48:51], v[216:219], a[192:195], v[48:51]
    v_rcp_f32 v17, v17
    v_mfma_f32_16x16x32_bf16 v[48:51], v[220:223], a[208:211], v[48:51]
    ds_read_b64_tr_b16 v[210:211], v26 offset:30720
    v_mul_f32 v138, v138, v17
    v_mfma_f32_16x16x32_bf16 v[48:51], v[192:195], a[224:227], v[48:51]
    v_exp_f32 v17, -v141
    v_mfma_f32_16x16x32_bf16 v[52:55], v[216:219], a[196:199], v[52:55]
    ds_read_b64_tr_b16 v[212:213], v26 offset:26624
    v_add_f32 v18, 1.0, v18
    v_mfma_f32_16x16x32_bf16 v[52:55], v[220:223], a[212:215], v[52:55]
    v_rcp_f32 v18, v18
    v_mfma_f32_16x16x32_bf16 v[52:55], v[192:195], a[228:231], v[52:55]
    ds_read_b64_tr_b16 v[214:215], v26 offset:32768
    v_mul_f32 v139, v139, v18
    v_mfma_f32_16x16x32_bf16 v[56:59], v[216:219], a[200:203], v[56:59]
    v_exp_f32 v18, -v142
    v_mfma_f32_16x16x32_bf16 v[56:59], v[220:223], a[216:219], v[56:59]
    v_add_f32 v16, 1.0, v16
    v_add_f32 v17, 1.0, v17
    v_mfma_f32_16x16x32_bf16 v[56:59], v[192:195], a[232:235], v[56:59]
    v_rcp_f32 v16, v16
    v_mfma_f32_16x16x32_bf16 v[60:63], v[216:219], a[204:207], v[60:63]
    ds_read_b64_tr_b16 v[216:217], v26 offset:28672
    v_mul_f32 v140, v140, v16
    v_mfma_f32_16x16x32_bf16 v[60:63], v[220:223], a[220:223], v[60:63]
    v_rcp_f32 v17, v17
    v_mfma_f32_16x16x32_bf16 v[60:63], v[192:195], a[236:239], v[60:63]
    s_waitcnt lgkmcnt(5)
    ds_read_b64_tr_b16 v[218:219], v26 offset:34816
    v_xor_b32 v27, 98304, v12
    v_mfma_f32_16x16x32_bf16 v[60:63], v[196:199], a[252:255], v[60:63]
    v_exp_f32 v16, -v143
    v_mfma_f32_16x16x32_bf16 v[60:63], v[200:203], v[236:239], v[60:63]
    ds_read_b64_tr_b16 v[220:221], v27 offset:0
    v_mul_f32 v141, v141, v17
    v_mfma_f32_16x16x32_bf16 v[60:63], v[204:207], v[252:255], v[60:63]
    v_add_f32 v18, 1.0, v18
    v_add_f32 v16, 1.0, v16
    v_mfma_f32_16x16x32_bf16 v[56:59], v[196:199], a[248:251], v[56:59]
    ds_read_b64_tr_b16 v[222:223], v27 offset:6144
    v_mul_f32 v144, v144, v128
    v_mfma_f32_16x16x32_bf16 v[56:59], v[200:203], v[232:235], v[56:59]
    v_rcp_f32 v18, v18
    v_mfma_f32_16x16x32_bf16 v[56:59], v[204:207], v[248:251], v[56:59]
    ds_read_b64_tr_b16 v[192:193], v27 offset:2048
    v_mul_f32 v142, v142, v18
    v_mfma_f32_16x16x32_bf16 v[52:55], v[196:199], a[244:247], v[52:55]
    v_rcp_f32 v16, v16
    v_mfma_f32_16x16x32_bf16 v[52:55], v[200:203], v[228:231], v[52:55]
    ds_read_b64_tr_b16 v[194:195], v27 offset:8192
    v_mul_f32 v143, v143, v16
    v_mfma_f32_16x16x32_bf16 v[52:55], v[204:207], v[244:247], v[52:55]
    v_exp_f32 v16, -v32
    v_mfma_f32_16x16x32_bf16 v[48:51], v[196:199], a[240:243], v[48:51]
    ds_read_b64_tr_b16 v[196:197], v27 offset:4096
    v_mul_f32 v145, v145, v129
    v_mfma_f32_16x16x32_bf16 v[48:51], v[200:203], v[224:227], v[48:51]
    v_exp_f32 v17, -v33
    v_add_u32 v24, 3, v24
    v_mfma_f32_16x16x32_bf16 v[48:51], v[204:207], v[240:243], v[48:51]
    s_waitcnt lgkmcnt(5)
    s_waitcnt vmcnt(3)
    ds_read_b64_tr_b16 v[198:199], v27 offset:10240
    v_mul_f32 v146, v146, v130
    v_mfma_f32_16x16x32_bf16 v[64:67], v[208:211], a[0:3], 0
    buffer_store_dword v24, v23, s[12:15], s44 offen sc1
    v_exp_f32 v18, -v34
    v_mfma_f32_16x16x32_bf16 v[64:67], v[212:215], a[16:19], v[64:67]
    ds_read_b64_tr_b16 v[200:201], v26 offset:36864
    v_mul_f32 v147, v147, v131
    v_mfma_f32_16x16x32_bf16 v[64:67], v[216:219], a[32:35], v[64:67]
    s_waitcnt vmcnt(1)
    s_barrier
    v_mul_f32 v148, v148, v132
    v_mfma_f32_16x16x32_bf16 v[68:71], v[208:211], a[4:7], 0
    ds_read_b64_tr_b16 v[202:203], v26 offset:43008
    v_mul_f32 v149, v149, v133
    v_mfma_f32_16x16x32_bf16 v[68:71], v[212:215], a[20:23], v[68:71]
    v_mul_f32 v150, v150, v134
    v_mul_f32 v151, v151, v135
    v_mfma_f32_16x16x32_bf16 v[68:71], v[216:219], a[36:39], v[68:71]
    s_mul_i32 s49, s81, 4
    ds_read_b64_tr_b16 v[204:205], v26 offset:38912
    v_cvt_pk_bf16_f32 v128, v144, v145
    v_mfma_f32_16x16x32_bf16 v[72:75], v[208:211], a[8:11], 0
    s_add_u32 s52, s41, 12288
    v_cvt_pk_bf16_f32 v129, v146, v147
    v_cvt_pk_bf16_f32 v130, v148, v149
    v_mfma_f32_16x16x32_bf16 v[72:75], v[212:215], a[24:27], v[72:75]
    s_add_u32 s49, s49, s98
    ds_read_b64_tr_b16 v[206:207], v26 offset:45056
    v_cvt_pk_bf16_f32 v131, v150, v151
    v_mfma_f32_16x16x32_bf16 v[72:75], v[216:219], a[40:43], v[72:75]
    v_permlane16_swap_b32 v128, v130
    v_mfma_f32_16x16x32_bf16 v[76:79], v[208:211], a[12:15], 0
    s_add_u32 s49, s49, 512
    s_add_u32 m0, s11, 24576
    ds_read_b64_tr_b16 v[208:209], v26 offset:40960
    v_mfma_f32_16x16x32_bf16 v[76:79], v[212:215], a[28:31], v[76:79]
    buffer_load_dwordx4 v5, s[16:19], s49 offen offset:0 lds
    v_mfma_f32_16x16x32_bf16 v[76:79], v[216:219], a[44:47], v[76:79]
    s_waitcnt lgkmcnt(5)
    ds_read_b64_tr_b16 v[210:211], v26 offset:47104
    v_mul_f32 v152, v152, v136
    v_mfma_f32_16x16x32_bf16 v[76:79], v[220:223], a[60:63], v[76:79]
    v_permlane16_swap_b32 v129, v131
    v_mfma_f32_16x16x32_bf16 v[76:79], v[192:195], a[76:79], v[76:79]
    ds_read_b64_tr_b16 v[212:213], v27 offset:12288
    v_mul_f32 v153, v153, v137
    v_mfma_f32_16x16x32_bf16 v[76:79], v[196:199], a[92:95], v[76:79]
    buffer_load_dwordx4 v6, s[16:19], s49 offen offset:1024 lds
    v_mfma_f32_16x16x32_bf16 v[72:75], v[220:223], a[56:59], v[72:75]
    ds_read_b64_tr_b16 v[214:215], v27 offset:18432
    v_mul_f32 v154, v154, v138
    v_mfma_f32_16x16x32_bf16 v[72:75], v[192:195], a[72:75], v[72:75]
    buffer_store_dwordx4 v[128:131], v10, s[36:39], s52 offen sc1
    v_mul_f32 v155, v155, v139
    v_mfma_f32_16x16x32_bf16 v[72:75], v[196:199], a[88:91], v[72:75]
    ds_read_b64_tr_b16 v[216:217], v27 offset:14336
    v_mul_f32 v156, v156, v140
    v_mfma_f32_16x16x32_bf16 v[68:71], v[220:223], a[52:55], v[68:71]
    v_mul_f32 v157, v157, v141
    v_mul_f32 v158, v158, v142
    v_mfma_f32_16x16x32_bf16 v[68:71], v[192:195], a[68:71], v[68:71]
    ds_read_b64_tr_b16 v[218:219], v27 offset:20480
    v_mul_f32 v159, v159, v143
    v_mfma_f32_16x16x32_bf16 v[68:71], v[196:199], a[84:87], v[68:71]
    buffer_load_dwordx4 v7, s[16:19], s49 offen offset:2048 lds
    v_mfma_f32_16x16x32_bf16 v[64:67], v[220:223], a[48:51], v[64:67]
    s_add_u32 s100, s41, 12288
    ds_read_b64_tr_b16 v[220:221], v27 offset:16384
    v_cvt_pk_bf16_f32 v136, v152, v153
    v_mfma_f32_16x16x32_bf16 v[64:67], v[192:195], a[64:67], v[64:67]
    v_cvt_pk_bf16_f32 v137, v154, v155
    v_cvt_pk_bf16_f32 v138, v156, v157
    v_mfma_f32_16x16x32_bf16 v[64:67], v[196:199], a[80:83], v[64:67]
    s_waitcnt lgkmcnt(5)
    ds_read_b64_tr_b16 v[222:223], v27 offset:22528
    v_xor_b32 v29, 49184, v12
    v_mfma_f32_16x16x32_bf16 v[80:83], v[200:203], a[0:3], 0
    v_permlane16_swap_b32 v136, v138
    v_mfma_f32_16x16x32_bf16 v[80:83], v[204:207], a[16:19], v[80:83]
    ds_read_b64_tr_b16 v[192:193], v29 offset:24576
    v_cvt_pk_bf16_f32 v139, v158, v159
    v_mfma_f32_16x16x32_bf16 v[80:83], v[208:211], a[32:35], v[80:83]
    v_add_f32 v16, 1.0, v16
    v_add_f32 v17, 1.0, v17
    v_mfma_f32_16x16x32_bf16 v[84:87], v[200:203], a[4:7], 0
    ds_read_b64_tr_b16 v[194:195], v29 offset:30720
    v_add_f32 v18, 1.0, v18
    v_mfma_f32_16x16x32_bf16 v[84:87], v[204:207], a[20:23], v[84:87]
    buffer_load_dwordx4 v8, s[16:19], s49 offen offset:3072 lds
    v_mfma_f32_16x16x32_bf16 v[84:87], v[208:211], a[36:39], v[84:87]
    s_add_u32 s49, s49, s82
    ds_read_b64_tr_b16 v[196:197], v29 offset:26624
    v_mfma_f32_16x16x32_bf16 v[88:91], v[200:203], a[8:11], 0
    v_permlane16_swap_b32 v137, v139
    v_mfma_f32_16x16x32_bf16 v[88:91], v[204:207], a[24:27], v[88:91]
    s_add_u32 m0, s11, 28672
    ds_read_b64_tr_b16 v[198:199], v29 offset:32768
    v_mfma_f32_16x16x32_bf16 v[88:91], v[208:211], a[40:43], v[88:91]
    buffer_store_dwordx4 v[136:139], v11, s[36:39], s100 offen sc1
    v_mfma_f32_16x16x32_bf16 v[92:95], v[200:203], a[12:15], 0
    ds_read_b64_tr_b16 v[200:201], v29 offset:28672
    v_mfma_f32_16x16x32_bf16 v[92:95], v[204:207], a[28:31], v[92:95]
    buffer_load_dwordx4 v5, s[16:19], s49 offen offset:0 lds
    v_mfma_f32_16x16x32_bf16 v[92:95], v[208:211], a[44:47], v[92:95]
    s_waitcnt lgkmcnt(5)
    ds_read_b64_tr_b16 v[202:203], v29 offset:34816
    v_xor_b32 v28, 98336, v12
    v_mfma_f32_16x16x32_bf16 v[92:95], v[212:215], a[60:63], v[92:95]
    v_rcp_f32 v16, v16
    v_mfma_f32_16x16x32_bf16 v[92:95], v[216:219], a[76:79], v[92:95]
    ds_read_b64_tr_b16 v[204:205], v28 offset:0
    v_mul_f32 v32, v32, v16
    v_mfma_f32_16x16x32_bf16 v[92:95], v[220:223], a[92:95], v[92:95]
    v_rcp_f32 v17, v17
    v_mfma_f32_16x16x32_bf16 v[88:91], v[212:215], a[56:59], v[88:91]
    ds_read_b64_tr_b16 v[206:207], v28 offset:6144
    v_mul_f32 v33, v33, v17
    v_mfma_f32_16x16x32_bf16 v[88:91], v[216:219], a[72:75], v[88:91]
    buffer_load_dwordx4 v6, s[16:19], s49 offen offset:1024 lds
    v_mfma_f32_16x16x32_bf16 v[88:91], v[220:223], a[88:91], v[88:91]
    s_mul_i32 s49, s81, 5
    ds_read_b64_tr_b16 v[208:209], v28 offset:2048
    v_mul_f32 v48, v48, v32
    v_mfma_f32_16x16x32_bf16 v[84:87], v[212:215], a[52:55], v[84:87]
    v_rcp_f32 v18, v18
    v_mfma_f32_16x16x32_bf16 v[84:87], v[216:219], a[68:71], v[84:87]
    s_add_u32 s49, s49, s98
    ds_read_b64_tr_b16 v[210:211], v28 offset:8192
    v_mul_f32 v34, v34, v18
    v_mfma_f32_16x16x32_bf16 v[84:87], v[220:223], a[84:87], v[84:87]
    v_exp_f32 v16, -v35
    v_mfma_f32_16x16x32_bf16 v[80:83], v[212:215], a[48:51], v[80:83]
    s_add_u32 s49, s49, 512
    s_add_u32 m0, s11, 49152
    ds_read_b64_tr_b16 v[212:213], v28 offset:4096
    v_mfma_f32_16x16x32_bf16 v[80:83], v[216:219], a[64:67], v[80:83]
    buffer_load_dwordx4 v5, s[16:19], s49 offen offset:0 lds
    v_mfma_f32_16x16x32_bf16 v[80:83], v[220:223], a[80:83], v[80:83]
    s_waitcnt lgkmcnt(5)
    ds_read_b64_tr_b16 v[214:215], v28 offset:10240
    v_add_f32 v16, 1.0, v16
    v_mfma_f32_16x16x32_bf16 v[96:99], v[192:195], a[0:3], 0
    v_rcp_f32 v16, v16
    v_mfma_f32_16x16x32_bf16 v[96:99], v[196:199], a[16:19], v[96:99]
    ds_read_b64_tr_b16 v[216:217], v29 offset:36864
    v_mul_f32 v35, v35, v16
    v_mfma_f32_16x16x32_bf16 v[96:99], v[200:203], a[32:35], v[96:99]
    v_exp_f32 v17, -v36
    v_mfma_f32_16x16x32_bf16 v[100:103], v[192:195], a[4:7], 0
    ds_read_b64_tr_b16 v[218:219], v29 offset:43008
    v_add_f32 v17, 1.0, v17
    v_mfma_f32_16x16x32_bf16 v[100:103], v[196:199], a[20:23], v[100:103]
    buffer_load_dwordx4 v6, s[16:19], s49 offen offset:1024 lds
    v_mfma_f32_16x16x32_bf16 v[100:103], v[200:203], a[36:39], v[100:103]
    ds_read_b64_tr_b16 v[220:221], v29 offset:38912
    v_mul_f32 v49, v49, v33
    v_mfma_f32_16x16x32_bf16 v[104:107], v[192:195], a[8:11], 0
    v_rcp_f32 v17, v17
    v_mfma_f32_16x16x32_bf16 v[104:107], v[196:199], a[24:27], v[104:107]
    ds_read_b64_tr_b16 v[222:223], v29 offset:45056
    v_mul_f32 v36, v36, v17
    v_mfma_f32_16x16x32_bf16 v[104:107], v[200:203], a[40:43], v[104:107]
    v_exp_f32 v18, -v37
    v_mfma_f32_16x16x32_bf16 v[108:111], v[192:195], a[12:15], 0
    ds_read_b64_tr_b16 v[192:193], v29 offset:40960
    v_add_f32 v18, 1.0, v18
    v_mfma_f32_16x16x32_bf16 v[108:111], v[196:199], a[28:31], v[108:111]
    buffer_load_dwordx4 v7, s[16:19], s49 offen offset:2048 lds
    v_mfma_f32_16x16x32_bf16 v[108:111], v[200:203], a[44:47], v[108:111]
    s_waitcnt lgkmcnt(5)
    ds_read_b64_tr_b16 v[194:195], v29 offset:47104
    v_mul_f32 v50, v50, v34
    v_mfma_f32_16x16x32_bf16 v[108:111], v[204:207], a[60:63], v[108:111]
    v_rcp_f32 v18, v18
    v_mfma_f32_16x16x32_bf16 v[108:111], v[208:211], a[76:79], v[108:111]
    ds_read_b64_tr_b16 v[196:197], v28 offset:12288
    v_mul_f32 v37, v37, v18
    v_mfma_f32_16x16x32_bf16 v[108:111], v[212:215], a[92:95], v[108:111]
    v_exp_f32 v16, -v38
    v_mfma_f32_16x16x32_bf16 v[104:107], v[204:207], a[56:59], v[104:107]
    ds_read_b64_tr_b16 v[198:199], v28 offset:18432
    v_add_f32 v16, 1.0, v16
    v_mfma_f32_16x16x32_bf16 v[104:107], v[208:211], a[72:75], v[104:107]
    buffer_load_dwordx4 v8, s[16:19], s49 offen offset:3072 lds
    v_mfma_f32_16x16x32_bf16 v[104:107], v[212:215], a[88:91], v[104:107]
    s_add_u32 s49, s49, s82
    ds_read_b64_tr_b16 v[200:201], v28 offset:14336
    v_mul_f32 v51, v51, v35
    v_mfma_f32_16x16x32_bf16 v[100:103], v[204:207], a[52:55], v[100:103]
    v_rcp_f32 v16, v16
    v_mfma_f32_16x16x32_bf16 v[100:103], v[208:211], a[68:71], v[100:103]
    s_add_u32 m0, s11, 53248
    ds_read_b64_tr_b16 v[202:203], v28 offset:20480
    v_mul_f32 v38, v38, v16
    v_mfma_f32_16x16x32_bf16 v[100:103], v[212:215], a[84:87], v[100:103]
    v_exp_f32 v17, -v39
    v_mfma_f32_16x16x32_bf16 v[96:99], v[204:207], a[48:51], v[96:99]
    ds_read_b64_tr_b16 v[204:205], v28 offset:16384
    v_add_f32 v17, 1.0, v17
    v_mfma_f32_16x16x32_bf16 v[96:99], v[208:211], a[64:67], v[96:99]
    buffer_load_dwordx4 v5, s[16:19], s49 offen offset:0 lds
    v_mfma_f32_16x16x32_bf16 v[96:99], v[212:215], a[80:83], v[96:99]
    s_waitcnt lgkmcnt(5)
    ds_read_b64_tr_b16 v[206:207], v28 offset:22528
    v_xor_b32 v25, 49216, v12
    v_mfma_f32_16x16x32_bf16 v[112:115], v[216:219], a[0:3], 0
    v_rcp_f32 v17, v17
    v_mfma_f32_16x16x32_bf16 v[112:115], v[220:223], a[16:19], v[112:115]
    ds_read_b64_tr_b16 v[208:209], v25 offset:24576
    v_mul_f32 v39, v39, v17
    v_mfma_f32_16x16x32_bf16 v[112:115], v[192:195], a[32:35], v[112:115]
    v_exp_f32 v18, -v40
    v_mfma_f32_16x16x32_bf16 v[116:119], v[216:219], a[4:7], 0
    ds_read_b64_tr_b16 v[210:211], v25 offset:30720
    v_add_f32 v18, 1.0, v18
    v_mfma_f32_16x16x32_bf16 v[116:119], v[220:223], a[20:23], v[116:119]
    buffer_load_dwordx4 v6, s[16:19], s49 offen offset:1024 lds
    v_mfma_f32_16x16x32_bf16 v[116:119], v[192:195], a[36:39], v[116:119]
    ds_read_b64_tr_b16 v[212:213], v25 offset:26624
    v_mul_f32 v52, v52, v36
    v_mfma_f32_16x16x32_bf16 v[120:123], v[216:219], a[8:11], 0
    v_rcp_f32 v18, v18
    v_mfma_f32_16x16x32_bf16 v[120:123], v[220:223], a[24:27], v[120:123]
    ds_read_b64_tr_b16 v[214:215], v25 offset:32768
    v_mul_f32 v40, v40, v18
    v_mfma_f32_16x16x32_bf16 v[120:123], v[192:195], a[40:43], v[120:123]
    v_exp_f32 v16, -v41
    v_mfma_f32_16x16x32_bf16 v[124:127], v[216:219], a[12:15], 0
    ds_read_b64_tr_b16 v[216:217], v25 offset:28672
    v_add_f32 v16, 1.0, v16
    v_mfma_f32_16x16x32_bf16 v[124:127], v[220:223], a[28:31], v[124:127]
    v_rcp_f32 v16, v16
    v_mfma_f32_16x16x32_bf16 v[124:127], v[192:195], a[44:47], v[124:127]
    s_waitcnt lgkmcnt(5)
    ds_read_b64_tr_b16 v[218:219], v25 offset:34816
    v_xor_b32 v26, 98368, v12
    v_mfma_f32_16x16x32_bf16 v[124:127], v[196:199], a[60:63], v[124:127]
    v_exp_f32 v17, -v42
    v_mfma_f32_16x16x32_bf16 v[124:127], v[200:203], a[76:79], v[124:127]
    ds_read_b64_tr_b16 v[220:221], v26 offset:0
    v_mul_f32 v41, v41, v16
    v_mfma_f32_16x16x32_bf16 v[124:127], v[204:207], a[92:95], v[124:127]
    v_exp_f32 v18, -v43
    v_mfma_f32_16x16x32_bf16 v[120:123], v[196:199], a[56:59], v[120:123]
    ds_read_b64_tr_b16 v[222:223], v26 offset:6144
    v_add_f32 v17, 1.0, v17
    v_mfma_f32_16x16x32_bf16 v[120:123], v[200:203], a[72:75], v[120:123]
    v_rcp_f32 v17, v17
    v_mfma_f32_16x16x32_bf16 v[120:123], v[204:207], a[88:91], v[120:123]
    ds_read_b64_tr_b16 v[192:193], v26 offset:2048
    v_mul_f32 v42, v42, v17
    v_mfma_f32_16x16x32_bf16 v[116:119], v[196:199], a[52:55], v[116:119]
    v_exp_f32 v16, -v44
    v_mfma_f32_16x16x32_bf16 v[116:119], v[200:203], a[68:71], v[116:119]
    ds_read_b64_tr_b16 v[194:195], v26 offset:8192
    v_add_f32 v18, 1.0, v18
    v_mfma_f32_16x16x32_bf16 v[116:119], v[204:207], a[84:87], v[116:119]
    buffer_load_dword v31, v13, s[12:15], s47 offen sc1
    v_mfma_f32_16x16x32_bf16 v[112:115], v[196:199], a[48:51], v[112:115]
    ds_read_b64_tr_b16 v[196:197], v26 offset:4096
    v_add_f32 v16, 1.0, v16
    v_mfma_f32_16x16x32_bf16 v[112:115], v[200:203], a[64:67], v[112:115]
    v_rcp_f32 v18, v18
    v_mfma_f32_16x16x32_bf16 v[112:115], v[204:207], a[80:83], v[112:115]
    s_waitcnt lgkmcnt(5)
    ds_read_b64_tr_b16 v[198:199], v26 offset:10240
    v_mul_f32 v43, v43, v18
    v_mfma_f32_16x16x32_bf16 v[128:131], v[208:211], a[0:3], 0
    v_rcp_f32 v16, v16
    v_mfma_f32_16x16x32_bf16 v[128:131], v[212:215], a[16:19], v[128:131]
    ds_read_b64_tr_b16 v[200:201], v25 offset:36864
    v_mul_f32 v44, v44, v16
    v_mfma_f32_16x16x32_bf16 v[128:131], v[216:219], a[32:35], v[128:131]
    v_exp_f32 v17, -v45
    v_mfma_f32_16x16x32_bf16 v[132:135], v[208:211], a[4:7], 0
    ds_read_b64_tr_b16 v[202:203], v25 offset:43008
    v_add_f32 v17, 1.0, v17
    v_mfma_f32_16x16x32_bf16 v[132:135], v[212:215], a[20:23], v[132:135]
    v_rcp_f32 v17, v17
    v_mfma_f32_16x16x32_bf16 v[132:135], v[216:219], a[36:39], v[132:135]
    ds_read_b64_tr_b16 v[204:205], v25 offset:38912
    v_mul_f32 v45, v45, v17
    v_mfma_f32_16x16x32_bf16 v[136:139], v[208:211], a[8:11], 0
    v_exp_f32 v18, -v46
    v_mfma_f32_16x16x32_bf16 v[136:139], v[212:215], a[24:27], v[136:139]
    ds_read_b64_tr_b16 v[206:207], v25 offset:45056
    v_add_f32 v18, 1.0, v18
    v_mfma_f32_16x16x32_bf16 v[136:139], v[216:219], a[40:43], v[136:139]
    v_rcp_f32 v18, v18
    v_mfma_f32_16x16x32_bf16 v[140:143], v[208:211], a[12:15], 0
    ds_read_b64_tr_b16 v[208:209], v25 offset:40960
    v_mul_f32 v46, v46, v18
    v_mfma_f32_16x16x32_bf16 v[140:143], v[212:215], a[28:31], v[140:143]
    v_exp_f32 v16, -v47
    v_mfma_f32_16x16x32_bf16 v[140:143], v[216:219], a[44:47], v[140:143]
    s_waitcnt lgkmcnt(5)
    ds_read_b64_tr_b16 v[210:211], v25 offset:47104
    v_add_f32 v16, 1.0, v16
    v_mfma_f32_16x16x32_bf16 v[140:143], v[220:223], a[60:63], v[140:143]
    v_rcp_f32 v16, v16
    v_mfma_f32_16x16x32_bf16 v[140:143], v[192:195], a[76:79], v[140:143]
    ds_read_b64_tr_b16 v[212:213], v26 offset:12288
    v_mul_f32 v47, v47, v16
    v_mfma_f32_16x16x32_bf16 v[140:143], v[196:199], a[92:95], v[140:143]
    v_mul_f32 v53, v53, v37
    v_mul_f32 v54, v54, v38
    v_mfma_f32_16x16x32_bf16 v[136:139], v[220:223], a[56:59], v[136:139]
    ds_read_b64_tr_b16 v[214:215], v26 offset:18432
    v_mul_f32 v55, v55, v39
    v_mfma_f32_16x16x32_bf16 v[136:139], v[192:195], a[72:75], v[136:139]
    s_add_u32 s52, s41, 16384
    v_cvt_pk_bf16_f32 v32, v48, v49
    v_cvt_pk_bf16_f32 v33, v50, v51
    v_mfma_f32_16x16x32_bf16 v[136:139], v[196:199], a[88:91], v[136:139]
    ds_read_b64_tr_b16 v[216:217], v26 offset:14336
    v_cvt_pk_bf16_f32 v34, v52, v53
    v_mfma_f32_16x16x32_bf16 v[132:135], v[220:223], a[52:55], v[132:135]
    v_cvt_pk_bf16_f32 v35, v54, v55
    v_mul_f32 v56, v56, v40
    v_mfma_f32_16x16x32_bf16 v[132:135], v[192:195], a[68:71], v[132:135]
    ds_read_b64_tr_b16 v[218:219], v26 offset:20480
    v_mul_f32 v57, v57, v41
    v_mfma_f32_16x16x32_bf16 v[132:135], v[196:199], a[84:87], v[132:135]
    v_permlane16_swap_b32 v32, v34
    v_mfma_f32_16x16x32_bf16 v[128:131], v[220:223], a[48:51], v[128:131]
    ds_read_b64_tr_b16 v[220:221], v26 offset:16384
    v_mul_f32 v58, v58, v42
    v_mfma_f32_16x16x32_bf16 v[128:131], v[192:195], a[64:67], v[128:131]
    v_permlane16_swap_b32 v33, v35
    v_mfma_f32_16x16x32_bf16 v[128:131], v[196:199], a[80:83], v[128:131]
    s_waitcnt lgkmcnt(5)
    ds_read_b64_tr_b16 v[222:223], v26 offset:22528
    v_xor_b32 v27, 49248, v12
    v_mfma_f32_16x16x32_bf16 v[144:147], v[200:203], a[0:3], 0
    buffer_store_dwordx4 v[32:35], v10, s[36:39], s52 offen sc1
    v_mul_f32 v59, v59, v43
    v_mfma_f32_16x16x32_bf16 v[144:147], v[204:207], a[16:19], v[144:147]
    ds_read_b64_tr_b16 v[192:193], v27 offset:24576
    v_mul_f32 v60, v60, v44
    v_mfma_f32_16x16x32_bf16 v[144:147], v[208:211], a[32:35], v[144:147]
    v_mul_f32 v61, v61, v45
    v_mul_f32 v62, v62, v46
    v_mfma_f32_16x16x32_bf16 v[148:151], v[200:203], a[4:7], 0
    ds_read_b64_tr_b16 v[194:195], v27 offset:30720
    v_mul_f32 v63, v63, v47
    v_mfma_f32_16x16x32_bf16 v[148:151], v[204:207], a[20:23], v[148:151]
    s_add_u32 s100, s41, 16384
    v_cvt_pk_bf16_f32 v40, v56, v57
    v_cvt_pk_bf16_f32 v41, v58, v59
    v_mfma_f32_16x16x32_bf16 v[148:151], v[208:211], a[36:39], v[148:151]
    ds_read_b64_tr_b16 v[196:197], v27 offset:26624
    v_cvt_pk_bf16_f32 v42, v60, v61
    v_mfma_f32_16x16x32_bf16 v[152:155], v[200:203], a[8:11], 0
    v_cvt_pk_bf16_f32 v43, v62, v63
    v_mfma_f32_16x16x32_bf16 v[152:155], v[204:207], a[24:27], v[152:155]
    ds_read_b64_tr_b16 v[198:199], v27 offset:32768
    v_mfma_f32_16x16x32_bf16 v[152:155], v[208:211], a[40:43], v[152:155]
    v_permlane16_swap_b32 v40, v42
    v_mfma_f32_16x16x32_bf16 v[156:159], v[200:203], a[12:15], 0
    ds_read_b64_tr_b16 v[200:201], v27 offset:28672
    v_mfma_f32_16x16x32_bf16 v[156:159], v[204:207], a[28:31], v[156:159]
    v_permlane16_swap_b32 v41, v43
    v_mfma_f32_16x16x32_bf16 v[156:159], v[208:211], a[44:47], v[156:159]
    s_waitcnt lgkmcnt(5)
    ds_read_b64_tr_b16 v[202:203], v27 offset:34816
    v_mfma_f32_16x16x32_bf16 v[156:159], v[212:215], a[60:63], v[156:159]
    v_mfma_f32_16x16x32_bf16 v[156:159], v[216:219], a[76:79], v[156:159]
    ds_read_b64_tr_b16 v[204:205], v27 offset:36864
    v_mfma_f32_16x16x32_bf16 v[156:159], v[220:223], a[92:95], v[156:159]
    buffer_store_dwordx4 v[40:43], v11, s[36:39], s100 offen sc1
    v_mfma_f32_16x16x32_bf16 v[152:155], v[212:215], a[56:59], v[152:155]
    ds_read_b64_tr_b16 v[206:207], v27 offset:43008
    v_mfma_f32_16x16x32_bf16 v[152:155], v[216:219], a[72:75], v[152:155]
    v_mfma_f32_16x16x32_bf16 v[152:155], v[220:223], a[88:91], v[152:155]
    ds_read_b64_tr_b16 v[208:209], v27 offset:38912
    v_mfma_f32_16x16x32_bf16 v[148:151], v[212:215], a[52:55], v[148:151]
    v_mfma_f32_16x16x32_bf16 v[148:151], v[216:219], a[68:71], v[148:151]
    ds_read_b64_tr_b16 v[210:211], v27 offset:45056
    v_mfma_f32_16x16x32_bf16 v[148:151], v[220:223], a[84:87], v[148:151]
    v_mfma_f32_16x16x32_bf16 v[144:147], v[212:215], a[48:51], v[144:147]
    ds_read_b64_tr_b16 v[212:213], v27 offset:40960
    v_mfma_f32_16x16x32_bf16 v[144:147], v[216:219], a[64:67], v[144:147]
    v_mfma_f32_16x16x32_bf16 v[144:147], v[220:223], a[80:83], v[144:147]
    s_waitcnt lgkmcnt(5)
    ds_read_b64_tr_b16 v[214:215], v27 offset:47104
    v_xor_b32 v29, 98400, v12
    v_mfma_f32_16x16x32_bf16 v[32:35], v[192:195], a[0:3], 0
    v_mfma_f32_16x16x32_bf16 v[32:35], v[196:199], a[16:19], v[32:35]
    s_add_u32 s9, s6, 3
    ds_read_b64_tr_b16 v[216:217], v29 offset:0
    v_mfma_f32_16x16x32_bf16 v[32:35], v[200:203], a[32:35], v[32:35]
    v_mfma_f32_16x16x32_bf16 v[36:39], v[192:195], a[4:7], 0
    s_waitcnt vmcnt(2)
    ds_read_b64_tr_b16 v[218:219], v29 offset:6144
    v_subrev_u32 v31, s9, v31
    v_mfma_f32_16x16x32_bf16 v[36:39], v[196:199], a[20:23], v[36:39]
    v_cmp_lt_u32 vcc, 6, v31
    v_mfma_f32_16x16x32_bf16 v[36:39], v[200:203], a[36:39], v[36:39]
    ds_read_b64_tr_b16 v[220:221], v29 offset:2048
    v_mfma_f32_16x16x32_bf16 v[40:43], v[192:195], a[8:11], 0
    v_mfma_f32_16x16x32_bf16 v[40:43], v[196:199], a[24:27], v[40:43]
    s_cbranch_vccnz Lslow_24
Lback_25:
    ds_read_b64_tr_b16 v[222:223], v29 offset:8192
    v_mfma_f32_16x16x32_bf16 v[40:43], v[200:203], a[40:43], v[40:43]
    v_mfma_f32_16x16x32_bf16 v[44:47], v[192:195], a[12:15], 0
    s_add_u32 s51, s42, 0
    ds_read_b64_tr_b16 v[192:193], v29 offset:4096
    v_mfma_f32_16x16x32_bf16 v[44:47], v[196:199], a[28:31], v[44:47]
    buffer_load_dwordx4 v[160:163], v4, s[36:39], s51 offen offset:0 sc1
    v_mfma_f32_16x16x32_bf16 v[44:47], v[200:203], a[44:47], v[44:47]
    s_waitcnt lgkmcnt(5)
    ds_read_b64_tr_b16 v[194:195], v29 offset:10240
    v_mfma_f32_16x16x32_bf16 v[48:51], v[204:207], a[0:3], 0
    v_mfma_f32_16x16x32_bf16 v[48:51], v[208:211], a[16:19], v[48:51]
    ds_read_b64_tr_b16 v[196:197], v29 offset:12288
    v_mfma_f32_16x16x32_bf16 v[48:51], v[212:215], a[32:35], v[48:51]
    v_mfma_f32_16x16x32_bf16 v[52:55], v[204:207], a[4:7], 0
    ds_read_b64_tr_b16 v[198:199], v29 offset:18432
    v_mfma_f32_16x16x32_bf16 v[52:55], v[208:211], a[20:23], v[52:55]
    buffer_load_dwordx4 v[164:167], v4, s[36:39], s51 offen offset:1024 sc1
    v_mfma_f32_16x16x32_bf16 v[52:55], v[212:215], a[36:39], v[52:55]
    ds_read_b64_tr_b16 v[200:201], v29 offset:14336
    v_mfma_f32_16x16x32_bf16 v[56:59], v[204:207], a[8:11], 0
    v_mfma_f32_16x16x32_bf16 v[56:59], v[208:211], a[24:27], v[56:59]
    ds_read_b64_tr_b16 v[202:203], v29 offset:20480
    v_mfma_f32_16x16x32_bf16 v[56:59], v[212:215], a[40:43], v[56:59]
    v_mfma_f32_16x16x32_bf16 v[60:63], v[204:207], a[12:15], 0
    ds_read_b64_tr_b16 v[204:205], v29 offset:16384
    v_mfma_f32_16x16x32_bf16 v[60:63], v[208:211], a[28:31], v[60:63]
    buffer_load_dwordx4 v[168:171], v4, s[36:39], s51 offen offset:2048 sc1
    v_mfma_f32_16x16x32_bf16 v[60:63], v[212:215], a[44:47], v[60:63]
    s_waitcnt lgkmcnt(5)
    ds_read_b64_tr_b16 v[206:207], v29 offset:22528
    v_xor_b32 v28, 98304, v12
    v_mfma_f32_16x16x32_bf16 v[32:35], v[216:219], a[48:51], v[32:35]
    v_mfma_f32_16x16x32_bf16 v[32:35], v[220:223], a[64:67], v[32:35]
    ds_read_b64_tr_b16 v[208:209], v28 offset:24576
    v_mfma_f32_16x16x32_bf16 v[32:35], v[192:195], a[80:83], v[32:35]
    v_mfma_f32_16x16x32_bf16 v[36:39], v[216:219], a[52:55], v[36:39]
    ds_read_b64_tr_b16 v[210:211], v28 offset:30720
    v_mfma_f32_16x16x32_bf16 v[36:39], v[220:223], a[68:71], v[36:39]
    v_mfma_f32_16x16x32_bf16 v[36:39], v[192:195], a[84:87], v[36:39]
    ds_read_b64_tr_b16 v[212:213], v28 offset:26624
    v_mfma_f32_16x16x32_bf16 v[40:43], v[216:219], a[56:59], v[40:43]
    buffer_load_dwordx4 v[172:175], v4, s[36:39], s51 offen offset:3072 sc1
    v_mfma_f32_16x16x32_bf16 v[40:43], v[220:223], a[72:75], v[40:43]
    ds_read_b64_tr_b16 v[214:215], v28 offset:32768
    v_mfma_f32_16x16x32_bf16 v[40:43], v[192:195], a[88:91], v[40:43]
    v_mfma_f32_16x16x32_bf16 v[44:47], v[216:219], a[60:63], v[44:47]
    ds_read_b64_tr_b16 v[216:217], v28 offset:28672
    v_mfma_f32_16x16x32_bf16 v[44:47], v[220:223], a[76:79], v[44:47]
    v_mfma_f32_16x16x32_bf16 v[44:47], v[192:195], a[92:95], v[44:47]
    s_waitcnt lgkmcnt(5)
    ds_read_b64_tr_b16 v[218:219], v28 offset:34816
    v_xor_b32 v25, 0, v12
    v_mfma_f32_16x16x32_bf16 v[48:51], v[196:199], a[48:51], v[48:51]
    buffer_load_dwordx4 v[176:179], v19, s[36:39], s51 offen offset:0 sc1
    v_mfma_f32_16x16x32_bf16 v[48:51], v[200:203], a[64:67], v[48:51]
    ds_read_b64_tr_b16 v[220:221], v25 offset:0
    v_mfma_f32_16x16x32_bf16 v[48:51], v[204:207], a[80:83], v[48:51]
    v_mfma_f32_16x16x32_bf16 v[52:55], v[196:199], a[52:55], v[52:55]
    ds_read_b64_tr_b16 v[222:223], v25 offset:6144
    v_mfma_f32_16x16x32_bf16 v[52:55], v[200:203], a[68:71], v[52:55]
    v_mfma_f32_16x16x32_bf16 v[52:55], v[204:207], a[84:87], v[52:55]
    ds_read_b64_tr_b16 v[192:193], v25 offset:2048
    v_mfma_f32_16x16x32_bf16 v[56:59], v[196:199], a[56:59], v[56:59]
    v_mfma_f32_16x16x32_bf16 v[56:59], v[200:203], a[72:75], v[56:59]
    ds_read_b64_tr_b16 v[194:195], v25 offset:8192
    v_mfma_f32_16x16x32_bf16 v[56:59], v[204:207], a[88:91], v[56:59]
    buffer_load_dwordx4 v[180:183], v19, s[36:39], s51 offen offset:1024 sc1
    v_mfma_f32_16x16x32_bf16 v[60:63], v[196:199], a[60:63], v[60:63]
    ds_read_b64_tr_b16 v[196:197], v25 offset:4096
    v_mfma_f32_16x16x32_bf16 v[60:63], v[200:203], a[76:79], v[60:63]
    s_waitcnt vmcnt(9)
    s_barrier
    v_mfma_f32_16x16x32_bf16 v[60:63], v[204:207], a[92:95], v[60:63]
    s_waitcnt lgkmcnt(5)
    ds_read_b64_tr_b16 v[198:199], v25 offset:10240
    v_mfma_f32_16x16x32_bf16 v[64:67], v[208:211], a[96:99], v[64:67]
    v_mfma_f32_16x16x32_bf16 v[64:67], v[212:215], a[112:115], v[64:67]
    ds_read_b64_tr_b16 v[200:201], v25 offset:24576
    v_mfma_f32_16x16x32_bf16 v[64:67], v[216:219], a[128:131], v[64:67]
    s_barrier
    v_mfma_f32_16x16x32_bf16 v[68:71], v[208:211], a[100:103], v[68:71]
    ds_read_b64_tr_b16 v[202:203], v25 offset:30720
    v_mfma_f32_16x16x32_bf16 v[68:71], v[212:215], a[116:119], v[68:71]
    buffer_load_dwordx4 v[184:187], v19, s[36:39], s51 offen offset:2048 sc1
    v_add_u32 v24, 2, v24
    v_mfma_f32_16x16x32_bf16 v[68:71], v[216:219], a[132:135], v[68:71]
    s_waitcnt vmcnt(7)
    ds_read_b64_tr_b16 v[204:205], v25 offset:26624
    v_mfma_f32_16x16x32_bf16 v[72:75], v[208:211], a[104:107], v[72:75]
    buffer_store_dword v24, v23, s[12:15], s44 offen sc1
    v_mfma_f32_16x16x32_bf16 v[72:75], v[212:215], a[120:123], v[72:75]
    ds_read_b64_tr_b16 v[206:207], v25 offset:32768
    v_mfma_f32_16x16x32_bf16 v[72:75], v[216:219], a[136:139], v[72:75]
    v_mfma_f32_16x16x32_bf16 v[76:79], v[208:211], a[108:111], v[76:79]
    ds_read_b64_tr_b16 v[208:209], v25 offset:28672
    v_mfma_f32_16x16x32_bf16 v[76:79], v[212:215], a[124:127], v[76:79]
    buffer_load_dwordx4 v[188:191], v19, s[36:39], s51 offen offset:3072 sc1
    v_mfma_f32_16x16x32_bf16 v[76:79], v[216:219], a[140:143], v[76:79]
    s_waitcnt lgkmcnt(5)
    ds_read_b64_tr_b16 v[210:211], v25 offset:34816
    v_xor_b32 v26, 49152, v12
    v_mfma_f32_16x16x32_bf16 v[76:79], v[220:223], a[156:159], v[76:79]
    v_mfma_f32_16x16x32_bf16 v[76:79], v[192:195], a[172:175], v[76:79]
    s_add_u32 s51, s42, 4096
    ds_read_b64_tr_b16 v[212:213], v26 offset:0
    v_mfma_f32_16x16x32_bf16 v[76:79], v[196:199], a[188:191], v[76:79]
    buffer_load_dwordx4 a[0:3], v4, s[36:39], s51 offen offset:0 sc1
    v_mfma_f32_16x16x32_bf16 v[72:75], v[220:223], a[152:155], v[72:75]
    ds_read_b64_tr_b16 v[214:215], v26 offset:6144
    v_mfma_f32_16x16x32_bf16 v[72:75], v[192:195], a[168:171], v[72:75]
    v_mfma_f32_16x16x32_bf16 v[72:75], v[196:199], a[184:187], v[72:75]
    ds_read_b64_tr_b16 v[216:217], v26 offset:2048
    v_mfma_f32_16x16x32_bf16 v[68:71], v[220:223], a[148:151], v[68:71]
    v_mfma_f32_16x16x32_bf16 v[68:71], v[192:195], a[164:167], v[68:71]
Lhop7:
    s_cbranch_execz Lhop11
    ds_read_b64_tr_b16 v[218:219], v26 offset:8192
    v_mfma_f32_16x16x32_bf16 v[68:71], v[196:199], a[180:183], v[68:71]
    buffer_load_dwordx4 a[4:7], v4, s[36:39], s51 offen offset:1024 sc1
    v_mfma_f32_16x16x32_bf16 v[64:67], v[220:223], a[144:147], v[64:67]
    ds_read_b64_tr_b16 v[220:221], v26 offset:4096
    v_mfma_f32_16x16x32_bf16 v[64:67], v[192:195], a[160:163], v[64:67]
    v_mfma_f32_16x16x32_bf16 v[64:67], v[196:199], a[176:179], v[64:67]
    s_waitcnt lgkmcnt(5)
    ds_read_b64_tr_b16 v[222:223], v26 offset:10240
    v_mfma_f32_16x16x32_bf16 v[64:67], v[200:203], a[192:195], v[64:67]
    v_mfma_f32_16x16x32_bf16 v[64:67], v[204:207], a[208:211], v[64:67]
    ds_read_b64_tr_b16 v[192:193], v28 offset:36864
    v_mfma_f32_16x16x32_bf16 v[64:67], v[208:211], a[224:227], v[64:67]
    buffer_load_dwordx4 a[8:11], v4, s[36:39], s51 offen offset:2048 sc1
    v_mfma_f32_16x16x32_bf16 v[68:71], v[200:203], a[196:199], v[68:71]
    ds_read_b64_tr_b16 v[194:195], v28 offset:43008
    v_mfma_f32_16x16x32_bf16 v[68:71], v[204:207], a[212:215], v[68:71]
    v_mfma_f32_16x16x32_bf16 v[68:71], v[208:211], a[228:231], v[68:71]
    ds_read_b64_tr_b16 v[196:197], v28 offset:38912
    v_mfma_f32_16x16x32_bf16 v[72:75], v[200:203], a[200:203], v[72:75]
    v_mfma_f32_16x16x32_bf16 v[72:75], v[204:207], a[216:219], v[72:75]
    ds_read_b64_tr_b16 v[198:199], v28 offset:45056
    v_mfma_f32_16x16x32_bf16 v[72:75], v[208:211], a[232:235], v[72:75]
    v_mfma_f32_16x16x32_bf16 v[76:79], v[200:203], a[204:207], v[76:79]
    ds_read_b64_tr_b16 v[200:201], v28 offset:40960
    v_mfma_f32_16x16x32_bf16 v[76:79], v[204:207], a[220:223], v[76:79]
    buffer_load_dwordx4 a[12:15], v4, s[36:39], s51 offen offset:3072 sc1
    v_mfma_f32_16x16x32_bf16 v[76:79], v[208:211], a[236:239], v[76:79]
    s_waitcnt lgkmcnt(5)
    ds_read_b64_tr_b16 v[202:203], v28 offset:47104
    v_mfma_f32_16x16x32_bf16 v[76:79], v[212:215], a[252:255], v[76:79]
    v_mfma_f32_16x16x32_bf16 v[76:79], v[216:219], v[236:239], v[76:79]
    ds_read_b64_tr_b16 v[204:205], v25 offset:12288
    v_mfma_f32_16x16x32_bf16 v[76:79], v[220:223], v[252:255], v[76:79]
    v_mfma_f32_16x16x32_bf16 v[72:75], v[212:215], a[248:251], v[72:75]
    ds_read_b64_tr_b16 v[206:207], v25 offset:18432
    v_mfma_f32_16x16x32_bf16 v[72:75], v[216:219], v[232:235], v[72:75]
    buffer_load_dwordx4 a[16:19], v19, s[36:39], s51 offen offset:0 sc1
    v_mfma_f32_16x16x32_bf16 v[72:75], v[220:223], v[248:251], v[72:75]
    ds_read_b64_tr_b16 v[208:209], v25 offset:14336
    v_mfma_f32_16x16x32_bf16 v[68:71], v[212:215], a[244:247], v[68:71]
    v_mfma_f32_16x16x32_bf16 v[68:71], v[216:219], v[228:231], v[68:71]
    ds_read_b64_tr_b16 v[210:211], v25 offset:20480
    v_mfma_f32_16x16x32_bf16 v[68:71], v[220:223], v[244:247], v[68:71]
    v_mfma_f32_16x16x32_bf16 v[64:67], v[212:215], a[240:243], v[64:67]
    ds_read_b64_tr_b16 v[212:213], v25 offset:16384
    v_mfma_f32_16x16x32_bf16 v[64:67], v[216:219], v[224:227], v[64:67]
    v_mfma_f32_16x16x32_bf16 v[64:67], v[220:223], v[240:243], v[64:67]
    s_waitcnt lgkmcnt(5)
    ds_read_b64_tr_b16 v[214:215], v25 offset:22528
    v_mfma_f32_16x16x32_bf16 v[80:83], v[192:195], a[96:99], v[80:83]
    buffer_load_dwordx4 a[20:23], v19, s[36:39], s51 offen offset:1024 sc1
    v_mfma_f32_16x16x32_bf16 v[80:83], v[196:199], a[112:115], v[80:83]
    ds_read_b64_tr_b16 v[216:217], v25 offset:36864
    v_mfma_f32_16x16x32_bf16 v[80:83], v[200:203], a[128:131], v[80:83]
    v_mfma_f32_16x16x32_bf16 v[84:87], v[192:195], a[100:103], v[84:87]
    ds_read_b64_tr_b16 v[218:219], v25 offset:43008
    v_mfma_f32_16x16x32_bf16 v[84:87], v[196:199], a[116:119], v[84:87]
    v_mfma_f32_16x16x32_bf16 v[84:87], v[200:203], a[132:135], v[84:87]
    ds_read_b64_tr_b16 v[220:221], v25 offset:38912
    v_mfma_f32_16x16x32_bf16 v[88:91], v[192:195], a[104:107], v[88:91]
    buffer_load_dwordx4 a[24:27], v19, s[36:39], s51 offen offset:2048 sc1
    v_mfma_f32_16x16x32_bf16 v[88:91], v[196:199], a[120:123], v[88:91]
    ds_read_b64_tr_b16 v[222:223], v25 offset:45056
    v_mfma_f32_16x16x32_bf16 v[88:91], v[200:203], a[136:139], v[88:91]
    v_exp_f32 v16, -v64
    v_mfma_f32_16x16x32_bf16 v[92:95], v[192:195], a[108:111], v[92:95]
    ds_read_b64_tr_b16 v[192:193], v25 offset:40960
    v_add_f32 v16, 1.0, v16
    v_mfma_f32_16x16x32_bf16 v[92:95], v[196:199], a[124:127], v[92:95]
    v_rcp_f32 v16, v16
    v_mfma_f32_16x16x32_bf16 v[92:95], v[200:203], a[140:143], v[92:95]
    s_waitcnt lgkmcnt(5)
    ds_read_b64_tr_b16 v[194:195], v25 offset:47104
    v_mul_f32 v64, v64, v16
    v_mfma_f32_16x16x32_bf16 v[92:95], v[204:207], a[156:159], v[92:95]
    v_exp_f32 v17, -v65
    v_mfma_f32_16x16x32_bf16 v[92:95], v[208:211], a[172:175], v[92:95]
    ds_read_b64_tr_b16 v[196:197], v26 offset:12288
    v_add_f32 v17, 1.0, v17
    v_mfma_f32_16x16x32_bf16 v[92:95], v[212:215], a[188:191], v[92:95]
    buffer_load_dwordx4 a[28:31], v19, s[36:39], s51 offen offset:3072 sc1
    v_mfma_f32_16x16x32_bf16 v[88:91], v[204:207], a[152:155], v[88:91]
    s_mov_b32 s49, 0
    ds_read_b64_tr_b16 v[198:199], v26 offset:18432
    v_mfma_f32_16x16x32_bf16 v[88:91], v[208:211], a[168:171], v[88:91]
    v_rcp_f32 v17, v17
    v_mfma_f32_16x16x32_bf16 v[88:91], v[212:215], a[184:187], v[88:91]
    s_add_u32 m0, s31, 73728
    ds_read_b64_tr_b16 v[200:201], v26 offset:14336
    v_mul_f32 v65, v65, v17
    v_mfma_f32_16x16x32_bf16 v[84:87], v[204:207], a[148:151], v[84:87]
    buffer_load_dwordx4 v20, s[20:23], s49 offen offset:0 sc1 lds
    v_mfma_f32_16x16x32_bf16 v[84:87], v[208:211], a[164:167], v[84:87]
    ds_read_b64_tr_b16 v[202:203], v26 offset:20480
    v_mfma_f32_16x16x32_bf16 v[84:87], v[212:215], a[180:183], v[84:87]
    v_exp_f32 v18, -v66
    v_mfma_f32_16x16x32_bf16 v[80:83], v[204:207], a[144:147], v[80:83]
    ds_read_b64_tr_b16 v[204:205], v26 offset:16384
    v_add_f32 v18, 1.0, v18
    v_mfma_f32_16x16x32_bf16 v[80:83], v[208:211], a[160:163], v[80:83]
    v_rcp_f32 v18, v18
    v_mfma_f32_16x16x32_bf16 v[80:83], v[212:215], a[176:179], v[80:83]
    s_waitcnt lgkmcnt(5)
    ds_read_b64_tr_b16 v[206:207], v26 offset:22528
    v_xor_b32 v27, 98336, v12
    v_mfma_f32_16x16x32_bf16 v[80:83], v[216:219], a[192:195], v[80:83]
    buffer_load_dwordx4 v20, s[20:23], s49 offen offset:1024 sc1 lds
    v_mfma_f32_16x16x32_bf16 v[80:83], v[220:223], a[208:211], v[80:83]
    ds_read_b64_tr_b16 v[208:209], v27 offset:24576
    v_mul_f32 v66, v66, v18
    v_mfma_f32_16x16x32_bf16 v[80:83], v[192:195], a[224:227], v[80:83]
    v_exp_f32 v16, -v67
    v_mfma_f32_16x16x32_bf16 v[84:87], v[216:219], a[196:199], v[84:87]
    ds_read_b64_tr_b16 v[210:211], v27 offset:30720
    v_add_f32 v16, 1.0, v16
    v_mfma_f32_16x16x32_bf16 v[84:87], v[220:223], a[212:215], v[84:87]
    v_rcp_f32 v16, v16
    v_mfma_f32_16x16x32_bf16 v[84:87], v[192:195], a[228:231], v[84:87]
    ds_read_b64_tr_b16 v[212:213], v27 offset:26624
    v_mul_f32 v67, v67, v16
    v_mfma_f32_16x16x32_bf16 v[88:91], v[216:219], a[200:203], v[88:91]
    buffer_load_dwordx4 v20, s[20:23], s49 offen offset:2048 sc1 lds
    v_mfma_f32_16x16x32_bf16 v[88:91], v[220:223], a[216:219], v[88:91]
    ds_read_b64_tr_b16 v[214:215], v27 offset:32768
    v_mfma_f32_16x16x32_bf16 v[88:91], v[192:195], a[232:235], v[88:91]
    v_exp_f32 v17, -v68
    v_mfma_f32_16x16x32_bf16 v[92:95], v[216:219], a[204:207], v[92:95]
    ds_read_b64_tr_b16 v[216:217], v27 offset:28672
    v_add_f32 v17, 1.0, v17
    v_mfma_f32_16x16x32_bf16 v[92:95], v[220:223], a[220:223], v[92:95]
    v_rcp_f32 v17, v17
    v_mfma_f32_16x16x32_bf16 v[92:95], v[192:195], a[236:239], v[92:95]
    s_waitcnt lgkmcnt(5)
    ds_read_b64_tr_b16 v[218:219], v27 offset:34816
    v_xor_b32 v29, 32, v12
    v_mfma_f32_16x16x32_bf16 v[92:95], v[196:199], a[252:255], v[92:95]
    v_exp_f32 v18, -v69
    v_mfma_f32_16x16x32_bf16 v[92:95], v[200:203], v[236:239], v[92:95]
    ds_read_b64_tr_b16 v[220:221], v29 offset:0
    v_mul_f32 v68, v68, v17
    v_mfma_f32_16x16x32_bf16 v[92:95], v[204:207], v[252:255], v[92:95]
    buffer_load_dwordx4 v20, s[20:23], s49 offen offset:3072 sc1 lds
    v_mfma_f32_16x16x32_bf16 v[88:91], v[196:199], a[248:251], v[88:91]
    s_mov_b32 s49, 4096
    ds_read_b64_tr_b16 v[222:223], v29 offset:6144
    v_add_f32 v18, 1.0, v18
    v_mfma_f32_16x16x32_bf16 v[88:91], v[200:203], v[232:235], v[88:91]
    v_rcp_f32 v18, v18
    v_mfma_f32_16x16x32_bf16 v[88:91], v[204:207], v[248:251], v[88:91]
    s_add_u32 m0, s31, 77824
    ds_read_b64_tr_b16 v[192:193], v29 offset:2048
    v_mul_f32 v69, v69, v18
    v_mfma_f32_16x16x32_bf16 v[84:87], v[196:199], a[244:247], v[84:87]
    v_exp_f32 v16, -v70
    v_mfma_f32_16x16x32_bf16 v[84:87], v[200:203], v[228:231], v[84:87]
    ds_read_b64_tr_b16 v[194:195], v29 offset:8192
    v_add_f32 v16, 1.0, v16
    v_mfma_f32_16x16x32_bf16 v[84:87], v[204:207], v[244:247], v[84:87]
    buffer_load_dwordx4 v20, s[20:23], s49 offen offset:0 sc1 lds
    v_mfma_f32_16x16x32_bf16 v[80:83], v[196:199], a[240:243], v[80:83]
    ds_read_b64_tr_b16 v[196:197], v29 offset:4096
    v_mfma_f32_16x16x32_bf16 v[80:83], v[200:203], v[224:227], v[80:83]
    v_rcp_f32 v16, v16
    v_mfma_f32_16x16x32_bf16 v[80:83], v[204:207], v[240:243], v[80:83]
    s_waitcnt lgkmcnt(5)
    ds_read_b64_tr_b16 v[198:199], v29 offset:10240
    v_mul_f32 v70, v70, v16
    v_mfma_f32_16x16x32_bf16 v[96:99], v[208:211], a[96:99], v[96:99]
    v_exp_f32 v17, -v71
    v_mfma_f32_16x16x32_bf16 v[96:99], v[212:215], a[112:115], v[96:99]
    ds_read_b64_tr_b16 v[200:201], v29 offset:24576
    v_add_f32 v17, 1.0, v17
    v_mfma_f32_16x16x32_bf16 v[96:99], v[216:219], a[128:131], v[96:99]
    v_rcp_f32 v17, v17
    v_mfma_f32_16x16x32_bf16 v[100:103], v[208:211], a[100:103], v[100:103]
    ds_read_b64_tr_b16 v[202:203], v29 offset:30720
    v_mul_f32 v71, v71, v17
    v_mfma_f32_16x16x32_bf16 v[100:103], v[212:215], a[116:119], v[100:103]
    buffer_load_dwordx4 v20, s[20:23], s49 offen offset:1024 sc1 lds
    v_mfma_f32_16x16x32_bf16 v[100:103], v[216:219], a[132:135], v[100:103]
    ds_read_b64_tr_b16 v[204:205], v29 offset:26624
    v_mfma_f32_16x16x32_bf16 v[104:107], v[208:211], a[104:107], v[104:107]
    v_exp_f32 v18, -v72
    v_mfma_f32_16x16x32_bf16 v[104:107], v[212:215], a[120:123], v[104:107]
    ds_read_b64_tr_b16 v[206:207], v29 offset:32768
    v_add_f32 v18, 1.0, v18
    v_mfma_f32_16x16x32_bf16 v[104:107], v[216:219], a[136:139], v[104:107]
    v_rcp_f32 v18, v18
    v_mfma_f32_16x16x32_bf16 v[108:111], v[208:211], a[108:111], v[108:111]
    ds_read_b64_tr_b16 v[208:209], v29 offset:28672
    v_mul_f32 v72, v72, v18
    v_mfma_f32_16x16x32_bf16 v[108:111], v[212:215], a[124:127], v[108:111]
    buffer_load_dwordx4 v20, s[20:23], s49 offen offset:2048 sc1 lds
    v_mfma_f32_16x16x32_bf16 v[108:111], v[216:219], a[140:143], v[108:111]
    s_waitcnt lgkmcnt(5)
    ds_read_b64_tr_b16 v[210:211], v29 offset:34816
    v_xor_b32 v28, 49184, v12
    v_mfma_f32_16x16x32_bf16 v[108:111], v[220:223], a[156:159], v[108:111]
    v_exp_f32 v16, -v73
    v_mfma_f32_16x16x32_bf16 v[108:111], v[192:195], a[172:175], v[108:111]
    ds_read_b64_tr_b16 v[212:213], v28 offset:0
    v_add_f32 v16, 1.0, v16
    v_mfma_f32_16x16x32_bf16 v[108:111], v[196:199], a[188:191], v[108:111]
    buffer_load_dword v31, v13, s[12:15], s47 offen sc1
    v_mfma_f32_16x16x32_bf16 v[104:107], v[220:223], a[152:155], v[104:107]
    ds_read_b64_tr_b16 v[214:215], v28 offset:6144
    v_mul_f32 v80, v80, v64
    v_mfma_f32_16x16x32_bf16 v[104:107], v[192:195], a[168:171], v[104:107]
    v_rcp_f32 v16, v16
    v_mfma_f32_16x16x32_bf16 v[104:107], v[196:199], a[184:187], v[104:107]
    ds_read_b64_tr_b16 v[216:217], v28 offset:2048
    v_mul_f32 v73, v73, v16
    v_mfma_f32_16x16x32_bf16 v[100:103], v[220:223], a[148:151], v[100:103]
    buffer_load_dwordx4 v20, s[20:23], s49 offen offset:3072 sc1 lds
    v_mfma_f32_16x16x32_bf16 v[100:103], v[192:195], a[164:167], v[100:103]
    s_mov_b32 s49, 8192
    ds_read_b64_tr_b16 v[218:219], v28 offset:8192
    v_mul_f32 v81, v81, v65
    v_mfma_f32_16x16x32_bf16 v[100:103], v[196:199], a[180:183], v[100:103]
    v_exp_f32 v17, -v74
    v_mfma_f32_16x16x32_bf16 v[96:99], v[220:223], a[144:147], v[96:99]
    s_add_u32 m0, s31, 81920
    ds_read_b64_tr_b16 v[220:221], v28 offset:4096
    v_add_f32 v17, 1.0, v17
    v_mfma_f32_16x16x32_bf16 v[96:99], v[192:195], a[160:163], v[96:99]
    v_rcp_f32 v17, v17
    v_mfma_f32_16x16x32_bf16 v[96:99], v[196:199], a[176:179], v[96:99]
    s_waitcnt lgkmcnt(5)
    ds_read_b64_tr_b16 v[222:223], v28 offset:10240
    v_mul_f32 v74, v74, v17
    v_mfma_f32_16x16x32_bf16 v[96:99], v[200:203], a[192:195], v[96:99]
    buffer_load_dwordx4 v20, s[20:23], s49 offen offset:0 sc1 lds
    v_mfma_f32_16x16x32_bf16 v[96:99], v[204:207], a[208:211], v[96:99]
    s_add_u32 s51, s42, 8192
    ds_read_b64_tr_b16 v[192:193], v27 offset:36864
    v_mul_f32 v82, v82, v66
    v_mfma_f32_16x16x32_bf16 v[96:99], v[208:211], a[224:227], v[96:99]
    buffer_load_dwordx4 a[32:35], v4, s[36:39], s51 offen offset:0 sc1
    v_mfma_f32_16x16x32_bf16 v[100:103], v[200:203], a[196:199], v[100:103]
    ds_read_b64_tr_b16 v[194:195], v27 offset:43008
    v_mul_f32 v83, v83, v67
    v_mfma_f32_16x16x32_bf16 v[100:103], v[204:207], a[212:215], v[100:103]
    v_exp_f32 v18, -v75
    v_mfma_f32_16x16x32_bf16 v[100:103], v[208:211], a[228:231], v[100:103]
    ds_read_b64_tr_b16 v[196:197], v27 offset:38912
    v_add_f32 v18, 1.0, v18
    v_mfma_f32_16x16x32_bf16 v[104:107], v[200:203], a[200:203], v[104:107]
    v_rcp_f32 v18, v18
    v_mfma_f32_16x16x32_bf16 v[104:107], v[204:207], a[216:219], v[104:107]
    ds_read_b64_tr_b16 v[198:199], v27 offset:45056
    v_mul_f32 v75, v75, v18
    v_mfma_f32_16x16x32_bf16 v[104:107], v[208:211], a[232:235], v[104:107]
    buffer_load_dwordx4 a[36:39], v4, s[36:39], s51 offen offset:1024 sc1
    v_mfma_f32_16x16x32_bf16 v[108:111], v[200:203], a[204:207], v[108:111]
    ds_read_b64_tr_b16 v[200:201], v27 offset:40960
    v_mul_f32 v84, v84, v68
    v_mfma_f32_16x16x32_bf16 v[108:111], v[204:207], a[220:223], v[108:111]
    v_exp_f32 v16, -v76
    v_mfma_f32_16x16x32_bf16 v[108:111], v[208:211], a[236:239], v[108:111]
    s_waitcnt lgkmcnt(5)
    ds_read_b64_tr_b16 v[202:203], v27 offset:47104
    v_add_f32 v16, 1.0, v16
    v_mfma_f32_16x16x32_bf16 v[108:111], v[212:215], a[252:255], v[108:111]
    v_rcp_f32 v16, v16
    v_mfma_f32_16x16x32_bf16 v[108:111], v[216:219], v[236:239], v[108:111]
    ds_read_b64_tr_b16 v[204:205], v29 offset:12288
    v_mul_f32 v76, v76, v16
    v_mfma_f32_16x16x32_bf16 v[108:111], v[220:223], v[252:255], v[108:111]
    buffer_load_dwordx4 a[40:43], v4, s[36:39], s51 offen offset:2048 sc1
    v_mfma_f32_16x16x32_bf16 v[104:107], v[212:215], a[248:251], v[104:107]
    ds_read_b64_tr_b16 v[206:207], v29 offset:18432
    v_mul_f32 v85, v85, v69
    v_mfma_f32_16x16x32_bf16 v[104:107], v[216:219], v[232:235], v[104:107]
    v_exp_f32 v17, -v77
    v_mfma_f32_16x16x32_bf16 v[104:107], v[220:223], v[248:251], v[104:107]
    ds_read_b64_tr_b16 v[208:209], v29 offset:14336
    v_add_f32 v17, 1.0, v17
    v_mfma_f32_16x16x32_bf16 v[100:103], v[212:215], a[244:247], v[100:103]
    v_rcp_f32 v17, v17
    v_mfma_f32_16x16x32_bf16 v[100:103], v[216:219], v[228:231], v[100:103]
    ds_read_b64_tr_b16 v[210:211], v29 offset:20480
    v_mul_f32 v77, v77, v17
    v_mfma_f32_16x16x32_bf16 v[100:103], v[220:223], v[244:247], v[100:103]
    v_exp_f32 v18, -v78
    v_mfma_f32_16x16x32_bf16 v[96:99], v[212:215], a[240:243], v[96:99]
    ds_read_b64_tr_b16 v[212:213], v29 offset:16384
    v_add_f32 v18, 1.0, v18
    v_mfma_f32_16x16x32_bf16 v[96:99], v[216:219], v[224:227], v[96:99]
    buffer_load_dwordx4 a[44:47], v4, s[36:39], s51 offen offset:3072 sc1
    v_mfma_f32_16x16x32_bf16 v[96:99], v[220:223], v[240:243], v[96:99]
    s_waitcnt lgkmcnt(5)
    ds_read_b64_tr_b16 v[214:215], v29 offset:22528
    v_mul_f32 v86, v86, v70
    v_mfma_f32_16x16x32_bf16 v[112:115], v[192:195], a[96:99], v[112:115]
    v_rcp_f32 v18, v18
    v_mfma_f32_16x16x32_bf16 v[112:115], v[196:199], a[112:115], v[112:115]
    ds_read_b64_tr_b16 v[216:217], v29 offset:36864
    v_mul_f32 v78, v78, v18
    v_mfma_f32_16x16x32_bf16 v[112:115], v[200:203], a[128:131], v[112:115]
    v_exp_f32 v16, -v79
    v_mfma_f32_16x16x32_bf16 v[116:119], v[192:195], a[100:103], v[116:119]
    ds_read_b64_tr_b16 v[218:219], v29 offset:43008
    v_add_f32 v16, 1.0, v16
    v_mfma_f32_16x16x32_bf16 v[116:119], v[196:199], a[116:119], v[116:119]
    buffer_load_dwordx4 a[48:51], v19, s[36:39], s51 offen offset:0 sc1
    v_mfma_f32_16x16x32_bf16 v[116:119], v[200:203], a[132:135], v[116:119]
    ds_read_b64_tr_b16 v[220:221], v29 offset:38912
    v_mul_f32 v87, v87, v71
    v_mfma_f32_16x16x32_bf16 v[120:123], v[192:195], a[104:107], v[120:123]
    v_rcp_f32 v16, v16
    v_mfma_f32_16x16x32_bf16 v[120:123], v[196:199], a[120:123], v[120:123]
    ds_read_b64_tr_b16 v[222:223], v29 offset:45056
    v_mul_f32 v79, v79, v16
    v_mfma_f32_16x16x32_bf16 v[120:123], v[200:203], a[136:139], v[120:123]
    v_exp_f32 v16, -v96
    v_mfma_f32_16x16x32_bf16 v[124:127], v[192:195], a[108:111], v[124:127]
    s_add_u32 s52, s41, 20480
    ds_read_b64_tr_b16 v[192:193], v29 offset:40960
    v_cvt_pk_bf16_f32 v64, v80, v81
    v_mfma_f32_16x16x32_bf16 v[124:127], v[196:199], a[124:127], v[124:127]
    v_exp_f32 v17, -v97
    v_mfma_f32_16x16x32_bf16 v[124:127], v[200:203], a[140:143], v[124:127]
    s_waitcnt lgkmcnt(5)
    ds_read_b64_tr_b16 v[194:195], v29 offset:47104
    v_cvt_pk_bf16_f32 v65, v82, v83
    v_mfma_f32_16x16x32_bf16 v[124:127], v[204:207], a[156:159], v[124:127]
    buffer_load_dwordx4 a[52:55], v19, s[36:39], s51 offen offset:1024 sc1
    v_mfma_f32_16x16x32_bf16 v[124:127], v[208:211], a[172:175], v[124:127]
    ds_read_b64_tr_b16 v[196:197], v28 offset:12288
    v_cvt_pk_bf16_f32 v66, v84, v85
    v_mfma_f32_16x16x32_bf16 v[124:127], v[212:215], a[188:191], v[124:127]
    v_exp_f32 v18, -v98
    v_mfma_f32_16x16x32_bf16 v[120:123], v[204:207], a[152:155], v[120:123]
    ds_read_b64_tr_b16 v[198:199], v28 offset:18432
    v_cvt_pk_bf16_f32 v67, v86, v87
    v_mfma_f32_16x16x32_bf16 v[120:123], v[208:211], a[168:171], v[120:123]
    v_permlane16_swap_b32 v64, v66
    v_mfma_f32_16x16x32_bf16 v[120:123], v[212:215], a[184:187], v[120:123]
    ds_read_b64_tr_b16 v[200:201], v28 offset:14336
    v_mul_f32 v88, v88, v72
    v_mfma_f32_16x16x32_bf16 v[116:119], v[204:207], a[148:151], v[116:119]
    buffer_load_dwordx4 a[56:59], v19, s[36:39], s51 offen offset:2048 sc1
    v_mfma_f32_16x16x32_bf16 v[116:119], v[208:211], a[164:167], v[116:119]
    ds_read_b64_tr_b16 v[202:203], v28 offset:20480
    v_mul_f32 v89, v89, v73
    v_mfma_f32_16x16x32_bf16 v[116:119], v[212:215], a[180:183], v[116:119]
    v_permlane16_swap_b32 v65, v67
    v_mfma_f32_16x16x32_bf16 v[112:115], v[204:207], a[144:147], v[112:115]
    s_add_u32 s9, s6, 5
    s_waitcnt vmcnt(9)
    ds_read_b64_tr_b16 v[204:205], v28 offset:16384
    v_mul_f32 v90, v90, v74
    v_mfma_f32_16x16x32_bf16 v[112:115], v[208:211], a[160:163], v[112:115]
    v_subrev_u32 v31, s9, v31
    v_cmp_lt_u32 vcc, 4, v31
    v_mfma_f32_16x16x32_bf16 v[112:115], v[212:215], a[176:179], v[112:115]
    s_waitcnt lgkmcnt(5)
    ds_read_b64_tr_b16 v[206:207], v28 offset:22528
    v_xor_b32 v25, 98368, v12
    v_mul_f32 v91, v91, v75
    v_mfma_f32_16x16x32_bf16 v[112:115], v[216:219], a[192:195], v[112:115]
    buffer_store_dwordx4 v[64:67], v10, s[36:39], s52 offen sc1
    v_mul_f32 v92, v92, v76
    v_mfma_f32_16x16x32_bf16 v[112:115], v[220:223], a[208:211], v[112:115]
    s_cbranch_vccnz Lslow_26
Lback_27:
    ds_read_b64_tr_b16 v[208:209], v25 offset:24576
    v_mul_f32 v93, v93, v77
    v_mul_f32 v94, v94, v78
    v_mfma_f32_16x16x32_bf16 v[112:115], v[192:195], a[224:227], v[112:115]
    buffer_load_dwordx4 a[60:63], v19, s[36:39], s51 offen offset:3072 sc1
    v_mfma_f32_16x16x32_bf16 v[116:119], v[216:219], a[196:199], v[116:119]
    s_add_u32 s51, s42, 12288
    ds_read_b64_tr_b16 v[210:211], v25 offset:30720
    v_mul_f32 v95, v95, v79
    v_cvt_pk_bf16_f32 v72, v88, v89
    v_mfma_f32_16x16x32_bf16 v[116:119], v[220:223], a[212:215], v[116:119]
    buffer_load_dwordx4 a[64:67], v4, s[36:39], s51 offen offset:0 sc1
    v_mfma_f32_16x16x32_bf16 v[116:119], v[192:195], a[228:231], v[116:119]
    s_add_u32 s100, s41, 20480
    ds_read_b64_tr_b16 v[212:213], v25 offset:26624
    v_cvt_pk_bf16_f32 v73, v90, v91
    v_cvt_pk_bf16_f32 v74, v92, v93
    v_mfma_f32_16x16x32_bf16 v[120:123], v[216:219], a[200:203], v[120:123]
    v_cvt_pk_bf16_f32 v75, v94, v95
    v_add_f32 v16, 1.0, v16
    v_mfma_f32_16x16x32_bf16 v[120:123], v[220:223], a[216:219], v[120:123]
    ds_read_b64_tr_b16 v[214:215], v25 offset:32768
    v_permlane16_swap_b32 v72, v74
    v_mfma_f32_16x16x32_bf16 v[120:123], v[192:195], a[232:235], v[120:123]
    v_permlane16_swap_b32 v73, v75
    v_mfma_f32_16x16x32_bf16 v[124:127], v[216:219], a[204:207], v[124:127]
    ds_read_b64_tr_b16 v[216:217], v25 offset:28672
    v_rcp_f32 v16, v16
    v_mfma_f32_16x16x32_bf16 v[124:127], v[220:223], a[220:223], v[124:127]
    buffer_load_dwordx4 a[68:71], v4, s[36:39], s51 offen offset:1024 sc1
    v_mfma_f32_16x16x32_bf16 v[124:127], v[192:195], a[236:239], v[124:127]
    s_waitcnt lgkmcnt(5)
    ds_read_b64_tr_b16 v[218:219], v25 offset:34816
    v_xor_b32 v26, 64, v12
    v_mul_f32 v96, v96, v16
    v_mfma_f32_16x16x32_bf16 v[124:127], v[196:199], a[252:255], v[124:127]
    v_exp_f32 v16, -v99
    v_mfma_f32_16x16x32_bf16 v[124:127], v[200:203], v[236:239], v[124:127]
    ds_read_b64_tr_b16 v[220:221], v26 offset:0
    v_add_f32 v17, 1.0, v17
    v_add_f32 v18, 1.0, v18
    v_mfma_f32_16x16x32_bf16 v[124:127], v[204:207], v[252:255], v[124:127]
    buffer_store_dwordx4 v[72:75], v11, s[36:39], s100 offen sc1
    v_add_f32 v16, 1.0, v16
    v_mfma_f32_16x16x32_bf16 v[120:123], v[196:199], a[248:251], v[120:123]
    ds_read_b64_tr_b16 v[222:223], v26 offset:6144
    v_rcp_f32 v17, v17
    v_mfma_f32_16x16x32_bf16 v[120:123], v[200:203], v[232:235], v[120:123]
    buffer_load_dwordx4 a[72:75], v4, s[36:39], s51 offen offset:2048 sc1
    v_mfma_f32_16x16x32_bf16 v[120:123], v[204:207], v[248:251], v[120:123]
    ds_read_b64_tr_b16 v[192:193], v26 offset:2048
    v_mul_f32 v97, v97, v17
    v_mfma_f32_16x16x32_bf16 v[116:119], v[196:199], a[244:247], v[116:119]
    v_rcp_f32 v18, v18
    v_mfma_f32_16x16x32_bf16 v[116:119], v[200:203], v[228:231], v[116:119]
    ds_read_b64_tr_b16 v[194:195], v26 offset:8192
    v_mul_f32 v98, v98, v18
    v_mfma_f32_16x16x32_bf16 v[116:119], v[204:207], v[244:247], v[116:119]
    v_rcp_f32 v16, v16
    v_mfma_f32_16x16x32_bf16 v[112:115], v[196:199], a[240:243], v[112:115]
    ds_read_b64_tr_b16 v[196:197], v26 offset:4096
    v_mul_f32 v99, v99, v16
    v_mfma_f32_16x16x32_bf16 v[112:115], v[200:203], v[224:227], v[112:115]
    v_exp_f32 v17, -v100
    v_mfma_f32_16x16x32_bf16 v[112:115], v[204:207], v[240:243], v[112:115]
    s_waitcnt lgkmcnt(5)
    ds_read_b64_tr_b16 v[198:199], v26 offset:10240
    v_add_f32 v17, 1.0, v17
    v_mfma_f32_16x16x32_bf16 v[128:131], v[208:211], a[96:99], v[128:131]
    buffer_load_dwordx4 a[76:79], v4, s[36:39], s51 offen offset:3072 sc1
    v_mfma_f32_16x16x32_bf16 v[128:131], v[212:215], a[112:115], v[128:131]
    ds_read_b64_tr_b16 v[200:201], v26 offset:24576
    v_mfma_f32_16x16x32_bf16 v[128:131], v[216:219], a[128:131], v[128:131]
    v_rcp_f32 v17, v17
    v_mfma_f32_16x16x32_bf16 v[132:135], v[208:211], a[100:103], v[132:135]
    ds_read_b64_tr_b16 v[202:203], v26 offset:30720
    v_mul_f32 v100, v100, v17
    v_mfma_f32_16x16x32_bf16 v[132:135], v[212:215], a[116:119], v[132:135]
    v_exp_f32 v18, -v101
    v_mfma_f32_16x16x32_bf16 v[132:135], v[216:219], a[132:135], v[132:135]
    ds_read_b64_tr_b16 v[204:205], v26 offset:26624
    v_add_f32 v18, 1.0, v18
    v_mfma_f32_16x16x32_bf16 v[136:139], v[208:211], a[104:107], v[136:139]
    buffer_load_dwordx4 a[80:83], v19, s[36:39], s51 offen offset:0 sc1
    v_mfma_f32_16x16x32_bf16 v[136:139], v[212:215], a[120:123], v[136:139]
    ds_read_b64_tr_b16 v[206:207], v26 offset:32768
    v_mfma_f32_16x16x32_bf16 v[136:139], v[216:219], a[136:139], v[136:139]
    v_rcp_f32 v18, v18
    v_mfma_f32_16x16x32_bf16 v[140:143], v[208:211], a[108:111], v[140:143]
    ds_read_b64_tr_b16 v[208:209], v26 offset:28672
    v_mul_f32 v101, v101, v18
    v_mfma_f32_16x16x32_bf16 v[140:143], v[212:215], a[124:127], v[140:143]
    v_exp_f32 v16, -v102
    v_mfma_f32_16x16x32_bf16 v[140:143], v[216:219], a[140:143], v[140:143]
    s_waitcnt lgkmcnt(5)
    ds_read_b64_tr_b16 v[210:211], v26 offset:34816
    v_xor_b32 v27, 49216, v12
    v_mfma_f32_16x16x32_bf16 v[140:143], v[220:223], a[156:159], v[140:143]
    v_exp_f32 v17, -v103
    v_mfma_f32_16x16x32_bf16 v[140:143], v[192:195], a[172:175], v[140:143]
    ds_read_b64_tr_b16 v[212:213], v27 offset:0
    v_add_f32 v16, 1.0, v16
    v_mfma_f32_16x16x32_bf16 v[140:143], v[196:199], a[188:191], v[140:143]
    buffer_load_dwordx4 a[84:87], v19, s[36:39], s51 offen offset:1024 sc1
    v_mfma_f32_16x16x32_bf16 v[136:139], v[220:223], a[152:155], v[136:139]
    ds_read_b64_tr_b16 v[214:215], v27 offset:6144
    v_add_f32 v17, 1.0, v17
    v_mfma_f32_16x16x32_bf16 v[136:139], v[192:195], a[168:171], v[136:139]
    v_rcp_f32 v16, v16
    v_mfma_f32_16x16x32_bf16 v[136:139], v[196:199], a[184:187], v[136:139]
    ds_read_b64_tr_b16 v[216:217], v27 offset:2048
    v_mul_f32 v102, v102, v16
    v_mfma_f32_16x16x32_bf16 v[132:135], v[220:223], a[148:151], v[132:135]
    v_rcp_f32 v17, v17
    v_mfma_f32_16x16x32_bf16 v[132:135], v[192:195], a[164:167], v[132:135]
    ds_read_b64_tr_b16 v[218:219], v27 offset:8192
    v_mul_f32 v103, v103, v17
    v_mfma_f32_16x16x32_bf16 v[132:135], v[196:199], a[180:183], v[132:135]
    buffer_load_dwordx4 a[88:91], v19, s[36:39], s51 offen offset:2048 sc1
    v_mfma_f32_16x16x32_bf16 v[128:131], v[220:223], a[144:147], v[128:131]
    ds_read_b64_tr_b16 v[220:221], v27 offset:4096
    v_mul_f32 v112, v112, v96
    v_mfma_f32_16x16x32_bf16 v[128:131], v[192:195], a[160:163], v[128:131]
    v_exp_f32 v18, -v104
    v_mfma_f32_16x16x32_bf16 v[128:131], v[196:199], a[176:179], v[128:131]
    s_waitcnt lgkmcnt(5)
    ds_read_b64_tr_b16 v[222:223], v27 offset:10240
    v_add_f32 v18, 1.0, v18
    v_mfma_f32_16x16x32_bf16 v[128:131], v[200:203], a[192:195], v[128:131]
    v_rcp_f32 v18, v18
    v_mfma_f32_16x16x32_bf16 v[128:131], v[204:207], a[208:211], v[128:131]
    ds_read_b64_tr_b16 v[192:193], v25 offset:36864
    v_mul_f32 v104, v104, v18
    v_mfma_f32_16x16x32_bf16 v[128:131], v[208:211], a[224:227], v[128:131]
    v_exp_f32 v16, -v105
    v_mfma_f32_16x16x32_bf16 v[132:135], v[200:203], a[196:199], v[132:135]
    ds_read_b64_tr_b16 v[194:195], v25 offset:43008
    v_add_f32 v16, 1.0, v16
    v_mfma_f32_16x16x32_bf16 v[132:135], v[204:207], a[212:215], v[132:135]
    buffer_load_dwordx4 a[92:95], v19, s[36:39], s51 offen offset:3072 sc1
    v_mfma_f32_16x16x32_bf16 v[132:135], v[208:211], a[228:231], v[132:135]
    ds_read_b64_tr_b16 v[196:197], v25 offset:38912
    v_mul_f32 v113, v113, v97
    v_mfma_f32_16x16x32_bf16 v[136:139], v[200:203], a[200:203], v[136:139]
    v_rcp_f32 v16, v16
    v_mfma_f32_16x16x32_bf16 v[136:139], v[204:207], a[216:219], v[136:139]
    ds_read_b64_tr_b16 v[198:199], v25 offset:45056
    v_mul_f32 v105, v105, v16
    v_mfma_f32_16x16x32_bf16 v[136:139], v[208:211], a[232:235], v[136:139]
    v_exp_f32 v17, -v106
    v_mfma_f32_16x16x32_bf16 v[140:143], v[200:203], a[204:207], v[140:143]
    ds_read_b64_tr_b16 v[200:201], v25 offset:40960
    v_add_f32 v17, 1.0, v17
    v_mfma_f32_16x16x32_bf16 v[140:143], v[204:207], a[220:223], v[140:143]
    v_rcp_f32 v17, v17
    v_mfma_f32_16x16x32_bf16 v[140:143], v[208:211], a[236:239], v[140:143]
    s_waitcnt lgkmcnt(5)
    ds_read_b64_tr_b16 v[202:203], v25 offset:47104
    v_mul_f32 v106, v106, v17
    v_mfma_f32_16x16x32_bf16 v[140:143], v[212:215], a[252:255], v[140:143]
    v_exp_f32 v18, -v107
    v_mfma_f32_16x16x32_bf16 v[140:143], v[216:219], v[236:239], v[140:143]
    ds_read_b64_tr_b16 v[204:205], v26 offset:12288
    v_exp_f32 v16, -v108
    v_mfma_f32_16x16x32_bf16 v[140:143], v[220:223], v[252:255], v[140:143]
    v_exp_f32 v17, -v109
    v_mfma_f32_16x16x32_bf16 v[136:139], v[212:215], a[248:251], v[136:139]
    ds_read_b64_tr_b16 v[206:207], v26 offset:18432
    v_add_f32 v18, 1.0, v18
    v_add_f32 v16, 1.0, v16
    v_mfma_f32_16x16x32_bf16 v[136:139], v[216:219], v[232:235], v[136:139]
    v_rcp_f32 v18, v18
    v_mfma_f32_16x16x32_bf16 v[136:139], v[220:223], v[248:251], v[136:139]
    ds_read_b64_tr_b16 v[208:209], v26 offset:14336
    v_rcp_f32 v16, v16
    v_mfma_f32_16x16x32_bf16 v[132:135], v[212:215], a[244:247], v[132:135]
    v_mul_f32 v107, v107, v18
    v_mul_f32 v108, v108, v16
    v_mfma_f32_16x16x32_bf16 v[132:135], v[216:219], v[228:231], v[132:135]
    ds_read_b64_tr_b16 v[210:211], v26 offset:20480
    v_exp_f32 v18, -v110
    v_mfma_f32_16x16x32_bf16 v[132:135], v[220:223], v[244:247], v[132:135]
    v_exp_f32 v16, -v111
    v_mfma_f32_16x16x32_bf16 v[128:131], v[212:215], a[240:243], v[128:131]
    ds_read_b64_tr_b16 v[212:213], v26 offset:16384
    v_add_f32 v17, 1.0, v17
    v_add_f32 v18, 1.0, v18
    v_mfma_f32_16x16x32_bf16 v[128:131], v[216:219], v[224:227], v[128:131]
    v_rcp_f32 v17, v17
    v_mfma_f32_16x16x32_bf16 v[128:131], v[220:223], v[240:243], v[128:131]
    s_waitcnt lgkmcnt(5)
    ds_read_b64_tr_b16 v[214:215], v26 offset:22528
    v_rcp_f32 v18, v18
    v_mfma_f32_16x16x32_bf16 v[144:147], v[192:195], a[96:99], v[144:147]
    v_mul_f32 v109, v109, v17
    v_mul_f32 v110, v110, v18
    v_mfma_f32_16x16x32_bf16 v[144:147], v[196:199], a[112:115], v[144:147]
    ds_read_b64_tr_b16 v[216:217], v26 offset:36864
    v_add_f32 v16, 1.0, v16
    v_mul_f32 v114, v114, v98
    v_mfma_f32_16x16x32_bf16 v[144:147], v[200:203], a[128:131], v[144:147]
    v_rcp_f32 v16, v16
    v_mfma_f32_16x16x32_bf16 v[148:151], v[192:195], a[100:103], v[148:151]
    ds_read_b64_tr_b16 v[218:219], v26 offset:43008
    v_mul_f32 v111, v111, v16
    v_mul_f32 v115, v115, v99
    v_mfma_f32_16x16x32_bf16 v[148:151], v[196:199], a[116:119], v[148:151]
    v_mul_f32 v116, v116, v100
    v_mul_f32 v117, v117, v101
    v_mfma_f32_16x16x32_bf16 v[148:151], v[200:203], a[132:135], v[148:151]
    ds_read_b64_tr_b16 v[220:221], v26 offset:38912
    v_mul_f32 v118, v118, v102
    v_mul_f32 v119, v119, v103
    v_mfma_f32_16x16x32_bf16 v[152:155], v[192:195], a[104:107], v[152:155]
    s_add_u32 s52, s41, 24576
    v_cvt_pk_bf16_f32 v96, v112, v113
    v_cvt_pk_bf16_f32 v97, v114, v115
    v_mfma_f32_16x16x32_bf16 v[152:155], v[196:199], a[120:123], v[152:155]
    ds_read_b64_tr_b16 v[222:223], v26 offset:45056
    v_cvt_pk_bf16_f32 v98, v116, v117
    v_cvt_pk_bf16_f32 v99, v118, v119
Lhop8:
    s_cbranch_execz Lhopret
    v_mfma_f32_16x16x32_bf16 v[152:155], v[200:203], a[136:139], v[152:155]
    v_exp_f32 v16, -v128
    v_mfma_f32_16x16x32_bf16 v[156:159], v[192:195], a[108:111], v[156:159]
    ds_read_b64_tr_b16 v[192:193], v26 offset:40960
    v_permlane16_swap_b32 v96, v98
    v_mfma_f32_16x16x32_bf16 v[156:159], v[196:199], a[124:127], v[156:159]
    v_permlane16_swap_b32 v97, v99
    v_mfma_f32_16x16x32_bf16 v[156:159], v[200:203], a[140:143], v[156:159]
    s_waitcnt lgkmcnt(5)
    ds_read_b64_tr_b16 v[194:195], v26 offset:47104
    v_exp_f32 v17, -v129
    v_mfma_f32_16x16x32_bf16 v[156:159], v[204:207], a[156:159], v[156:159]
    buffer_store_dwordx4 v[96:99], v10, s[36:39], s52 offen sc1
    v_mul_f32 v120, v120, v104
    v_mfma_f32_16x16x32_bf16 v[156:159], v[208:211], a[172:175], v[156:159]
    ds_read_b64_tr_b16 v[196:197], v27 offset:12288
    v_exp_f32 v18, -v130
    v_mfma_f32_16x16x32_bf16 v[156:159], v[212:215], a[188:191], v[156:159]
    v_mul_f32 v121, v121, v105
    v_mul_f32 v122, v122, v106
    v_mfma_f32_16x16x32_bf16 v[152:155], v[204:207], a[152:155], v[152:155]
    ds_read_b64_tr_b16 v[198:199], v27 offset:18432
    v_mul_f32 v123, v123, v107
    v_mul_f32 v124, v124, v108
    v_mfma_f32_16x16x32_bf16 v[152:155], v[208:211], a[168:171], v[152:155]
    v_mul_f32 v125, v125, v109
    v_mul_f32 v126, v126, v110
    v_mfma_f32_16x16x32_bf16 v[152:155], v[212:215], a[184:187], v[152:155]
    s_add_u32 s100, s41, 24576
    ds_read_b64_tr_b16 v[200:201], v27 offset:14336
    v_mul_f32 v127, v127, v111
    v_cvt_pk_bf16_f32 v104, v120, v121
    v_mfma_f32_16x16x32_bf16 v[148:151], v[204:207], a[148:151], v[148:151]
    v_cvt_pk_bf16_f32 v105, v122, v123
    v_cvt_pk_bf16_f32 v106, v124, v125
    v_mfma_f32_16x16x32_bf16 v[148:151], v[208:211], a[164:167], v[148:151]
    ds_read_b64_tr_b16 v[202:203], v27 offset:20480
    v_cvt_pk_bf16_f32 v107, v126, v127
    v_add_f32 v16, 1.0, v16
    v_mfma_f32_16x16x32_bf16 v[148:151], v[212:215], a[180:183], v[148:151]
    v_permlane16_swap_b32 v104, v106
    v_mfma_f32_16x16x32_bf16 v[144:147], v[204:207], a[144:147], v[144:147]
    ds_read_b64_tr_b16 v[204:205], v27 offset:16384
    v_permlane16_swap_b32 v105, v107
    v_mfma_f32_16x16x32_bf16 v[144:147], v[208:211], a[160:163], v[144:147]
    v_rcp_f32 v16, v16
    v_mfma_f32_16x16x32_bf16 v[144:147], v[212:215], a[176:179], v[144:147]
    s_waitcnt lgkmcnt(5)
    ds_read_b64_tr_b16 v[206:207], v27 offset:22528
    v_xor_b32 v29, 98400, v12
    v_mul_f32 v128, v128, v16
    v_mfma_f32_16x16x32_bf16 v[144:147], v[216:219], a[192:195], v[144:147]
    v_exp_f32 v16, -v131
    v_mfma_f32_16x16x32_bf16 v[144:147], v[220:223], a[208:211], v[144:147]
    ds_read_b64_tr_b16 v[208:209], v29 offset:24576
    v_add_f32 v17, 1.0, v17
    v_add_f32 v18, 1.0, v18
    v_mfma_f32_16x16x32_bf16 v[144:147], v[192:195], a[224:227], v[144:147]
    buffer_store_dwordx4 v[104:107], v11, s[36:39], s100 offen sc1
    v_add_f32 v16, 1.0, v16
    v_mfma_f32_16x16x32_bf16 v[148:151], v[216:219], a[196:199], v[148:151]
    ds_read_b64_tr_b16 v[210:211], v29 offset:30720
    v_rcp_f32 v17, v17
    v_mfma_f32_16x16x32_bf16 v[148:151], v[220:223], a[212:215], v[148:151]
    v_rcp_f32 v18, v18
    v_mfma_f32_16x16x32_bf16 v[148:151], v[192:195], a[228:231], v[148:151]
    ds_read_b64_tr_b16 v[212:213], v29 offset:26624
    v_mul_f32 v129, v129, v17
    v_mfma_f32_16x16x32_bf16 v[152:155], v[216:219], a[200:203], v[152:155]
    v_rcp_f32 v16, v16
    v_mfma_f32_16x16x32_bf16 v[152:155], v[220:223], a[216:219], v[152:155]
    ds_read_b64_tr_b16 v[214:215], v29 offset:32768
    v_mul_f32 v130, v130, v18
    v_mfma_f32_16x16x32_bf16 v[152:155], v[192:195], a[232:235], v[152:155]
    v_exp_f32 v17, -v132
    v_mfma_f32_16x16x32_bf16 v[156:159], v[216:219], a[204:207], v[156:159]
    ds_read_b64_tr_b16 v[216:217], v29 offset:28672
    v_mul_f32 v131, v131, v16
    v_mfma_f32_16x16x32_bf16 v[156:159], v[220:223], a[220:223], v[156:159]
    v_exp_f32 v18, -v133
    v_mfma_f32_16x16x32_bf16 v[156:159], v[192:195], a[236:239], v[156:159]
    s_waitcnt lgkmcnt(5)
    ds_read_b64_tr_b16 v[218:219], v29 offset:34816
    v_add_f32 v17, 1.0, v17
    v_mfma_f32_16x16x32_bf16 v[156:159], v[196:199], a[252:255], v[156:159]
    v_rcp_f32 v17, v17
    v_mfma_f32_16x16x32_bf16 v[156:159], v[200:203], v[236:239], v[156:159]
    ds_read_b64_tr_b16 v[220:221], v29 offset:36864
    v_mul_f32 v132, v132, v17
    v_mfma_f32_16x16x32_bf16 v[156:159], v[204:207], v[252:255], v[156:159]
    v_exp_f32 v16, -v134
    v_mfma_f32_16x16x32_bf16 v[152:155], v[196:199], a[248:251], v[152:155]
    ds_read_b64_tr_b16 v[222:223], v29 offset:43008
    v_add_f32 v18, 1.0, v18
    v_mfma_f32_16x16x32_bf16 v[152:155], v[200:203], v[232:235], v[152:155]
    v_rcp_f32 v18, v18
    v_mfma_f32_16x16x32_bf16 v[152:155], v[204:207], v[248:251], v[152:155]
    ds_read_b64_tr_b16 v[192:193], v29 offset:38912
    v_mul_f32 v133, v133, v18
    v_mfma_f32_16x16x32_bf16 v[148:151], v[196:199], a[244:247], v[148:151]
    v_exp_f32 v17, -v135
    v_mfma_f32_16x16x32_bf16 v[148:151], v[200:203], v[228:231], v[148:151]
    ds_read_b64_tr_b16 v[194:195], v29 offset:45056
    v_add_f32 v16, 1.0, v16
    v_mfma_f32_16x16x32_bf16 v[148:151], v[204:207], v[244:247], v[148:151]
    v_rcp_f32 v16, v16
    v_mfma_f32_16x16x32_bf16 v[144:147], v[196:199], a[240:243], v[144:147]
    ds_read_b64_tr_b16 v[196:197], v29 offset:40960
    v_mul_f32 v134, v134, v16
    v_mfma_f32_16x16x32_bf16 v[144:147], v[200:203], v[224:227], v[144:147]
    v_exp_f32 v18, -v136
    v_mfma_f32_16x16x32_bf16 v[144:147], v[204:207], v[240:243], v[144:147]
    s_waitcnt lgkmcnt(5)
    ds_read_b64_tr_b16 v[198:199], v29 offset:47104
    v_xor_b32 v28, 96, v12
    v_mfma_f32_16x16x32_bf16 v[32:35], v[208:211], a[96:99], v[32:35]
    v_exp_f32 v16, -v137
    v_mfma_f32_16x16x32_bf16 v[32:35], v[212:215], a[112:115], v[32:35]
    ds_read_b64_tr_b16 v[200:201], v28 offset:0
    v_add_f32 v17, 1.0, v17
    v_mfma_f32_16x16x32_bf16 v[32:35], v[216:219], a[128:131], v[32:35]
    v_rcp_f32 v17, v17
    v_mfma_f32_16x16x32_bf16 v[36:39], v[208:211], a[100:103], v[36:39]
    ds_read_b64_tr_b16 v[202:203], v28 offset:6144
    v_mul_f32 v135, v135, v17
    v_mfma_f32_16x16x32_bf16 v[36:39], v[212:215], a[116:119], v[36:39]
    v_exp_f32 v17, -v138
    v_mfma_f32_16x16x32_bf16 v[36:39], v[216:219], a[132:135], v[36:39]
    ds_read_b64_tr_b16 v[204:205], v28 offset:2048
    v_add_f32 v18, 1.0, v18
    v_mfma_f32_16x16x32_bf16 v[40:43], v[208:211], a[104:107], v[40:43]
    v_rcp_f32 v18, v18
    v_mfma_f32_16x16x32_bf16 v[40:43], v[212:215], a[120:123], v[40:43]
    ds_read_b64_tr_b16 v[206:207], v28 offset:8192
    v_mul_f32 v136, v136, v18
    v_mfma_f32_16x16x32_bf16 v[40:43], v[216:219], a[136:139], v[40:43]
    v_exp_f32 v18, -v139
    v_mfma_f32_16x16x32_bf16 v[44:47], v[208:211], a[108:111], v[44:47]
    ds_read_b64_tr_b16 v[208:209], v28 offset:4096
    v_add_f32 v16, 1.0, v16
    v_mfma_f32_16x16x32_bf16 v[44:47], v[212:215], a[124:127], v[44:47]
    v_rcp_f32 v16, v16
    v_mfma_f32_16x16x32_bf16 v[44:47], v[216:219], a[140:143], v[44:47]
    s_waitcnt lgkmcnt(5)
    ds_read_b64_tr_b16 v[210:211], v28 offset:10240
    v_mul_f32 v137, v137, v16
    v_mfma_f32_16x16x32_bf16 v[48:51], v[220:223], a[96:99], v[48:51]
    v_exp_f32 v16, -v140
    v_mfma_f32_16x16x32_bf16 v[48:51], v[192:195], a[112:115], v[48:51]
    ds_read_b64_tr_b16 v[212:213], v28 offset:24576
    v_add_f32 v17, 1.0, v17
    v_mfma_f32_16x16x32_bf16 v[48:51], v[196:199], a[128:131], v[48:51]
    v_rcp_f32 v17, v17
    v_mfma_f32_16x16x32_bf16 v[52:55], v[220:223], a[100:103], v[52:55]
    ds_read_b64_tr_b16 v[214:215], v28 offset:30720
    v_mul_f32 v138, v138, v17
    v_mfma_f32_16x16x32_bf16 v[52:55], v[192:195], a[116:119], v[52:55]
    v_exp_f32 v17, -v141
    v_mfma_f32_16x16x32_bf16 v[52:55], v[196:199], a[132:135], v[52:55]
    ds_read_b64_tr_b16 v[216:217], v28 offset:26624
    v_add_f32 v18, 1.0, v18
    v_mfma_f32_16x16x32_bf16 v[56:59], v[220:223], a[104:107], v[56:59]
    v_rcp_f32 v18, v18
    v_mfma_f32_16x16x32_bf16 v[56:59], v[192:195], a[120:123], v[56:59]
    ds_read_b64_tr_b16 v[218:219], v28 offset:32768
    v_mul_f32 v139, v139, v18
    v_mfma_f32_16x16x32_bf16 v[56:59], v[196:199], a[136:139], v[56:59]
    v_exp_f32 v18, -v142
    v_mfma_f32_16x16x32_bf16 v[60:63], v[220:223], a[108:111], v[60:63]
    ds_read_b64_tr_b16 v[220:221], v28 offset:28672
    v_add_f32 v16, 1.0, v16
    v_mfma_f32_16x16x32_bf16 v[60:63], v[192:195], a[124:127], v[60:63]
    v_rcp_f32 v16, v16
    v_mfma_f32_16x16x32_bf16 v[60:63], v[196:199], a[140:143], v[60:63]
    s_waitcnt lgkmcnt(5)
    ds_read_b64_tr_b16 v[222:223], v28 offset:34816
    v_xor_b32 v25, 49248, v12
    v_mfma_f32_16x16x32_bf16 v[32:35], v[200:203], a[144:147], v[32:35]
    v_mul_f32 v140, v140, v16
    v_add_f32 v17, 1.0, v17
    v_mfma_f32_16x16x32_bf16 v[32:35], v[204:207], a[160:163], v[32:35]
    ds_read_b64_tr_b16 v[192:193], v25 offset:0
    v_add_f32 v18, 1.0, v18
    v_mfma_f32_16x16x32_bf16 v[32:35], v[208:211], a[176:179], v[32:35]
    s_waitcnt vmcnt(20)
    s_barrier
    v_mul_f32 v144, v144, v128
    v_mfma_f32_16x16x32_bf16 v[36:39], v[200:203], a[148:151], v[36:39]
    ds_read_b64_tr_b16 v[194:195], v25 offset:6144
    v_mul_f32 v145, v145, v129
    v_mfma_f32_16x16x32_bf16 v[36:39], v[204:207], a[164:167], v[36:39]
    v_rcp_f32 v17, v17
    v_mfma_f32_16x16x32_bf16 v[36:39], v[208:211], a[180:183], v[36:39]
    s_mov_b32 s49, 36864
    ds_read_b64_tr_b16 v[196:197], v25 offset:2048
    v_mul_f32 v141, v141, v17
    v_mfma_f32_16x16x32_bf16 v[40:43], v[200:203], a[152:155], v[40:43]
    v_rcp_f32 v18, v18
    v_mfma_f32_16x16x32_bf16 v[40:43], v[204:207], a[168:171], v[40:43]
    s_add_u32 m0, s31, 110592
    ds_read_b64_tr_b16 v[198:199], v25 offset:8192
    v_mul_f32 v142, v142, v18
    v_mfma_f32_16x16x32_bf16 v[40:43], v[208:211], a[184:187], v[40:43]
    buffer_load_dwordx4 v20, s[20:23], s49 offen offset:0 sc1 lds
    v_mfma_f32_16x16x32_bf16 v[44:47], v[200:203], a[156:159], v[44:47]
    ds_read_b64_tr_b16 v[200:201], v25 offset:4096
    v_mul_f32 v146, v146, v130
    v_mfma_f32_16x16x32_bf16 v[44:47], v[204:207], a[172:175], v[44:47]
    v_exp_f32 v16, -v143
    v_mfma_f32_16x16x32_bf16 v[44:47], v[208:211], a[188:191], v[44:47]
    s_waitcnt lgkmcnt(5)
    ds_read_b64_tr_b16 v[202:203], v25 offset:10240
    v_add_f32 v16, 1.0, v16
    v_mfma_f32_16x16x32_bf16 v[44:47], v[212:215], a[204:207], v[44:47]
    buffer_load_dwordx4 v20, s[20:23], s49 offen offset:1024 sc1 lds
    v_mfma_f32_16x16x32_bf16 v[44:47], v[216:219], a[220:223], v[44:47]
    ds_read_b64_tr_b16 v[204:205], v28 offset:12288
    v_mul_f32 v147, v147, v131
    v_mfma_f32_16x16x32_bf16 v[44:47], v[220:223], a[236:239], v[44:47]
    v_rcp_f32 v16, v16
    v_mfma_f32_16x16x32_bf16 v[40:43], v[212:215], a[200:203], v[40:43]
    ds_read_b64_tr_b16 v[206:207], v28 offset:18432
    v_mul_f32 v143, v143, v16
    v_mfma_f32_16x16x32_bf16 v[40:43], v[216:219], a[216:219], v[40:43]
    buffer_load_dwordx4 v20, s[20:23], s49 offen offset:2048 sc1 lds
    v_add_u32 v24, 2, v24
    v_mfma_f32_16x16x32_bf16 v[40:43], v[220:223], a[232:235], v[40:43]
    s_waitcnt vmcnt(3)
    ds_read_b64_tr_b16 v[208:209], v28 offset:14336
    v_mul_f32 v148, v148, v132
    v_mfma_f32_16x16x32_bf16 v[36:39], v[212:215], a[196:199], v[36:39]
    buffer_store_dword v24, v23, s[12:15], s44 offen sc1
    v_mul_f32 v149, v149, v133
    v_mul_f32 v150, v150, v134
    v_mfma_f32_16x16x32_bf16 v[36:39], v[216:219], a[212:215], v[36:39]
    ds_read_b64_tr_b16 v[210:211], v28 offset:20480
    v_mul_f32 v151, v151, v135
    v_mfma_f32_16x16x32_bf16 v[36:39], v[220:223], a[228:231], v[36:39]
    s_add_u32 s52, s41, 28672
    v_cvt_pk_bf16_f32 v128, v144, v145
    v_cvt_pk_bf16_f32 v129, v146, v147
    v_mfma_f32_16x16x32_bf16 v[32:35], v[212:215], a[192:195], v[32:35]
    ds_read_b64_tr_b16 v[212:213], v28 offset:16384
    v_cvt_pk_bf16_f32 v130, v148, v149
    v_cvt_pk_bf16_f32 v131, v150, v151
    v_mfma_f32_16x16x32_bf16 v[32:35], v[216:219], a[208:211], v[32:35]
    buffer_load_dwordx4 v20, s[20:23], s49 offen offset:3072 sc1 lds
    v_mfma_f32_16x16x32_bf16 v[32:35], v[220:223], a[224:227], v[32:35]
    s_waitcnt lgkmcnt(5)
    ds_read_b64_tr_b16 v[214:215], v28 offset:22528
    v_permlane16_swap_b32 v128, v130
    v_mfma_f32_16x16x32_bf16 v[32:35], v[192:195], a[240:243], v[32:35]
    v_permlane16_swap_b32 v129, v131
    v_mfma_f32_16x16x32_bf16 v[32:35], v[196:199], v[224:227], v[32:35]
    s_mov_b32 s49, 40960
    ds_read_b64_tr_b16 v[216:217], v28 offset:36864
    v_mul_f32 v152, v152, v136
    v_mul_f32 v153, v153, v137
    v_mfma_f32_16x16x32_bf16 v[32:35], v[200:203], v[240:243], v[32:35]
    buffer_store_dwordx4 v[128:131], v10, s[36:39], s52 offen sc1
    v_mul_f32 v154, v154, v138
    v_mfma_f32_16x16x32_bf16 v[36:39], v[192:195], a[244:247], v[36:39]
    s_add_u32 m0, s31, 114688
    ds_read_b64_tr_b16 v[218:219], v28 offset:43008
    v_mul_f32 v155, v155, v139
    v_mul_f32 v156, v156, v140
    v_mfma_f32_16x16x32_bf16 v[36:39], v[196:199], v[228:231], v[36:39]
    buffer_load_dwordx4 v20, s[20:23], s49 offen offset:0 sc1 lds
    v_mfma_f32_16x16x32_bf16 v[36:39], v[200:203], v[244:247], v[36:39]
    ds_read_b64_tr_b16 v[220:221], v28 offset:38912
    v_mul_f32 v157, v157, v141
    v_mul_f32 v158, v158, v142
    v_mfma_f32_16x16x32_bf16 v[40:43], v[192:195], a[248:251], v[40:43]
    s_add_u32 s100, s41, 28672
    v_mul_f32 v159, v159, v143
    v_cvt_pk_bf16_f32 v136, v152, v153
    v_mfma_f32_16x16x32_bf16 v[40:43], v[196:199], v[232:235], v[40:43]
    ds_read_b64_tr_b16 v[222:223], v28 offset:45056
    v_cvt_pk_bf16_f32 v137, v154, v155
    v_cvt_pk_bf16_f32 v138, v156, v157
    v_mfma_f32_16x16x32_bf16 v[40:43], v[200:203], v[248:251], v[40:43]
    buffer_load_dwordx4 v20, s[20:23], s49 offen offset:1024 sc1 lds
    v_mfma_f32_16x16x32_bf16 v[44:47], v[192:195], a[252:255], v[44:47]
    ds_read_b64_tr_b16 v[192:193], v28 offset:40960
    v_permlane16_swap_b32 v136, v138
    v_mfma_f32_16x16x32_bf16 v[44:47], v[196:199], v[236:239], v[44:47]
    v_cvt_pk_bf16_f32 v139, v158, v159
    v_mfma_f32_16x16x32_bf16 v[44:47], v[200:203], v[252:255], v[44:47]
    s_waitcnt lgkmcnt(5)
    ds_read_b64_tr_b16 v[194:195], v28 offset:47104
    v_mfma_f32_16x16x32_bf16 v[48:51], v[204:207], a[144:147], v[48:51]
    buffer_load_dwordx4 v20, s[20:23], s49 offen offset:2048 sc1 lds
    v_mfma_f32_16x16x32_bf16 v[48:51], v[208:211], a[160:163], v[48:51]
    ds_read_b64_tr_b16 v[196:197], v25 offset:12288
    v_permlane16_swap_b32 v137, v139
    v_mfma_f32_16x16x32_bf16 v[48:51], v[212:215], a[176:179], v[48:51]
    v_mfma_f32_16x16x32_bf16 v[52:55], v[204:207], a[148:151], v[52:55]
    ds_read_b64_tr_b16 v[198:199], v25 offset:18432
    v_mfma_f32_16x16x32_bf16 v[52:55], v[208:211], a[164:167], v[52:55]
    buffer_store_dwordx4 v[136:139], v11, s[36:39], s100 offen sc1
    v_mfma_f32_16x16x32_bf16 v[52:55], v[212:215], a[180:183], v[52:55]
    ds_read_b64_tr_b16 v[200:201], v25 offset:14336
    v_mfma_f32_16x16x32_bf16 v[56:59], v[204:207], a[152:155], v[56:59]
    buffer_load_dwordx4 v20, s[20:23], s49 offen offset:3072 sc1 lds
    v_mfma_f32_16x16x32_bf16 v[56:59], v[208:211], a[168:171], v[56:59]
    s_mov_b32 s49, 45056
    ds_read_b64_tr_b16 v[202:203], v25 offset:20480
    v_mfma_f32_16x16x32_bf16 v[56:59], v[212:215], a[184:187], v[56:59]
    v_exp_f32 v16, -v32
    v_mfma_f32_16x16x32_bf16 v[60:63], v[204:207], a[156:159], v[60:63]
    s_add_u32 m0, s31, 118784
    ds_read_b64_tr_b16 v[204:205], v25 offset:16384
    v_exp_f32 v17, -v33
    v_mfma_f32_16x16x32_bf16 v[60:63], v[208:211], a[172:175], v[60:63]
    buffer_load_dwordx4 v20, s[20:23], s49 offen offset:0 sc1 lds
    v_mfma_f32_16x16x32_bf16 v[60:63], v[212:215], a[188:191], v[60:63]
    s_waitcnt lgkmcnt(5)
    ds_read_b64_tr_b16 v[206:207], v25 offset:22528
    v_exp_f32 v18, -v34
    v_mfma_f32_16x16x32_bf16 v[60:63], v[216:219], a[204:207], v[60:63]
    v_add_f32 v16, 1.0, v16
    v_add_f32 v17, 1.0, v17
    v_mfma_f32_16x16x32_bf16 v[60:63], v[220:223], a[220:223], v[60:63]
    s_add_u32 s51, s42, 16384
    ds_read_b128 v[208:211], v21 offset:8192
    v_rcp_f32 v16, v16
    v_mfma_f32_16x16x32_bf16 v[60:63], v[192:195], a[236:239], v[60:63]
    buffer_load_dwordx4 a[96:99], v4, s[36:39], s51 offen offset:0 sc1
    v_mfma_f32_16x16x32_bf16 v[56:59], v[216:219], a[200:203], v[56:59]
    ds_read_b128 v[212:215], v21 offset:9216
    v_rcp_f32 v17, v17
    v_mfma_f32_16x16x32_bf16 v[56:59], v[220:223], a[216:219], v[56:59]
    v_mul_f32 v32, v32, v16
    v_mul_f32 v33, v33, v17
    v_mfma_f32_16x16x32_bf16 v[56:59], v[192:195], a[232:235], v[56:59]
    buffer_load_dwordx4 a[100:103], v4, s[36:39], s51 offen offset:1024 sc1
    v_add_f32 v18, 1.0, v18
    v_mfma_f32_16x16x32_bf16 v[52:55], v[216:219], a[196:199], v[52:55]
    v_rcp_f32 v18, v18
    v_mfma_f32_16x16x32_bf16 v[52:55], v[220:223], a[212:215], v[52:55]
    v_exp_f32 v16, -v35
    v_mul_f32 v34, v34, v18
    v_mfma_f32_16x16x32_bf16 v[52:55], v[192:195], a[228:231], v[52:55]
    v_exp_f32 v17, -v36
    v_mfma_f32_16x16x32_bf16 v[48:51], v[216:219], a[192:195], v[48:51]
    ds_read_b128 v[216:219], v21 offset:10240
    v_exp_f32 v18, -v37
    v_mfma_f32_16x16x32_bf16 v[48:51], v[220:223], a[208:211], v[48:51]
    buffer_load_dwordx4 a[104:107], v4, s[36:39], s51 offen offset:2048 sc1
    v_mfma_f32_16x16x32_bf16 v[48:51], v[192:195], a[224:227], v[48:51]
    s_waitcnt lgkmcnt(3)
    ds_read_b128 v[220:223], v21 offset:11264
    v_add_f32 v16, 1.0, v16
    v_add_f32 v17, 1.0, v17
    v_mfma_f32_16x16x32_bf16 v[48:51], v[196:199], a[240:243], v[48:51]
    v_rcp_f32 v16, v16
    v_mfma_f32_16x16x32_bf16 v[48:51], v[200:203], v[224:227], v[48:51]
    ds_read_b128 v[192:195], v21 offset:12288
    v_rcp_f32 v17, v17
    v_mfma_f32_16x16x32_bf16 v[48:51], v[204:207], v[240:243], v[48:51]
    v_mul_f32 v35, v35, v16
    v_mul_f32 v36, v36, v17
    v_mfma_f32_16x16x32_bf16 v[52:55], v[196:199], a[244:247], v[52:55]
    buffer_load_dwordx4 a[108:111], v4, s[36:39], s51 offen offset:3072 sc1
    v_add_f32 v18, 1.0, v18
    v_mfma_f32_16x16x32_bf16 v[52:55], v[200:203], v[228:231], v[52:55]
    v_rcp_f32 v18, v18
    v_mfma_f32_16x16x32_bf16 v[52:55], v[204:207], v[244:247], v[52:55]
    v_exp_f32 v16, -v38
    v_mul_f32 v37, v37, v18
    v_mfma_f32_16x16x32_bf16 v[56:59], v[196:199], a[248:251], v[56:59]
    v_exp_f32 v17, -v39
    v_mfma_f32_16x16x32_bf16 v[56:59], v[200:203], v[232:235], v[56:59]
    v_exp_f32 v18, -v40
    v_add_f32 v16, 1.0, v16
    v_mfma_f32_16x16x32_bf16 v[56:59], v[204:207], v[248:251], v[56:59]
    buffer_load_dwordx4 a[112:115], v19, s[36:39], s51 offen offset:0 sc1
    v_mfma_f32_16x16x32_bf16 v[60:63], v[196:199], a[252:255], v[60:63]
    ds_read_b128 v[196:199], v21 offset:13312
    v_rcp_f32 v16, v16
    v_mfma_f32_16x16x32_bf16 v[60:63], v[200:203], v[236:239], v[60:63]
    v_mul_f32 v38, v38, v16
    v_add_f32 v17, 1.0, v17
    v_mfma_f32_16x16x32_bf16 v[60:63], v[204:207], v[252:255], v[60:63]
    s_waitcnt vmcnt(55) lgkmcnt(2)
    ds_read_b128 v[200:203], v21 offset:14336
    v_rcp_f32 v17, v17
    v_mfma_f32_16x16x32_bf16 v[64:67], v[208:211], v[160:163], 0
    v_exp_f32 v16, -v41
    v_mfma_f32_16x16x32_bf16 v[64:67], v[212:215], v[164:167], v[64:67]
    ds_read_b128 v[204:207], v21 offset:15360
    v_mul_f32 v39, v39, v17
    v_add_f32 v18, 1.0, v18
    v_mfma_f32_16x16x32_bf16 v[68:71], v[208:211], v[176:179], 0
    s_barrier
    v_rcp_f32 v18, v18
    v_mfma_f32_16x16x32_bf16 v[68:71], v[212:215], v[180:183], v[68:71]
    ds_read_b128 v[208:211], v21 offset:16384
    v_exp_f32 v17, -v42
    v_mfma_f32_16x16x32_bf16 v[68:71], v[216:219], v[184:187], v[68:71]
    buffer_load_dwordx4 a[116:119], v19, s[36:39], s51 offen offset:1024 sc1
    v_mfma_f32_16x16x32_bf16 v[68:71], v[220:223], v[188:191], v[68:71]
    ds_read_b128 v[212:215], v21 offset:17408
    v_mul_f32 v40, v40, v18
    v_add_f32 v16, 1.0, v16
    v_mfma_f32_16x16x32_bf16 v[64:67], v[216:219], v[168:171], v[64:67]
    v_rcp_f32 v16, v16
    v_mfma_f32_16x16x32_bf16 v[64:67], v[220:223], v[172:175], v[64:67]
    s_waitcnt lgkmcnt(2)
    ds_read_b128 v[216:219], v21 offset:18432
    v_exp_f32 v18, -v43
    v_mfma_f32_16x16x32_bf16 v[72:75], v[192:195], v[160:163], 0
    buffer_load_dwordx4 a[120:123], v19, s[36:39], s51 offen offset:2048 sc1
    v_mfma_f32_16x16x32_bf16 v[72:75], v[196:199], v[164:167], v[72:75]
    ds_read_b128 v[220:223], v21 offset:19456
    v_mul_f32 v41, v41, v16
    v_add_f32 v17, 1.0, v17
    v_mfma_f32_16x16x32_bf16 v[76:79], v[192:195], v[176:179], 0
    v_rcp_f32 v17, v17
    v_mfma_f32_16x16x32_bf16 v[76:79], v[196:199], v[180:183], v[76:79]
    ds_read_b128 v[192:195], v21 offset:20480
    v_exp_f32 v16, -v44
    v_mfma_f32_16x16x32_bf16 v[76:79], v[200:203], v[184:187], v[76:79]
    buffer_load_dwordx4 a[124:127], v19, s[36:39], s51 offen offset:3072 sc1
    v_mfma_f32_16x16x32_bf16 v[76:79], v[204:207], v[188:191], v[76:79]
    s_mov_b32 s49, 73728
    s_add_u32 m0, s31, 0
    ds_read_b128 v[196:199], v21 offset:21504
    v_mul_f32 v42, v42, v17
    v_mfma_f32_16x16x32_bf16 v[72:75], v[200:203], v[168:171], v[72:75]
    buffer_load_dwordx4 v20, s[20:23], s49 offen offset:0 sc1 lds
    v_mfma_f32_16x16x32_bf16 v[72:75], v[204:207], v[172:175], v[72:75]
    s_waitcnt lgkmcnt(2)
    ds_read_b128 v[200:203], v21 offset:22528
    v_exp_f32 v17, -v45
    v_mfma_f32_16x16x32_bf16 v[80:83], v[208:211], v[160:163], 0
    v_add_f32 v18, 1.0, v18
    v_add_f32 v16, 1.0, v16
    v_mfma_f32_16x16x32_bf16 v[80:83], v[212:215], v[164:167], v[80:83]
    ds_read_b128 v[204:207], v21 offset:23552
    v_rcp_f32 v18, v18
    v_mfma_f32_16x16x32_bf16 v[84:87], v[208:211], v[176:179], 0
    buffer_load_dwordx4 v20, s[20:23], s49 offen offset:1024 sc1 lds
    v_mfma_f32_16x16x32_bf16 v[84:87], v[212:215], v[180:183], v[84:87]
    ds_read_b128 v[208:211], v21 offset:24576
    v_rcp_f32 v16, v16
    v_mfma_f32_16x16x32_bf16 v[84:87], v[216:219], v[184:187], v[84:87]
    v_mul_f32 v43, v43, v18
    v_mul_f32 v44, v44, v16
    v_mfma_f32_16x16x32_bf16 v[84:87], v[220:223], v[188:191], v[84:87]
    ds_read_b128 v[212:215], v21 offset:25600
    v_exp_f32 v18, -v46
    v_mfma_f32_16x16x32_bf16 v[80:83], v[216:219], v[168:171], v[80:83]
    buffer_load_dwordx4 v20, s[20:23], s49 offen offset:2048 sc1 lds
    v_mfma_f32_16x16x32_bf16 v[80:83], v[220:223], v[172:175], v[80:83]
    s_waitcnt lgkmcnt(2)
    ds_read_b128 v[216:219], v21 offset:26624
    v_exp_f32 v16, -v47
    v_mfma_f32_16x16x32_bf16 v[88:91], v[192:195], v[160:163], 0
    v_add_f32 v17, 1.0, v17
    v_add_f32 v18, 1.0, v18
    v_mfma_f32_16x16x32_bf16 v[88:91], v[196:199], v[164:167], v[88:91]
    ds_read_b128 v[220:223], v21 offset:27648
    v_rcp_f32 v17, v17
    v_mfma_f32_16x16x32_bf16 v[92:95], v[192:195], v[176:179], 0
    v_rcp_f32 v18, v18
    v_mfma_f32_16x16x32_bf16 v[92:95], v[196:199], v[180:183], v[92:95]
    ds_read_b128 v[192:195], v21 offset:28672
    v_mul_f32 v45, v45, v17
    v_mul_f32 v46, v46, v18
    v_mfma_f32_16x16x32_bf16 v[92:95], v[200:203], v[184:187], v[92:95]
    buffer_load_dwordx4 v20, s[20:23], s49 offen offset:3072 sc1 lds
    v_mfma_f32_16x16x32_bf16 v[92:95], v[204:207], v[188:191], v[92:95]
    s_mov_b32 s49, 77824
    s_add_u32 m0, s31, 4096
    ds_read_b128 v[196:199], v21 offset:29696
    v_add_f32 v16, 1.0, v16
    v_mfma_f32_16x16x32_bf16 v[88:91], v[200:203], v[168:171], v[88:91]
    v_rcp_f32 v16, v16
    v_mfma_f32_16x16x32_bf16 v[88:91], v[204:207], v[172:175], v[88:91]
    s_waitcnt lgkmcnt(2)
    ds_read_b128 v[200:203], v21 offset:30720
    v_mul_f32 v47, v47, v16
    v_mul_f32 v48, v48, v32
    v_mfma_f32_16x16x32_bf16 v[96:99], v[208:211], v[160:163], 0
    buffer_load_dwordx4 v20, s[20:23], s49 offen offset:0 sc1 lds
    v_mfma_f32_16x16x32_bf16 v[96:99], v[212:215], v[164:167], v[96:99]
    ds_read_b128 v[204:207], v21 offset:31744
    v_mul_f32 v49, v49, v33
    v_mul_f32 v50, v50, v34
    v_mfma_f32_16x16x32_bf16 v[100:103], v[208:211], v[176:179], 0
    v_mul_f32 v51, v51, v35
    v_mul_f32 v52, v52, v36
    v_mfma_f32_16x16x32_bf16 v[100:103], v[212:215], v[180:183], v[100:103]
    ds_read_b128 v[208:211], v21 offset:32768
    v_mul_f32 v53, v53, v37
    v_mul_f32 v54, v54, v38
    v_mfma_f32_16x16x32_bf16 v[100:103], v[216:219], v[184:187], v[100:103]
    s_add_u32 s52, s41, 32768
    v_mul_f32 v55, v55, v39
    v_cvt_pk_bf16_f32 v32, v48, v49
    v_mfma_f32_16x16x32_bf16 v[100:103], v[220:223], v[188:191], v[100:103]
    ds_read_b128 v[212:215], v21 offset:33792
    v_cvt_pk_bf16_f32 v33, v50, v51
    v_cvt_pk_bf16_f32 v34, v52, v53
    v_mfma_f32_16x16x32_bf16 v[96:99], v[216:219], v[168:171], v[96:99]
    buffer_load_dwordx4 v20, s[20:23], s49 offen offset:1024 sc1 lds
    v_mfma_f32_16x16x32_bf16 v[96:99], v[220:223], v[172:175], v[96:99]
    s_waitcnt lgkmcnt(2)
    ds_read_b128 v[216:219], v21 offset:34816
    v_permlane16_swap_b32 v32, v34
    v_mfma_f32_16x16x32_bf16 v[104:107], v[192:195], v[160:163], 0
    v_cvt_pk_bf16_f32 v35, v54, v55
    v_mul_f32 v56, v56, v40
    v_mfma_f32_16x16x32_bf16 v[104:107], v[196:199], v[164:167], v[104:107]
    ds_read_b128 v[220:223], v21 offset:35840
    v_mul_f32 v57, v57, v41
    v_mul_f32 v58, v58, v42
    v_mfma_f32_16x16x32_bf16 v[108:111], v[192:195], v[176:179], 0
    buffer_load_dwordx4 v20, s[20:23], s49 offen offset:2048 sc1 lds
    v_mfma_f32_16x16x32_bf16 v[108:111], v[196:199], v[180:183], v[108:111]
    ds_read_b128 v[192:195], v21 offset:36864
    v_permlane16_swap_b32 v33, v35
    v_mfma_f32_16x16x32_bf16 v[108:111], v[200:203], v[184:187], v[108:111]
    buffer_store_dwordx4 v[32:35], v10, s[36:39], s52 offen sc1
    v_mul_f32 v59, v59, v43
    v_mfma_f32_16x16x32_bf16 v[108:111], v[204:207], v[188:191], v[108:111]
    ds_read_b128 v[196:199], v21 offset:37888
    v_mul_f32 v60, v60, v44
    v_mul_f32 v61, v61, v45
    v_mfma_f32_16x16x32_bf16 v[104:107], v[200:203], v[168:171], v[104:107]
    v_mul_f32 v62, v62, v46
    v_mul_f32 v63, v63, v47
    v_mfma_f32_16x16x32_bf16 v[104:107], v[204:207], v[172:175], v[104:107]
    s_waitcnt lgkmcnt(2)
    ds_read_b128 v[200:203], v21 offset:38912
    v_cvt_pk_bf16_f32 v40, v56, v57
    v_cvt_pk_bf16_f32 v41, v58, v59
    v_mfma_f32_16x16x32_bf16 v[112:115], v[208:211], v[160:163], 0
    buffer_load_dwordx4 v20, s[20:23], s49 offen offset:3072 sc1 lds
    v_mfma_f32_16x16x32_bf16 v[112:115], v[212:215], v[164:167], v[112:115]
    s_mov_b32 s49, 81920
    ds_read_b128 v[204:207], v21 offset:39936
    v_cvt_pk_bf16_f32 v42, v60, v61
    v_cvt_pk_bf16_f32 v43, v62, v63
    v_mfma_f32_16x16x32_bf16 v[116:119], v[208:211], v[176:179], 0
    buffer_load_dword v31, v13, s[12:15], s47 offen sc1
    v_mfma_f32_16x16x32_bf16 v[116:119], v[212:215], v[180:183], v[116:119]
    s_add_u32 m0, s31, 8192
    ds_read_b128 v[208:211], v21 offset:40960
    v_permlane16_swap_b32 v40, v42
    v_mfma_f32_16x16x32_bf16 v[116:119], v[216:219], v[184:187], v[116:119]
    buffer_load_dwordx4 v20, s[20:23], s49 offen offset:0 sc1 lds
    v_mfma_f32_16x16x32_bf16 v[116:119], v[220:223], v[188:191], v[116:119]
    s_mov_b32 s49, 110592
    s_add_u32 m0, s31, 36864
    s_add_u32 s100, s41, 32768
    ds_read_b128 v[212:215], v21 offset:41984
    v_mfma_f32_16x16x32_bf16 v[112:115], v[216:219], v[168:171], v[112:115]
    s_waitcnt vmcnt(19)
    s_barrier
    v_mfma_f32_16x16x32_bf16 v[112:115], v[220:223], v[172:175], v[112:115]
    s_waitcnt vmcnt(61) lgkmcnt(2)
    ds_read_b128 v[216:219], v21 offset:43008
    v_permlane16_swap_b32 v41, v43
    v_mfma_f32_16x16x32_bf16 v[64:67], v[192:195], a[0:3], v[64:67]
    buffer_load_dwordx4 v20, s[20:23], s49 offen offset:0 sc1 lds
    v_mfma_f32_16x16x32_bf16 v[64:67], v[196:199], a[4:7], v[64:67]
    ds_read_b128 v[220:223], v21 offset:44032
    v_mfma_f32_16x16x32_bf16 v[68:71], v[192:195], a[16:19], v[68:71]
    buffer_store_dwordx4 v[40:43], v11, s[36:39], s100 offen sc1
    v_mfma_f32_16x16x32_bf16 v[68:71], v[196:199], a[20:23], v[68:71]
    ds_read_b128 v[192:195], v21 offset:45056
    v_mfma_f32_16x16x32_bf16 v[68:71], v[200:203], a[24:27], v[68:71]
    buffer_load_dwordx4 v20, s[20:23], s49 offen offset:1024 sc1 lds
    v_mfma_f32_16x16x32_bf16 v[68:71], v[204:207], a[28:31], v[68:71]
    ds_read_b128 v[196:199], v21 offset:46080
    v_mfma_f32_16x16x32_bf16 v[64:67], v[200:203], a[8:11], v[64:67]
    v_mfma_f32_16x16x32_bf16 v[64:67], v[204:207], a[12:15], v[64:67]
    s_waitcnt lgkmcnt(2)
    ds_read_b128 v[200:203], v21 offset:47104
    v_mfma_f32_16x16x32_bf16 v[72:75], v[208:211], a[0:3], v[72:75]
    buffer_load_dwordx4 v20, s[20:23], s49 offen offset:2048 sc1 lds
    v_mfma_f32_16x16x32_bf16 v[72:75], v[212:215], a[4:7], v[72:75]
    ds_read_b128 v[204:207], v21 offset:48128
    v_mfma_f32_16x16x32_bf16 v[76:79], v[208:211], a[16:19], v[76:79]
    v_mfma_f32_16x16x32_bf16 v[76:79], v[212:215], a[20:23], v[76:79]
    ds_read_b128 v[208:211], v21 offset:49152
    v_mfma_f32_16x16x32_bf16 v[76:79], v[216:219], a[24:27], v[76:79]
    v_mfma_f32_16x16x32_bf16 v[76:79], v[220:223], a[28:31], v[76:79]
    ds_read_b128 v[212:215], v21 offset:50176
    v_mfma_f32_16x16x32_bf16 v[72:75], v[216:219], a[8:11], v[72:75]
    buffer_load_dwordx4 v20, s[20:23], s49 offen offset:3072 sc1 lds
    v_mfma_f32_16x16x32_bf16 v[72:75], v[220:223], a[12:15], v[72:75]
    s_waitcnt lgkmcnt(2)
    ds_read_b128 v[216:219], v21 offset:51200
    v_mfma_f32_16x16x32_bf16 v[80:83], v[192:195], a[0:3], v[80:83]
    v_mfma_f32_16x16x32_bf16 v[80:83], v[196:199], a[4:7], v[80:83]
    s_mov_b32 s49, 114688
    ds_read_b128 v[220:223], v21 offset:52224
Lhop9:
    s_cbranch_execz Lhopret
    v_mfma_f32_16x16x32_bf16 v[84:87], v[192:195], a[16:19], v[84:87]
    v_mfma_f32_16x16x32_bf16 v[84:87], v[196:199], a[20:23], v[84:87]
    s_add_u32 m0, s31, 40960
    ds_read_b128 v[192:195], v21 offset:53248
    v_mfma_f32_16x16x32_bf16 v[84:87], v[200:203], a[24:27], v[84:87]
    buffer_load_dwordx4 v20, s[20:23], s49 offen offset:0 sc1 lds
    v_mfma_f32_16x16x32_bf16 v[84:87], v[204:207], a[28:31], v[84:87]
    ds_read_b128 v[196:199], v21 offset:54272
    v_mfma_f32_16x16x32_bf16 v[80:83], v[200:203], a[8:11], v[80:83]
    v_mfma_f32_16x16x32_bf16 v[80:83], v[204:207], a[12:15], v[80:83]
    s_waitcnt lgkmcnt(2)
    ds_read_b128 v[200:203], v21 offset:55296
    v_mfma_f32_16x16x32_bf16 v[88:91], v[208:211], a[0:3], v[88:91]
    buffer_load_dwordx4 v20, s[20:23], s49 offen offset:1024 sc1 lds
    v_mfma_f32_16x16x32_bf16 v[88:91], v[212:215], a[4:7], v[88:91]
    ds_read_b128 v[204:207], v21 offset:56320
    v_mfma_f32_16x16x32_bf16 v[92:95], v[208:211], a[16:19], v[92:95]
    v_mfma_f32_16x16x32_bf16 v[92:95], v[212:215], a[20:23], v[92:95]
    ds_read_b128 v[208:211], v21 offset:57344
    v_mfma_f32_16x16x32_bf16 v[92:95], v[216:219], a[24:27], v[92:95]
    buffer_load_dwordx4 v20, s[20:23], s49 offen offset:2048 sc1 lds
    v_mfma_f32_16x16x32_bf16 v[92:95], v[220:223], a[28:31], v[92:95]
    ds_read_b128 v[212:215], v21 offset:58368
    v_mfma_f32_16x16x32_bf16 v[88:91], v[216:219], a[8:11], v[88:91]
    v_mfma_f32_16x16x32_bf16 v[88:91], v[220:223], a[12:15], v[88:91]
    s_waitcnt lgkmcnt(2)
    ds_read_b128 v[216:219], v21 offset:59392
    v_mfma_f32_16x16x32_bf16 v[96:99], v[192:195], a[0:3], v[96:99]
    v_mfma_f32_16x16x32_bf16 v[96:99], v[196:199], a[4:7], v[96:99]
    ds_read_b128 v[220:223], v21 offset:60416
    v_mfma_f32_16x16x32_bf16 v[100:103], v[192:195], a[16:19], v[100:103]
    buffer_load_dwordx4 v20, s[20:23], s49 offen offset:3072 sc1 lds
    v_mfma_f32_16x16x32_bf16 v[100:103], v[196:199], a[20:23], v[100:103]
    s_mov_b32 s49, 118784
    ds_read_b128 v[192:195], v21 offset:61440
    v_mfma_f32_16x16x32_bf16 v[100:103], v[200:203], a[24:27], v[100:103]
    v_mfma_f32_16x16x32_bf16 v[100:103], v[204:207], a[28:31], v[100:103]
    s_add_u32 m0, s31, 45056
    ds_read_b128 v[196:199], v21 offset:62464
    v_mfma_f32_16x16x32_bf16 v[96:99], v[200:203], a[8:11], v[96:99]
    buffer_load_dwordx4 v20, s[20:23], s49 offen offset:0 sc1 lds
    v_mfma_f32_16x16x32_bf16 v[96:99], v[204:207], a[12:15], v[96:99]
    s_waitcnt lgkmcnt(2)
    ds_read_b128 v[200:203], v21 offset:63488
    v_mfma_f32_16x16x32_bf16 v[104:107], v[208:211], a[0:3], v[104:107]
    v_mfma_f32_16x16x32_bf16 v[104:107], v[212:215], a[4:7], v[104:107]
    ds_read_b128 v[204:207], v21 offset:64512
    v_mfma_f32_16x16x32_bf16 v[108:111], v[208:211], a[16:19], v[108:111]
    v_mfma_f32_16x16x32_bf16 v[108:111], v[212:215], a[20:23], v[108:111]
    ds_read_b128 v[208:211], v22 offset:0
    v_mfma_f32_16x16x32_bf16 v[108:111], v[216:219], a[24:27], v[108:111]
    v_mfma_f32_16x16x32_bf16 v[108:111], v[220:223], a[28:31], v[108:111]
    ds_read_b128 v[212:215], v22 offset:1024
    v_mfma_f32_16x16x32_bf16 v[104:107], v[216:219], a[8:11], v[104:107]
    v_mfma_f32_16x16x32_bf16 v[104:107], v[220:223], a[12:15], v[104:107]
    s_waitcnt lgkmcnt(2)
    ds_read_b128 v[216:219], v22 offset:2048
    v_mfma_f32_16x16x32_bf16 v[112:115], v[192:195], a[0:3], v[112:115]
    v_mfma_f32_16x16x32_bf16 v[112:115], v[196:199], a[4:7], v[112:115]
    s_add_u32 s9, s6, 7
    ds_read_b128 v[220:223], v22 offset:3072
    v_mfma_f32_16x16x32_bf16 v[116:119], v[192:195], a[16:19], v[116:119]
    v_mfma_f32_16x16x32_bf16 v[116:119], v[196:199], a[20:23], v[116:119]
    s_waitcnt vmcnt(11)
    ds_read_b128 v[192:195], v22 offset:4096
    v_subrev_u32 v31, s9, v31
    v_mfma_f32_16x16x32_bf16 v[116:119], v[200:203], a[24:27], v[116:119]
    v_cmp_lt_u32 vcc, 2, v31
    v_mfma_f32_16x16x32_bf16 v[116:119], v[204:207], a[28:31], v[116:119]
    ds_read_b128 v[196:199], v22 offset:5120
    v_mfma_f32_16x16x32_bf16 v[112:115], v[200:203], a[8:11], v[112:115]
    s_cbranch_vccnz Lslow_28
Lback_29:
    v_mfma_f32_16x16x32_bf16 v[112:115], v[204:207], a[12:15], v[112:115]
    s_waitcnt vmcnt(52) lgkmcnt(2)
    ds_read_b128 v[200:203], v22 offset:6144
    v_mfma_f32_16x16x32_bf16 v[64:67], v[208:211], a[32:35], v[64:67]
    v_mfma_f32_16x16x32_bf16 v[64:67], v[212:215], a[36:39], v[64:67]
    s_add_u32 s51, s42, 20480
    ds_read_b128 v[204:207], v22 offset:7168
    v_mfma_f32_16x16x32_bf16 v[68:71], v[208:211], a[48:51], v[68:71]
    buffer_load_dwordx4 a[128:131], v4, s[36:39], s51 offen offset:0 sc1
    v_mfma_f32_16x16x32_bf16 v[68:71], v[212:215], a[52:55], v[68:71]
    ds_read_b128 v[208:211], v22 offset:8192
    v_mfma_f32_16x16x32_bf16 v[68:71], v[216:219], a[56:59], v[68:71]
    v_mfma_f32_16x16x32_bf16 v[68:71], v[220:223], a[60:63], v[68:71]
    ds_read_b128 v[212:215], v22 offset:9216
    v_mfma_f32_16x16x32_bf16 v[64:67], v[216:219], a[40:43], v[64:67]
    buffer_load_dwordx4 a[132:135], v4, s[36:39], s51 offen offset:1024 sc1
    v_add_u32 v24, 2, v24
    v_mfma_f32_16x16x32_bf16 v[64:67], v[220:223], a[44:47], v[64:67]
    s_waitcnt lgkmcnt(2)
    s_waitcnt vmcnt(10)
    ds_read_b128 v[216:219], v22 offset:10240
    v_mfma_f32_16x16x32_bf16 v[72:75], v[192:195], a[32:35], v[72:75]
    buffer_store_dword v24, v23, s[12:15], s44 offen sc1
    v_mfma_f32_16x16x32_bf16 v[72:75], v[196:199], a[36:39], v[72:75]
    ds_read_b128 v[220:223], v22 offset:11264
    v_mfma_f32_16x16x32_bf16 v[76:79], v[192:195], a[48:51], v[76:79]
    buffer_load_dwordx4 a[136:139], v4, s[36:39], s51 offen offset:2048 sc1
    v_mfma_f32_16x16x32_bf16 v[76:79], v[196:199], a[52:55], v[76:79]
    ds_read_b128 v[192:195], v22 offset:12288
    v_mfma_f32_16x16x32_bf16 v[76:79], v[200:203], a[56:59], v[76:79]
    v_mfma_f32_16x16x32_bf16 v[76:79], v[204:207], a[60:63], v[76:79]
    ds_read_b128 v[196:199], v22 offset:13312
    v_mfma_f32_16x16x32_bf16 v[72:75], v[200:203], a[40:43], v[72:75]
    s_waitcnt vmcnt(14)
    s_barrier
    v_mfma_f32_16x16x32_bf16 v[72:75], v[204:207], a[44:47], v[72:75]
    s_waitcnt lgkmcnt(2)
    ds_read_b128 v[200:203], v22 offset:14336
    v_mfma_f32_16x16x32_bf16 v[80:83], v[208:211], a[32:35], v[80:83]
    buffer_load_dwordx4 a[140:143], v4, s[36:39], s51 offen offset:3072 sc1
    v_mfma_f32_16x16x32_bf16 v[80:83], v[212:215], a[36:39], v[80:83]
    ds_read_b128 v[204:207], v22 offset:15360
    v_mfma_f32_16x16x32_bf16 v[84:87], v[208:211], a[48:51], v[84:87]
    v_mfma_f32_16x16x32_bf16 v[84:87], v[212:215], a[52:55], v[84:87]
    ds_read_b128 v[208:211], v4 offset:0
    v_mfma_f32_16x16x32_bf16 v[84:87], v[216:219], a[56:59], v[84:87]
    buffer_load_dwordx4 a[144:147], v19, s[36:39], s51 offen offset:0 sc1
    v_mfma_f32_16x16x32_bf16 v[84:87], v[220:223], a[60:63], v[84:87]
    ds_read_b128 v[212:215], v4 offset:1024
    v_mfma_f32_16x16x32_bf16 v[80:83], v[216:219], a[40:43], v[80:83]
    v_mfma_f32_16x16x32_bf16 v[80:83], v[220:223], a[44:47], v[80:83]
    s_waitcnt lgkmcnt(2)
    ds_read_b128 v[216:219], v4 offset:2048
    v_mfma_f32_16x16x32_bf16 v[88:91], v[192:195], a[32:35], v[88:91]
    v_mfma_f32_16x16x32_bf16 v[88:91], v[196:199], a[36:39], v[88:91]
    ds_read_b128 v[220:223], v4 offset:3072
    v_mfma_f32_16x16x32_bf16 v[92:95], v[192:195], a[48:51], v[92:95]
    buffer_load_dwordx4 a[148:151], v19, s[36:39], s51 offen offset:1024 sc1
    v_mfma_f32_16x16x32_bf16 v[92:95], v[196:199], a[52:55], v[92:95]
    ds_read_b128 v[192:195], v4 offset:4096
    v_mfma_f32_16x16x32_bf16 v[92:95], v[200:203], a[56:59], v[92:95]
    v_mfma_f32_16x16x32_bf16 v[92:95], v[204:207], a[60:63], v[92:95]
    ds_read_b128 v[196:199], v4 offset:5120
    v_mfma_f32_16x16x32_bf16 v[88:91], v[200:203], a[40:43], v[88:91]
    buffer_load_dwordx4 a[152:155], v19, s[36:39], s51 offen offset:2048 sc1
    v_mfma_f32_16x16x32_bf16 v[88:91], v[204:207], a[44:47], v[88:91]
    s_waitcnt lgkmcnt(2)
    ds_read_b128 v[200:203], v4 offset:6144
    v_mfma_f32_16x16x32_bf16 v[96:99], v[208:211], a[32:35], v[96:99]
    v_mfma_f32_16x16x32_bf16 v[96:99], v[212:215], a[36:39], v[96:99]
    ds_read_b128 v[204:207], v4 offset:7168
    v_mfma_f32_16x16x32_bf16 v[100:103], v[208:211], a[48:51], v[100:103]
    v_mfma_f32_16x16x32_bf16 v[100:103], v[212:215], a[52:55], v[100:103]
    ds_read_b128 v[208:211], v4 offset:8192
    v_mfma_f32_16x16x32_bf16 v[100:103], v[216:219], a[56:59], v[100:103]
    buffer_load_dwordx4 a[156:159], v19, s[36:39], s51 offen offset:3072 sc1
    v_mfma_f32_16x16x32_bf16 v[100:103], v[220:223], a[60:63], v[100:103]
    s_mov_b32 s49, 147456
    s_add_u32 m0, s31, 73728
    ds_read_b128 v[212:215], v4 offset:9216
    v_mfma_f32_16x16x32_bf16 v[96:99], v[216:219], a[40:43], v[96:99]
    buffer_load_dwordx4 v20, s[20:23], s49 offen offset:0 sc1 lds
    v_mfma_f32_16x16x32_bf16 v[96:99], v[220:223], a[44:47], v[96:99]
    s_waitcnt lgkmcnt(2)
    ds_read_b128 v[216:219], v4 offset:10240
    v_mfma_f32_16x16x32_bf16 v[104:107], v[192:195], a[32:35], v[104:107]
    v_mfma_f32_16x16x32_bf16 v[104:107], v[196:199], a[36:39], v[104:107]
    ds_read_b128 v[220:223], v4 offset:11264
    v_mfma_f32_16x16x32_bf16 v[108:111], v[192:195], a[48:51], v[108:111]
    buffer_load_dwordx4 v20, s[20:23], s49 offen offset:1024 sc1 lds
    v_mfma_f32_16x16x32_bf16 v[108:111], v[196:199], a[52:55], v[108:111]
    ds_read_b128 v[192:195], v4 offset:12288
    v_mfma_f32_16x16x32_bf16 v[108:111], v[200:203], a[56:59], v[108:111]
    v_mfma_f32_16x16x32_bf16 v[108:111], v[204:207], a[60:63], v[108:111]
    ds_read_b128 v[196:199], v4 offset:13312
    v_mfma_f32_16x16x32_bf16 v[104:107], v[200:203], a[40:43], v[104:107]
    buffer_load_dwordx4 v20, s[20:23], s49 offen offset:2048 sc1 lds
    v_mfma_f32_16x16x32_bf16 v[104:107], v[204:207], a[44:47], v[104:107]
    s_waitcnt lgkmcnt(2)
    ds_read_b128 v[200:203], v4 offset:14336
    v_mfma_f32_16x16x32_bf16 v[112:115], v[208:211], a[32:35], v[112:115]
    v_mfma_f32_16x16x32_bf16 v[112:115], v[212:215], a[36:39], v[112:115]
    ds_read_b128 v[204:207], v4 offset:15360
    v_mfma_f32_16x16x32_bf16 v[116:119], v[208:211], a[48:51], v[116:119]
    v_mfma_f32_16x16x32_bf16 v[116:119], v[212:215], a[52:55], v[116:119]
    ds_read_b128 v[208:211], v4 offset:16384
    v_mfma_f32_16x16x32_bf16 v[116:119], v[216:219], a[56:59], v[116:119]
    buffer_load_dwordx4 v20, s[20:23], s49 offen offset:3072 sc1 lds
    v_mfma_f32_16x16x32_bf16 v[116:119], v[220:223], a[60:63], v[116:119]
    s_mov_b32 s49, 151552
    s_add_u32 m0, s31, 77824
    ds_read_b128 v[212:215], v4 offset:17408
    v_mfma_f32_16x16x32_bf16 v[112:115], v[216:219], a[40:43], v[112:115]
    v_mfma_f32_16x16x32_bf16 v[112:115], v[220:223], a[44:47], v[112:115]
    s_waitcnt vmcnt(56) lgkmcnt(2)
    ds_read_b128 v[216:219], v4 offset:18432
    v_mfma_f32_16x16x32_bf16 v[64:67], v[192:195], a[64:67], v[64:67]
    buffer_load_dwordx4 v20, s[20:23], s49 offen offset:0 sc1 lds
    v_mfma_f32_16x16x32_bf16 v[64:67], v[196:199], a[68:71], v[64:67]
    ds_read_b128 v[220:223], v4 offset:19456
    v_mfma_f32_16x16x32_bf16 v[68:71], v[192:195], a[80:83], v[68:71]
    v_mfma_f32_16x16x32_bf16 v[68:71], v[196:199], a[84:87], v[68:71]
    ds_read_b128 v[192:195], v4 offset:20480
    v_mfma_f32_16x16x32_bf16 v[68:71], v[200:203], a[88:91], v[68:71]
    v_mfma_f32_16x16x32_bf16 v[68:71], v[204:207], a[92:95], v[68:71]
    ds_read_b128 v[196:199], v4 offset:21504
    v_mfma_f32_16x16x32_bf16 v[64:67], v[200:203], a[72:75], v[64:67]
    buffer_load_dwordx4 v20, s[20:23], s49 offen offset:1024 sc1 lds
    v_mfma_f32_16x16x32_bf16 v[64:67], v[204:207], a[76:79], v[64:67]
    s_waitcnt lgkmcnt(2)
    ds_read_b128 v[200:203], v4 offset:22528
    v_mfma_f32_16x16x32_bf16 v[72:75], v[208:211], a[64:67], v[72:75]
    v_mfma_f32_16x16x32_bf16 v[72:75], v[212:215], a[68:71], v[72:75]
    ds_read_b128 v[204:207], v4 offset:23552
    v_mfma_f32_16x16x32_bf16 v[76:79], v[208:211], a[80:83], v[76:79]
    buffer_load_dwordx4 v20, s[20:23], s49 offen offset:2048 sc1 lds
    v_mfma_f32_16x16x32_bf16 v[76:79], v[212:215], a[84:87], v[76:79]
    ds_read_b128 v[208:211], v4 offset:24576
    v_mfma_f32_16x16x32_bf16 v[76:79], v[216:219], a[88:91], v[76:79]
    v_mfma_f32_16x16x32_bf16 v[76:79], v[220:223], a[92:95], v[76:79]
    ds_read_b128 v[212:215], v4 offset:25600
    v_mfma_f32_16x16x32_bf16 v[72:75], v[216:219], a[72:75], v[72:75]
    v_mfma_f32_16x16x32_bf16 v[72:75], v[220:223], a[76:79], v[72:75]
    s_waitcnt lgkmcnt(2)
    ds_read_b128 v[216:219], v4 offset:26624
    v_mfma_f32_16x16x32_bf16 v[80:83], v[192:195], a[64:67], v[80:83]
    buffer_load_dwordx4 v20, s[20:23], s49 offen offset:3072 sc1 lds
    v_mfma_f32_16x16x32_bf16 v[80:83], v[196:199], a[68:71], v[80:83]
    s_mov_b32 s49, 155648
    ds_read_b128 v[220:223], v4 offset:27648
    v_mfma_f32_16x16x32_bf16 v[84:87], v[192:195], a[80:83], v[84:87]
    v_mfma_f32_16x16x32_bf16 v[84:87], v[196:199], a[84:87], v[84:87]
    s_add_u32 m0, s31, 81920
    ds_read_b128 v[192:195], v4 offset:28672
    v_mfma_f32_16x16x32_bf16 v[84:87], v[200:203], a[88:91], v[84:87]
    buffer_load_dwordx4 v20, s[20:23], s49 offen offset:0 sc1 lds
    v_mfma_f32_16x16x32_bf16 v[84:87], v[204:207], a[92:95], v[84:87]
    s_add_u32 s51, s42, 24576
    ds_read_b128 v[196:199], v4 offset:29696
    v_mfma_f32_16x16x32_bf16 v[80:83], v[200:203], a[72:75], v[80:83]
    buffer_load_dwordx4 a[160:163], v4, s[36:39], s51 offen offset:0 sc1
    v_mfma_f32_16x16x32_bf16 v[80:83], v[204:207], a[76:79], v[80:83]
    s_waitcnt lgkmcnt(2)
    ds_read_b128 v[200:203], v4 offset:30720
    v_mfma_f32_16x16x32_bf16 v[88:91], v[208:211], a[64:67], v[88:91]
    v_mfma_f32_16x16x32_bf16 v[88:91], v[212:215], a[68:71], v[88:91]
    ds_read_b128 v[204:207], v4 offset:31744
    v_mfma_f32_16x16x32_bf16 v[92:95], v[208:211], a[80:83], v[92:95]
    buffer_load_dwordx4 a[164:167], v4, s[36:39], s51 offen offset:1024 sc1
    v_mfma_f32_16x16x32_bf16 v[92:95], v[212:215], a[84:87], v[92:95]
    ds_read_b128 v[208:211], v4 offset:32768
    v_mfma_f32_16x16x32_bf16 v[92:95], v[216:219], a[88:91], v[92:95]
    v_mfma_f32_16x16x32_bf16 v[92:95], v[220:223], a[92:95], v[92:95]
    ds_read_b128 v[212:215], v4 offset:33792
    v_mfma_f32_16x16x32_bf16 v[88:91], v[216:219], a[72:75], v[88:91]
    s_waitcnt vmcnt(20)
    s_barrier
    v_mfma_f32_16x16x32_bf16 v[88:91], v[220:223], a[76:79], v[88:91]
    s_waitcnt lgkmcnt(2)
    ds_read_b128 v[216:219], v4 offset:34816
    v_mfma_f32_16x16x32_bf16 v[96:99], v[192:195], a[64:67], v[96:99]
    buffer_load_dwordx4 a[168:171], v4, s[36:39], s51 offen offset:2048 sc1
    v_mfma_f32_16x16x32_bf16 v[96:99], v[196:199], a[68:71], v[96:99]
    ds_read_b128 v[220:223], v4 offset:35840
    v_mfma_f32_16x16x32_bf16 v[100:103], v[192:195], a[80:83], v[100:103]
    v_mfma_f32_16x16x32_bf16 v[100:103], v[196:199], a[84:87], v[100:103]
    ds_read_b128 v[192:195], v4 offset:36864
    v_mfma_f32_16x16x32_bf16 v[100:103], v[200:203], a[88:91], v[100:103]
    buffer_load_dwordx4 a[172:175], v4, s[36:39], s51 offen offset:3072 sc1
    v_mfma_f32_16x16x32_bf16 v[100:103], v[204:207], a[92:95], v[100:103]
    ds_read_b128 v[196:199], v4 offset:37888
    v_mfma_f32_16x16x32_bf16 v[96:99], v[200:203], a[72:75], v[96:99]
    v_mfma_f32_16x16x32_bf16 v[96:99], v[204:207], a[76:79], v[96:99]
    s_waitcnt lgkmcnt(2)
    ds_read_b128 v[200:203], v4 offset:38912
    v_mfma_f32_16x16x32_bf16 v[104:107], v[208:211], a[64:67], v[104:107]
    buffer_load_dwordx4 a[176:179], v19, s[36:39], s51 offen offset:0 sc1
    v_mfma_f32_16x16x32_bf16 v[104:107], v[212:215], a[68:71], v[104:107]
    ds_read_b128 v[204:207], v4 offset:39936
    v_mfma_f32_16x16x32_bf16 v[108:111], v[208:211], a[80:83], v[108:111]
    buffer_load_dword v31, v13, s[12:15], s47 offen sc1
    v_mfma_f32_16x16x32_bf16 v[108:111], v[212:215], a[84:87], v[108:111]
    ds_read_b128 v[208:211], v4 offset:40960
    v_mfma_f32_16x16x32_bf16 v[108:111], v[216:219], a[88:91], v[108:111]
    v_mfma_f32_16x16x32_bf16 v[108:111], v[220:223], a[92:95], v[108:111]
    ds_read_b128 v[212:215], v4 offset:41984
    v_mfma_f32_16x16x32_bf16 v[104:107], v[216:219], a[72:75], v[104:107]
    buffer_load_dwordx4 a[180:183], v19, s[36:39], s51 offen offset:1024 sc1
    v_mfma_f32_16x16x32_bf16 v[104:107], v[220:223], a[76:79], v[104:107]
    s_waitcnt lgkmcnt(2)
    ds_read_b128 v[216:219], v4 offset:43008
    v_mfma_f32_16x16x32_bf16 v[112:115], v[192:195], a[64:67], v[112:115]
    v_mfma_f32_16x16x32_bf16 v[112:115], v[196:199], a[68:71], v[112:115]
    ds_read_b128 v[220:223], v4 offset:44032
    v_mfma_f32_16x16x32_bf16 v[116:119], v[192:195], a[80:83], v[116:119]
    buffer_load_dwordx4 a[184:187], v19, s[36:39], s51 offen offset:2048 sc1
    v_mfma_f32_16x16x32_bf16 v[116:119], v[196:199], a[84:87], v[116:119]
    ds_read_b128 v[192:195], v4 offset:45056
    v_mfma_f32_16x16x32_bf16 v[116:119], v[200:203], a[88:91], v[116:119]
    v_mfma_f32_16x16x32_bf16 v[116:119], v[204:207], a[92:95], v[116:119]
    ds_read_b128 v[196:199], v4 offset:46080
    v_mfma_f32_16x16x32_bf16 v[112:115], v[200:203], a[72:75], v[112:115]
    v_mfma_f32_16x16x32_bf16 v[112:115], v[204:207], a[76:79], v[112:115]
    s_waitcnt vmcnt(47) lgkmcnt(2)
    ds_read_b128 v[200:203], v4 offset:47104
    v_mfma_f32_16x16x32_bf16 v[64:67], v[208:211], a[96:99], v[64:67]
    buffer_load_dwordx4 a[188:191], v19, s[36:39], s51 offen offset:3072 sc1
    v_mfma_f32_16x16x32_bf16 v[64:67], v[212:215], a[100:103], v[64:67]
    s_mov_b32 s49, 184320
    ds_read_b128 v[204:207], v4 offset:48128
    v_mfma_f32_16x16x32_bf16 v[68:71], v[208:211], a[112:115], v[68:71]
    v_mfma_f32_16x16x32_bf16 v[68:71], v[212:215], a[116:119], v[68:71]
    s_add_u32 m0, s31, 110592
    ds_read_b128 v[208:211], v4 offset:49152
    v_mfma_f32_16x16x32_bf16 v[68:71], v[216:219], a[120:123], v[68:71]
    buffer_load_dwordx4 v20, s[20:23], s49 offen offset:0 sc1 lds
    v_mfma_f32_16x16x32_bf16 v[68:71], v[220:223], a[124:127], v[68:71]
    ds_read_b128 v[212:215], v4 offset:50176
    v_mfma_f32_16x16x32_bf16 v[64:67], v[216:219], a[104:107], v[64:67]
    v_mfma_f32_16x16x32_bf16 v[64:67], v[220:223], a[108:111], v[64:67]
    s_waitcnt lgkmcnt(2)
    ds_read_b128 v[216:219], v4 offset:51200
    v_mfma_f32_16x16x32_bf16 v[72:75], v[192:195], a[96:99], v[72:75]
    buffer_load_dwordx4 v20, s[20:23], s49 offen offset:1024 sc1 lds
    v_mfma_f32_16x16x32_bf16 v[72:75], v[196:199], a[100:103], v[72:75]
    ds_read_b128 v[220:223], v4 offset:52224
    v_mfma_f32_16x16x32_bf16 v[76:79], v[192:195], a[112:115], v[76:79]
    v_mfma_f32_16x16x32_bf16 v[76:79], v[196:199], a[116:119], v[76:79]
    ds_read_b128 v[192:195], v4 offset:53248
    v_mfma_f32_16x16x32_bf16 v[76:79], v[200:203], a[120:123], v[76:79]
    buffer_load_dwordx4 v20, s[20:23], s49 offen offset:2048 sc1 lds
    v_mfma_f32_16x16x32_bf16 v[76:79], v[204:207], a[124:127], v[76:79]
    ds_read_b128 v[196:199], v4 offset:54272
    v_mfma_f32_16x16x32_bf16 v[72:75], v[200:203], a[104:107], v[72:75]
    v_mfma_f32_16x16x32_bf16 v[72:75], v[204:207], a[108:111], v[72:75]
    s_waitcnt lgkmcnt(2)
    ds_read_b128 v[200:203], v4 offset:55296
    v_mfma_f32_16x16x32_bf16 v[80:83], v[208:211], a[96:99], v[80:83]
    v_mfma_f32_16x16x32_bf16 v[80:83], v[212:215], a[100:103], v[80:83]
    ds_read_b128 v[204:207], v4 offset:56320
    v_mfma_f32_16x16x32_bf16 v[84:87], v[208:211], a[112:115], v[84:87]
    buffer_load_dwordx4 v20, s[20:23], s49 offen offset:3072 sc1 lds
    v_mfma_f32_16x16x32_bf16 v[84:87], v[212:215], a[116:119], v[84:87]
    s_mov_b32 s49, 188416
    ds_read_b128 v[208:211], v4 offset:57344
    v_mfma_f32_16x16x32_bf16 v[84:87], v[216:219], a[120:123], v[84:87]
    v_mfma_f32_16x16x32_bf16 v[84:87], v[220:223], a[124:127], v[84:87]
    s_add_u32 m0, s31, 114688
    ds_read_b128 v[212:215], v4 offset:58368
    v_mfma_f32_16x16x32_bf16 v[80:83], v[216:219], a[104:107], v[80:83]
    buffer_load_dwordx4 v20, s[20:23], s49 offen offset:0 sc1 lds
    v_mfma_f32_16x16x32_bf16 v[80:83], v[220:223], a[108:111], v[80:83]
    s_waitcnt lgkmcnt(2)
    ds_read_b128 v[216:219], v4 offset:59392
    v_mfma_f32_16x16x32_bf16 v[88:91], v[192:195], a[96:99], v[88:91]
    v_mfma_f32_16x16x32_bf16 v[88:91], v[196:199], a[100:103], v[88:91]
    ds_read_b128 v[220:223], v4 offset:60416
    v_mfma_f32_16x16x32_bf16 v[92:95], v[192:195], a[112:115], v[92:95]
    v_mfma_f32_16x16x32_bf16 v[92:95], v[196:199], a[116:119], v[92:95]
    ds_read_b128 v[192:195], v4 offset:61440
    v_mfma_f32_16x16x32_bf16 v[92:95], v[200:203], a[120:123], v[92:95]
    buffer_load_dwordx4 v20, s[20:23], s49 offen offset:1024 sc1 lds
    v_mfma_f32_16x16x32_bf16 v[92:95], v[204:207], a[124:127], v[92:95]
    ds_read_b128 v[196:199], v4 offset:62464
    v_mfma_f32_16x16x32_bf16 v[88:91], v[200:203], a[104:107], v[88:91]
    v_mfma_f32_16x16x32_bf16 v[88:91], v[204:207], a[108:111], v[88:91]
    s_waitcnt lgkmcnt(2)
    ds_read_b128 v[200:203], v4 offset:63488
    v_mfma_f32_16x16x32_bf16 v[96:99], v[208:211], a[96:99], v[96:99]
    buffer_load_dwordx4 v20, s[20:23], s49 offen offset:2048 sc1 lds
    v_mfma_f32_16x16x32_bf16 v[96:99], v[212:215], a[100:103], v[96:99]
    ds_read_b128 v[204:207], v4 offset:64512
    v_mfma_f32_16x16x32_bf16 v[100:103], v[208:211], a[112:115], v[100:103]
    v_mfma_f32_16x16x32_bf16 v[100:103], v[212:215], a[116:119], v[100:103]
    ds_read_b128 v[208:211], v21 offset:0
    v_mfma_f32_16x16x32_bf16 v[100:103], v[216:219], a[120:123], v[100:103]
    v_mfma_f32_16x16x32_bf16 v[100:103], v[220:223], a[124:127], v[100:103]
    ds_read_b128 v[212:215], v21 offset:1024
    v_mfma_f32_16x16x32_bf16 v[96:99], v[216:219], a[104:107], v[96:99]
    buffer_load_dwordx4 v20, s[20:23], s49 offen offset:3072 sc1 lds
    v_mfma_f32_16x16x32_bf16 v[96:99], v[220:223], a[108:111], v[96:99]
    s_waitcnt lgkmcnt(2)
    s_add_u32 s9, s6, 9
    ds_read_b128 v[216:219], v21 offset:2048
    v_mfma_f32_16x16x32_bf16 v[104:107], v[192:195], a[96:99], v[104:107]
    s_waitcnt vmcnt(11)
    v_subrev_u32 v31, s9, v31
    v_cmp_lt_u32 vcc, 0, v31
    v_mfma_f32_16x16x32_bf16 v[104:107], v[196:199], a[100:103], v[104:107]
    s_mov_b32 s49, 192512
    ds_read_b128 v[220:223], v21 offset:3072
    v_mfma_f32_16x16x32_bf16 v[108:111], v[192:195], a[112:115], v[108:111]
    s_cbranch_vccnz Lslow_30
Lback_31:
    v_mfma_f32_16x16x32_bf16 v[108:111], v[196:199], a[116:119], v[108:111]
    s_add_u32 m0, s31, 118784
    ds_read_b128 v[192:195], v21 offset:4096
    v_mfma_f32_16x16x32_bf16 v[108:111], v[200:203], a[120:123], v[108:111]
    buffer_load_dwordx4 v20, s[20:23], s49 offen offset:0 sc1 lds
    v_mfma_f32_16x16x32_bf16 v[108:111], v[204:207], a[124:127], v[108:111]
    s_add_u32 s51, s42, 28672
    ds_read_b128 v[196:199], v21 offset:5120
    v_mfma_f32_16x16x32_bf16 v[104:107], v[200:203], a[104:107], v[104:107]
    s_waitcnt vmcnt(18)
    s_barrier
    v_mfma_f32_16x16x32_bf16 v[104:107], v[204:207], a[108:111], v[104:107]
    s_waitcnt lgkmcnt(2)
    ds_read_b128 v[200:203], v21 offset:6144
    v_mfma_f32_16x16x32_bf16 v[112:115], v[208:211], a[96:99], v[112:115]
    buffer_load_dwordx4 a[192:195], v4, s[36:39], s51 offen offset:0 sc1
    v_mfma_f32_16x16x32_bf16 v[112:115], v[212:215], a[100:103], v[112:115]
    ds_read_b128 v[204:207], v21 offset:7168
    v_mfma_f32_16x16x32_bf16 v[116:119], v[208:211], a[112:115], v[116:119]
    v_mfma_f32_16x16x32_bf16 v[116:119], v[212:215], a[116:119], v[116:119]
    ds_read_b128 v[208:211], v21 offset:8192
    v_mfma_f32_16x16x32_bf16 v[116:119], v[216:219], a[120:123], v[116:119]
    buffer_load_dwordx4 a[196:199], v4, s[36:39], s51 offen offset:1024 sc1
    v_mfma_f32_16x16x32_bf16 v[116:119], v[220:223], a[124:127], v[116:119]
    ds_read_b128 v[212:215], v21 offset:9216
    v_mfma_f32_16x16x32_bf16 v[112:115], v[216:219], a[104:107], v[112:115]
    v_mfma_f32_16x16x32_bf16 v[112:115], v[220:223], a[108:111], v[112:115]
    s_waitcnt vmcnt(29) lgkmcnt(2)
    ds_read_b128 v[216:219], v21 offset:10240
    v_mfma_f32_16x16x32_bf16 v[64:67], v[192:195], a[128:131], v[64:67]
    buffer_load_dwordx4 a[200:203], v4, s[36:39], s51 offen offset:2048 sc1
    v_mfma_f32_16x16x32_bf16 v[64:67], v[196:199], a[132:135], v[64:67]
    ds_read_b128 v[220:223], v21 offset:11264
    v_mfma_f32_16x16x32_bf16 v[68:71], v[192:195], a[144:147], v[68:71]
    v_mfma_f32_16x16x32_bf16 v[68:71], v[196:199], a[148:151], v[68:71]
    ds_read_b128 v[192:195], v21 offset:12288
    v_mfma_f32_16x16x32_bf16 v[68:71], v[200:203], a[152:155], v[68:71]
    v_mfma_f32_16x16x32_bf16 v[68:71], v[204:207], a[156:159], v[68:71]
    ds_read_b128 v[196:199], v21 offset:13312
    v_mfma_f32_16x16x32_bf16 v[64:67], v[200:203], a[136:139], v[64:67]
    buffer_load_dwordx4 a[204:207], v4, s[36:39], s51 offen offset:3072 sc1
    v_mfma_f32_16x16x32_bf16 v[64:67], v[204:207], a[140:143], v[64:67]
    s_waitcnt lgkmcnt(2)
    ds_read_b128 v[200:203], v21 offset:14336
    v_mfma_f32_16x16x32_bf16 v[72:75], v[208:211], a[128:131], v[72:75]
    v_mfma_f32_16x16x32_bf16 v[72:75], v[212:215], a[132:135], v[72:75]
    ds_read_b128 v[204:207], v21 offset:15360
    v_mfma_f32_16x16x32_bf16 v[76:79], v[208:211], a[144:147], v[76:79]
    buffer_load_dwordx4 a[208:211], v19, s[36:39], s51 offen offset:0 sc1
    v_mfma_f32_16x16x32_bf16 v[76:79], v[212:215], a[148:151], v[76:79]
    ds_read_b128 v[208:211], v21 offset:16384
    v_mfma_f32_16x16x32_bf16 v[76:79], v[216:219], a[152:155], v[76:79]
    v_mfma_f32_16x16x32_bf16 v[76:79], v[220:223], a[156:159], v[76:79]
    ds_read_b128 v[212:215], v21 offset:17408
    v_mfma_f32_16x16x32_bf16 v[72:75], v[216:219], a[136:139], v[72:75]
    v_mfma_f32_16x16x32_bf16 v[72:75], v[220:223], a[140:143], v[72:75]
    s_waitcnt lgkmcnt(2)
    ds_read_b128 v[216:219], v21 offset:18432
    v_mfma_f32_16x16x32_bf16 v[80:83], v[192:195], a[128:131], v[80:83]
    buffer_load_dwordx4 a[212:215], v19, s[36:39], s51 offen offset:1024 sc1
    v_mfma_f32_16x16x32_bf16 v[80:83], v[196:199], a[132:135], v[80:83]
    ds_read_b128 v[220:223], v21 offset:19456
    v_mfma_f32_16x16x32_bf16 v[84:87], v[192:195], a[144:147], v[84:87]
    v_mfma_f32_16x16x32_bf16 v[84:87], v[196:199], a[148:151], v[84:87]
    ds_read_b128 v[192:195], v21 offset:20480
    v_mfma_f32_16x16x32_bf16 v[84:87], v[200:203], a[152:155], v[84:87]
    buffer_load_dwordx4 a[216:219], v19, s[36:39], s51 offen offset:2048 sc1
    v_mfma_f32_16x16x32_bf16 v[84:87], v[204:207], a[156:159], v[84:87]
    ds_read_b128 v[196:199], v21 offset:21504
    v_mfma_f32_16x16x32_bf16 v[80:83], v[200:203], a[136:139], v[80:83]
    v_mfma_f32_16x16x32_bf16 v[80:83], v[204:207], a[140:143], v[80:83]
    s_waitcnt lgkmcnt(2)
    ds_read_b128 v[200:203], v21 offset:22528
    v_mfma_f32_16x16x32_bf16 v[88:91], v[208:211], a[128:131], v[88:91]
    v_mfma_f32_16x16x32_bf16 v[88:91], v[212:215], a[132:135], v[88:91]
    ds_read_b128 v[204:207], v21 offset:23552
    v_mfma_f32_16x16x32_bf16 v[92:95], v[208:211], a[144:147], v[92:95]
    buffer_load_dwordx4 a[220:223], v19, s[36:39], s51 offen offset:3072 sc1
    v_mfma_f32_16x16x32_bf16 v[92:95], v[212:215], a[148:151], v[92:95]
    s_add_u32 s51, s42, 32768
    ds_read_b128 v[208:211], v21 offset:24576
    v_mfma_f32_16x16x32_bf16 v[92:95], v[216:219], a[152:155], v[92:95]
    buffer_load_dwordx4 a[224:227], v4, s[36:39], s51 offen offset:0 sc1
    v_mfma_f32_16x16x32_bf16 v[92:95], v[220:223], a[156:159], v[92:95]
    ds_read_b128 v[212:215], v21 offset:25600
    v_mfma_f32_16x16x32_bf16 v[88:91], v[216:219], a[136:139], v[88:91]
    v_mfma_f32_16x16x32_bf16 v[88:91], v[220:223], a[140:143], v[88:91]
    s_waitcnt lgkmcnt(2)
    ds_read_b128 v[216:219], v21 offset:26624
    v_mfma_f32_16x16x32_bf16 v[96:99], v[192:195], a[128:131], v[96:99]
    buffer_load_dwordx4 a[228:231], v4, s[36:39], s51 offen offset:1024 sc1
    v_mfma_f32_16x16x32_bf16 v[96:99], v[196:199], a[132:135], v[96:99]
    ds_read_b128 v[220:223], v21 offset:27648
    v_mfma_f32_16x16x32_bf16 v[100:103], v[192:195], a[144:147], v[100:103]
    v_mfma_f32_16x16x32_bf16 v[100:103], v[196:199], a[148:151], v[100:103]
    ds_read_b128 v[192:195], v21 offset:28672
    v_mfma_f32_16x16x32_bf16 v[100:103], v[200:203], a[152:155], v[100:103]
    buffer_load_dwordx4 a[232:235], v4, s[36:39], s51 offen offset:2048 sc1
    v_mfma_f32_16x16x32_bf16 v[100:103], v[204:207], a[156:159], v[100:103]
    ds_read_b128 v[196:199], v21 offset:29696
    v_mfma_f32_16x16x32_bf16 v[96:99], v[200:203], a[136:139], v[96:99]
    v_mfma_f32_16x16x32_bf16 v[96:99], v[204:207], a[140:143], v[96:99]
    s_waitcnt lgkmcnt(2)
    ds_read_b128 v[200:203], v21 offset:30720
    v_mfma_f32_16x16x32_bf16 v[104:107], v[208:211], a[128:131], v[104:107]
    v_mfma_f32_16x16x32_bf16 v[104:107], v[212:215], a[132:135], v[104:107]
    ds_read_b128 v[204:207], v21 offset:31744
    v_mfma_f32_16x16x32_bf16 v[108:111], v[208:211], a[144:147], v[108:111]
    buffer_load_dwordx4 a[236:239], v4, s[36:39], s51 offen offset:3072 sc1
    v_mfma_f32_16x16x32_bf16 v[108:111], v[212:215], a[148:151], v[108:111]
    ds_read_b128 v[208:211], v21 offset:32768
    v_mfma_f32_16x16x32_bf16 v[108:111], v[216:219], a[152:155], v[108:111]
    v_mfma_f32_16x16x32_bf16 v[108:111], v[220:223], a[156:159], v[108:111]
    ds_read_b128 v[212:215], v21 offset:33792
    v_mfma_f32_16x16x32_bf16 v[104:107], v[216:219], a[136:139], v[104:107]
    buffer_load_dwordx4 a[240:243], v19, s[36:39], s51 offen offset:0 sc1
    v_mfma_f32_16x16x32_bf16 v[104:107], v[220:223], a[140:143], v[104:107]
    s_waitcnt lgkmcnt(2)
    ds_read_b128 v[216:219], v21 offset:34816
    v_mfma_f32_16x16x32_bf16 v[112:115], v[192:195], a[128:131], v[112:115]
    v_mfma_f32_16x16x32_bf16 v[112:115], v[196:199], a[132:135], v[112:115]
    ds_read_b128 v[220:223], v21 offset:35840
    v_mfma_f32_16x16x32_bf16 v[116:119], v[192:195], a[144:147], v[116:119]
    v_mfma_f32_16x16x32_bf16 v[116:119], v[196:199], a[148:151], v[116:119]
    ds_read_b128 v[192:195], v21 offset:36864
    v_mfma_f32_16x16x32_bf16 v[116:119], v[200:203], a[152:155], v[116:119]
    buffer_load_dwordx4 a[244:247], v19, s[36:39], s51 offen offset:1024 sc1
    v_mfma_f32_16x16x32_bf16 v[116:119], v[204:207], a[156:159], v[116:119]
    ds_read_b128 v[196:199], v21 offset:37888
    v_mfma_f32_16x16x32_bf16 v[112:115], v[200:203], a[136:139], v[112:115]
    v_mfma_f32_16x16x32_bf16 v[112:115], v[204:207], a[140:143], v[112:115]
    s_waitcnt vmcnt(23) lgkmcnt(2)
    ds_read_b128 v[200:203], v21 offset:38912
    v_mfma_f32_16x16x32_bf16 v[64:67], v[208:211], a[160:163], v[64:67]
    buffer_load_dwordx4 a[248:251], v19, s[36:39], s51 offen offset:2048 sc1
    v_mfma_f32_16x16x32_bf16 v[64:67], v[212:215], a[164:167], v[64:67]
    ds_read_b128 v[204:207], v21 offset:39936
    v_mfma_f32_16x16x32_bf16 v[68:71], v[208:211], a[176:179], v[68:71]
    v_mfma_f32_16x16x32_bf16 v[68:71], v[212:215], a[180:183], v[68:71]
    ds_read_b128 v[208:211], v21 offset:40960
    v_mfma_f32_16x16x32_bf16 v[68:71], v[216:219], a[184:187], v[68:71]
    v_mfma_f32_16x16x32_bf16 v[68:71], v[220:223], a[188:191], v[68:71]
    ds_read_b128 v[212:215], v21 offset:41984
    v_mfma_f32_16x16x32_bf16 v[64:67], v[216:219], a[168:171], v[64:67]
    s_waitcnt vmcnt(15)
    s_barrier
    v_mfma_f32_16x16x32_bf16 v[64:67], v[220:223], a[172:175], v[64:67]
    s_waitcnt lgkmcnt(2)
    ds_read_b128 v[216:219], v21 offset:43008
    v_mfma_f32_16x16x32_bf16 v[72:75], v[192:195], a[160:163], v[72:75]
    buffer_load_dwordx4 a[252:255], v19, s[36:39], s51 offen offset:3072 sc1
    v_mfma_f32_16x16x32_bf16 v[72:75], v[196:199], a[164:167], v[72:75]
    s_mul_i32 s48, s3, 5120
Lhop10:
    s_cbranch_execz Lhopret
    ds_read_b128 v[220:223], v21 offset:44032
    v_mfma_f32_16x16x32_bf16 v[76:79], v[192:195], a[176:179], v[76:79]
    v_mfma_f32_16x16x32_bf16 v[76:79], v[196:199], a[180:183], v[76:79]
    s_add_u32 s49, s48, 221184
    ds_read_b128 v[192:195], v21 offset:45056
    v_mfma_f32_16x16x32_bf16 v[76:79], v[200:203], a[184:187], v[76:79]
    v_mfma_f32_16x16x32_bf16 v[76:79], v[204:207], a[188:191], v[76:79]
    s_add_u32 m0, s48, 0
    ds_read_b128 v[196:199], v21 offset:46080
    v_mfma_f32_16x16x32_bf16 v[72:75], v[200:203], a[168:171], v[72:75]
    buffer_load_dwordx4 v4, s[20:23], s49 offen offset:0 sc1 lds
    v_mfma_f32_16x16x32_bf16 v[72:75], v[204:207], a[172:175], v[72:75]
    s_waitcnt lgkmcnt(2)
    ds_read_b128 v[200:203], v21 offset:47104
    v_mfma_f32_16x16x32_bf16 v[80:83], v[208:211], a[160:163], v[80:83]
    s_add_u32 s16, s4, 0x1e00000
    s_addc_u32 s17, s5, 0
    v_mfma_f32_16x16x32_bf16 v[80:83], v[212:215], a[164:167], v[80:83]
    s_mov_b32 s18, 7340032
    ds_read_b128 v[204:207], v21 offset:48128
    v_mfma_f32_16x16x32_bf16 v[84:87], v[208:211], a[176:179], v[84:87]
    buffer_load_dwordx4 v4, s[20:23], s49 offen offset:1024 sc1 lds
    v_mfma_f32_16x16x32_bf16 v[84:87], v[212:215], a[180:183], v[84:87]
    s_lshr_b32 s86, s29, 2
    ds_read_b128 v[208:211], v21 offset:49152
    v_mfma_f32_16x16x32_bf16 v[84:87], v[216:219], a[184:187], v[84:87]
    v_mfma_f32_16x16x32_bf16 v[84:87], v[220:223], a[188:191], v[84:87]
    s_lshl_b32 s86, s86, 2
    s_add_u32 s86, s86, s30
    ds_read_b128 v[212:215], v21 offset:50176
    v_mfma_f32_16x16x32_bf16 v[80:83], v[216:219], a[168:171], v[80:83]
    buffer_load_dwordx4 v4, s[20:23], s49 offen offset:2048 sc1 lds
    v_mfma_f32_16x16x32_bf16 v[80:83], v[220:223], a[172:175], v[80:83]
    s_waitcnt lgkmcnt(2)
    s_lshl_b32 s86, s86, 4
    ds_read_b128 v[216:219], v21 offset:51200
    v_mfma_f32_16x16x32_bf16 v[88:91], v[192:195], a[160:163], v[88:91]
    v_mfma_f32_16x16x32_bf16 v[88:91], v[196:199], a[164:167], v[88:91]
    s_add_u32 s86, s86, s3
    ds_read_b128 v[220:223], v21 offset:52224
    v_mfma_f32_16x16x32_bf16 v[92:95], v[192:195], a[176:179], v[92:95]
    v_mfma_f32_16x16x32_bf16 v[92:95], v[196:199], a[180:183], v[92:95]
    s_lshl_b32 s87, s26, 2
    s_add_u32 s87, s87, s86
    ds_read_b128 v[192:195], v21 offset:53248
    v_mfma_f32_16x16x32_bf16 v[92:95], v[200:203], a[184:187], v[92:95]
    buffer_load_dwordx4 v4, s[20:23], s49 offen offset:3072 sc1 lds
    v_mfma_f32_16x16x32_bf16 v[92:95], v[204:207], a[188:191], v[92:95]
    s_add_u32 s49, s49, 4096
    s_add_u32 m0, s48, 4096
    ds_read_b128 v[196:199], v21 offset:54272
    v_mfma_f32_16x16x32_bf16 v[88:91], v[200:203], a[168:171], v[88:91]
    s_mul_i32 s88, s87, 7168
    s_add_u32 s89, s88, 4096
    s_lshl_b32 s87, s87, 7
    v_mfma_f32_16x16x32_bf16 v[88:91], v[204:207], a[172:175], v[88:91]
    s_waitcnt lgkmcnt(2)
    s_add_u32 s87, s87, 131072
    ds_read_b128 v[200:203], v21 offset:55296
    v_mfma_f32_16x16x32_bf16 v[96:99], v[208:211], a[160:163], v[96:99]
    buffer_load_dwordx4 v4, s[20:23], s49 offen offset:0 sc1 lds
    v_mfma_f32_16x16x32_bf16 v[96:99], v[212:215], a[164:167], v[96:99]
    s_mov_b32 s49, 258048
    s_mul_i32 s99, s86, 7168
    ds_read_b128 v[204:207], v21 offset:56320
    v_mfma_f32_16x16x32_bf16 v[100:103], v[208:211], a[176:179], v[100:103]
    s_lshl_b32 s86, s86, 7
    s_add_u32 s86, s86, 131072
    v_and_b32 v8, 3, v1
    v_mfma_f32_16x16x32_bf16 v[100:103], v[212:215], a[180:183], v[100:103]
    s_add_u32 m0, s31, 36864
    ds_read_b128 v[208:211], v21 offset:57344
    v_lshlrev_b32 v8, 9, v8
    v_mfma_f32_16x16x32_bf16 v[100:103], v[216:219], a[184:187], v[100:103]
    buffer_load_dwordx4 v20, s[20:23], s49 offen offset:0 sc1 lds
    v_mfma_f32_16x16x32_bf16 v[100:103], v[220:223], a[188:191], v[100:103]
    ds_read_b128 v[212:215], v21 offset:58368
    v_mfma_f32_16x16x32_bf16 v[96:99], v[216:219], a[168:171], v[96:99]
    v_mfma_f32_16x16x32_bf16 v[96:99], v[220:223], a[172:175], v[96:99]
    s_waitcnt lgkmcnt(2)
    ds_read_b128 v[216:219], v21 offset:59392
    v_mfma_f32_16x16x32_bf16 v[104:107], v[192:195], a[160:163], v[104:107]
    buffer_load_dwordx4 v20, s[20:23], s49 offen offset:1024 sc1 lds
    v_mfma_f32_16x16x32_bf16 v[104:107], v[196:199], a[164:167], v[104:107]
    ds_read_b128 v[220:223], v21 offset:60416
    v_mfma_f32_16x16x32_bf16 v[108:111], v[192:195], a[176:179], v[108:111]
    v_mfma_f32_16x16x32_bf16 v[108:111], v[196:199], a[180:183], v[108:111]
    ds_read_b128 v[192:195], v21 offset:61440
    v_mfma_f32_16x16x32_bf16 v[108:111], v[200:203], a[184:187], v[108:111]
    buffer_load_dwordx4 v20, s[20:23], s49 offen offset:2048 sc1 lds
    v_mfma_f32_16x16x32_bf16 v[108:111], v[204:207], a[188:191], v[108:111]
    ds_read_b128 v[196:199], v21 offset:62464
    v_mfma_f32_16x16x32_bf16 v[104:107], v[200:203], a[168:171], v[104:107]
    v_mfma_f32_16x16x32_bf16 v[104:107], v[204:207], a[172:175], v[104:107]
    s_waitcnt lgkmcnt(2)
    ds_read_b128 v[200:203], v21 offset:63488
    v_mfma_f32_16x16x32_bf16 v[112:115], v[208:211], a[160:163], v[112:115]
    v_mfma_f32_16x16x32_bf16 v[112:115], v[212:215], a[164:167], v[112:115]
    ds_read_b128 v[204:207], v21 offset:64512
    v_mfma_f32_16x16x32_bf16 v[116:119], v[208:211], a[176:179], v[116:119]
    buffer_load_dwordx4 v20, s[20:23], s49 offen offset:3072 sc1 lds
    v_mfma_f32_16x16x32_bf16 v[116:119], v[212:215], a[180:183], v[116:119]
    s_mov_b32 s49, 262144
    ds_read_b128 v[208:211], v22 offset:0
    v_mfma_f32_16x16x32_bf16 v[116:119], v[216:219], a[184:187], v[116:119]
    v_mfma_f32_16x16x32_bf16 v[116:119], v[220:223], a[188:191], v[116:119]
    s_add_u32 m0, s31, 40960
    ds_read_b128 v[212:215], v22 offset:1024
    v_mfma_f32_16x16x32_bf16 v[112:115], v[216:219], a[168:171], v[112:115]
    buffer_load_dwordx4 v20, s[20:23], s49 offen offset:0 sc1 lds
    v_mfma_f32_16x16x32_bf16 v[112:115], v[220:223], a[172:175], v[112:115]
    s_waitcnt vmcnt(18) lgkmcnt(2)
    ds_read_b128 v[216:219], v22 offset:2048
    v_mfma_f32_16x16x32_bf16 v[64:67], v[192:195], a[192:195], v[64:67]
    v_mfma_f32_16x16x32_bf16 v[64:67], v[196:199], a[196:199], v[64:67]
    ds_read_b128 v[220:223], v22 offset:3072
    v_mfma_f32_16x16x32_bf16 v[68:71], v[192:195], a[208:211], v[68:71]
    v_mfma_f32_16x16x32_bf16 v[68:71], v[196:199], a[212:215], v[68:71]
    ds_read_b128 v[192:195], v22 offset:4096
    v_mfma_f32_16x16x32_bf16 v[68:71], v[200:203], a[216:219], v[68:71]
    buffer_load_dwordx4 v20, s[20:23], s49 offen offset:1024 sc1 lds
    v_mfma_f32_16x16x32_bf16 v[68:71], v[204:207], a[220:223], v[68:71]
    ds_read_b128 v[196:199], v22 offset:5120
    v_mfma_f32_16x16x32_bf16 v[64:67], v[200:203], a[200:203], v[64:67]
    v_mfma_f32_16x16x32_bf16 v[64:67], v[204:207], a[204:207], v[64:67]
    s_waitcnt vmcnt(11) lgkmcnt(2)
    ds_read_b128 v[200:203], v22 offset:6144
    v_mfma_f32_16x16x32_bf16 v[64:67], v[208:211], a[224:227], v[64:67]
    buffer_load_dwordx4 v20, s[20:23], s49 offen offset:2048 sc1 lds
    v_mfma_f32_16x16x32_bf16 v[64:67], v[212:215], a[228:231], v[64:67]
    ds_read_b128 v[204:207], v22 offset:7168
    v_mfma_f32_16x16x32_bf16 v[68:71], v[208:211], a[240:243], v[68:71]
    v_mfma_f32_16x16x32_bf16 v[68:71], v[212:215], a[244:247], v[68:71]
    ds_read_b128 v[208:211], v22 offset:8192
    v_mfma_f32_16x16x32_bf16 v[68:71], v[216:219], a[248:251], v[68:71]
    v_mfma_f32_16x16x32_bf16 v[68:71], v[220:223], a[252:255], v[68:71]
    ds_read_b128 v[212:215], v22 offset:9216
    v_mfma_f32_16x16x32_bf16 v[64:67], v[216:219], a[232:235], v[64:67]
    buffer_load_dwordx4 v20, s[20:23], s49 offen offset:3072 sc1 lds
    v_mfma_f32_16x16x32_bf16 v[64:67], v[220:223], a[236:239], v[64:67]
    s_waitcnt lgkmcnt(2)
    ds_read_b128 v[216:219], v22 offset:10240
    v_mfma_f32_16x16x32_bf16 v[72:75], v[192:195], a[192:195], v[72:75]
    v_mfma_f32_16x16x32_bf16 v[72:75], v[196:199], a[196:199], v[72:75]
    s_mov_b32 s49, 266240
    ds_read_b128 v[220:223], v22 offset:11264
    v_mfma_f32_16x16x32_bf16 v[76:79], v[192:195], a[208:211], v[76:79]
    v_mfma_f32_16x16x32_bf16 v[76:79], v[196:199], a[212:215], v[76:79]
    s_add_u32 m0, s31, 45056
    ds_read_b128 v[192:195], v22 offset:12288
    v_mfma_f32_16x16x32_bf16 v[76:79], v[200:203], a[216:219], v[76:79]
    buffer_load_dwordx4 v20, s[20:23], s49 offen offset:0 sc1 lds
    v_mfma_f32_16x16x32_bf16 v[76:79], v[204:207], a[220:223], v[76:79]
    ds_read_b128 v[196:199], v22 offset:13312
    v_mfma_f32_16x16x32_bf16 v[72:75], v[200:203], a[200:203], v[72:75]
    s_waitcnt vmcnt(9)
    s_barrier
    v_mfma_f32_16x16x32_bf16 v[72:75], v[204:207], a[204:207], v[72:75]
    s_waitcnt lgkmcnt(2)
    ds_read_b128 v[200:203], v22 offset:14336
    v_mfma_f32_16x16x32_bf16 v[72:75], v[208:211], a[224:227], v[72:75]
    v_mfma_f32_16x16x32_bf16 v[72:75], v[212:215], a[228:231], v[72:75]
    s_mov_b32 s49, 294912
    ds_read_b128 v[204:207], v22 offset:15360
    v_mfma_f32_16x16x32_bf16 v[76:79], v[208:211], a[240:243], v[76:79]
    v_mfma_f32_16x16x32_bf16 v[76:79], v[212:215], a[244:247], v[76:79]
    s_add_u32 m0, s31, 73728
    ds_read_b128 v[208:211], v4 offset:0
    v_mfma_f32_16x16x32_bf16 v[76:79], v[216:219], a[248:251], v[76:79]
    buffer_load_dwordx4 v20, s[20:23], s49 offen offset:0 sc1 lds
    v_mfma_f32_16x16x32_bf16 v[76:79], v[220:223], a[252:255], v[76:79]
    ds_read_b128 v[212:215], v4 offset:1024
    v_mfma_f32_16x16x32_bf16 v[72:75], v[216:219], a[232:235], v[72:75]
    v_mfma_f32_16x16x32_bf16 v[72:75], v[220:223], a[236:239], v[72:75]
    s_waitcnt lgkmcnt(2)
    ds_read_b128 v[216:219], v4 offset:2048
    v_mfma_f32_16x16x32_bf16 v[80:83], v[192:195], a[192:195], v[80:83]
    buffer_load_dwordx4 v20, s[20:23], s49 offen offset:1024 sc1 lds
    v_mfma_f32_16x16x32_bf16 v[80:83], v[196:199], a[196:199], v[80:83]
    ds_read_b128 v[220:223], v4 offset:3072
    v_mfma_f32_16x16x32_bf16 v[84:87], v[192:195], a[208:211], v[84:87]
    v_mfma_f32_16x16x32_bf16 v[84:87], v[196:199], a[212:215], v[84:87]
    ds_read_b128 v[192:195], v4 offset:4096
    v_mfma_f32_16x16x32_bf16 v[84:87], v[200:203], a[216:219], v[84:87]
    buffer_load_dwordx4 v20, s[20:23], s49 offen offset:2048 sc1 lds
    v_mfma_f32_16x16x32_bf16 v[84:87], v[204:207], a[220:223], v[84:87]
    ds_read_b128 v[196:199], v4 offset:5120
    v_mfma_f32_16x16x32_bf16 v[80:83], v[200:203], a[200:203], v[80:83]
    v_mfma_f32_16x16x32_bf16 v[80:83], v[204:207], a[204:207], v[80:83]
    s_waitcnt lgkmcnt(2)
    ds_read_b128 v[200:203], v4 offset:6144
    v_mfma_f32_16x16x32_bf16 v[80:83], v[208:211], a[224:227], v[80:83]
    v_cvt_pk_bf16_f32 v32, v64, v65
    v_cvt_pk_bf16_f32 v33, v66, v67
    v_mfma_f32_16x16x32_bf16 v[80:83], v[212:215], a[228:231], v[80:83]
    ds_read_b128 v[204:207], v4 offset:7168
    v_cvt_pk_bf16_f32 v34, v72, v73
    v_mfma_f32_16x16x32_bf16 v[84:87], v[208:211], a[240:243], v[84:87]
    buffer_load_dwordx4 v20, s[20:23], s49 offen offset:3072 sc1 lds
    v_mfma_f32_16x16x32_bf16 v[84:87], v[212:215], a[244:247], v[84:87]
    s_mov_b32 s49, 299008
    ds_read_b128 v[208:211], v4 offset:8192
    v_cvt_pk_bf16_f32 v35, v74, v75
    v_mfma_f32_16x16x32_bf16 v[84:87], v[216:219], a[248:251], v[84:87]
    buffer_store_dwordx4 v[32:35], v4, s[16:19], s88 offen offset:0 sc1
    v_cvt_pk_bf16_f32 v36, v68, v69
    v_mfma_f32_16x16x32_bf16 v[84:87], v[220:223], a[252:255], v[84:87]
    s_add_u32 m0, s31, 77824
    ds_read_b128 v[212:215], v4 offset:9216
    v_cvt_pk_bf16_f32 v37, v70, v71
    v_mfma_f32_16x16x32_bf16 v[80:83], v[216:219], a[232:235], v[80:83]
    buffer_load_dwordx4 v20, s[20:23], s49 offen offset:0 sc1 lds
    v_mfma_f32_16x16x32_bf16 v[80:83], v[220:223], a[236:239], v[80:83]
    s_waitcnt lgkmcnt(2)
    ds_read_b128 v[216:219], v4 offset:10240
    v_cvt_pk_bf16_f32 v38, v76, v77
    v_mfma_f32_16x16x32_bf16 v[88:91], v[192:195], a[192:195], v[88:91]
    v_cvt_pk_bf16_f32 v39, v78, v79
    v_mfma_f32_16x16x32_bf16 v[88:91], v[196:199], a[196:199], v[88:91]
    ds_read_b128 v[220:223], v4 offset:11264
    v_mfma_f32_16x16x32_bf16 v[92:95], v[192:195], a[208:211], v[92:95]
    v_mfma_f32_16x16x32_bf16 v[92:95], v[196:199], a[212:215], v[92:95]
    ds_read_b128 v[192:195], v4 offset:12288
    v_mfma_f32_16x16x32_bf16 v[92:95], v[200:203], a[216:219], v[92:95]
    buffer_load_dwordx4 v20, s[20:23], s49 offen offset:1024 sc1 lds
    v_mfma_f32_16x16x32_bf16 v[92:95], v[204:207], a[220:223], v[92:95]
    ds_read_b128 v[196:199], v4 offset:13312
    v_mfma_f32_16x16x32_bf16 v[88:91], v[200:203], a[200:203], v[88:91]
    buffer_store_dwordx4 v[36:39], v4, s[16:19], s88 offen offset:1024 sc1
    v_mfma_f32_16x16x32_bf16 v[88:91], v[204:207], a[204:207], v[88:91]
    s_waitcnt lgkmcnt(2)
    ds_read_b128 v[200:203], v4 offset:14336
    v_mfma_f32_16x16x32_bf16 v[88:91], v[208:211], a[224:227], v[88:91]
    buffer_load_dwordx4 v20, s[20:23], s49 offen offset:2048 sc1 lds
    v_mfma_f32_16x16x32_bf16 v[88:91], v[212:215], a[228:231], v[88:91]
    ds_read_b128 v[204:207], v4 offset:15360
    v_mfma_f32_16x16x32_bf16 v[92:95], v[208:211], a[240:243], v[92:95]
    v_mfma_f32_16x16x32_bf16 v[92:95], v[212:215], a[244:247], v[92:95]
    ds_read_b128 v[208:211], v4 offset:16384
    v_mfma_f32_16x16x32_bf16 v[92:95], v[216:219], a[248:251], v[92:95]
    v_mfma_f32_16x16x32_bf16 v[92:95], v[220:223], a[252:255], v[92:95]
    ds_read_b128 v[212:215], v4 offset:17408
    v_mfma_f32_16x16x32_bf16 v[88:91], v[216:219], a[232:235], v[88:91]
    buffer_load_dwordx4 v20, s[20:23], s49 offen offset:3072 sc1 lds
    v_mfma_f32_16x16x32_bf16 v[88:91], v[220:223], a[236:239], v[88:91]
    s_waitcnt lgkmcnt(2)
    ds_read_b128 v[216:219], v4 offset:18432
    v_mfma_f32_16x16x32_bf16 v[96:99], v[192:195], a[192:195], v[96:99]
    s_add_u32 s80, s26, 1
    s_and_b32 s80, s80, 3
    s_mul_i32 s80, s80, 28672
    v_mfma_f32_16x16x32_bf16 v[96:99], v[196:199], a[196:199], v[96:99]
    s_mov_b32 s49, 303104
    s_add_u32 s80, s80, s99
    ds_read_b128 v[220:223], v4 offset:19456
    v_mfma_f32_16x16x32_bf16 v[100:103], v[192:195], a[208:211], v[100:103]
    s_add_u32 s81, s26, 2
    s_and_b32 s81, s81, 3
    s_mul_i32 s81, s81, 28672
    v_mfma_f32_16x16x32_bf16 v[100:103], v[196:199], a[212:215], v[100:103]
    s_add_u32 m0, s31, 81920
    s_add_u32 s81, s81, s99
    ds_read_b128 v[192:195], v22 offset:16384
    v_mfma_f32_16x16x32_bf16 v[100:103], v[200:203], a[216:219], v[100:103]
    buffer_load_dwordx4 v20, s[20:23], s49 offen offset:0 sc1 lds
    v_mfma_f32_16x16x32_bf16 v[100:103], v[204:207], a[220:223], v[100:103]
    s_add_u32 s82, s26, 3
    s_and_b32 s82, s82, 3
    ds_read_b128 v[196:199], v22 offset:17408
    v_mfma_f32_16x16x32_bf16 v[96:99], v[200:203], a[200:203], v[96:99]
    s_mul_i32 s82, s82, 28672
    s_add_u32 s82, s82, s99
    v_add_u32 v19, 4096, v4
    v_mfma_f32_16x16x32_bf16 v[96:99], v[204:207], a[204:207], v[96:99]
    s_waitcnt lgkmcnt(2)
    ds_read_b128 v[200:203], v22 offset:18432
    v_mfma_f32_16x16x32_bf16 v[96:99], v[208:211], a[224:227], v[96:99]
    v_cvt_pk_bf16_f32 v40, v80, v81
    v_cvt_pk_bf16_f32 v41, v82, v83
    v_mfma_f32_16x16x32_bf16 v[96:99], v[212:215], a[228:231], v[96:99]
    ds_read_b128 v[204:207], v22 offset:19456
    v_cvt_pk_bf16_f32 v42, v88, v89
    v_mfma_f32_16x16x32_bf16 v[100:103], v[208:211], a[240:243], v[100:103]
    v_cvt_pk_bf16_f32 v43, v90, v91
    v_mfma_f32_16x16x32_bf16 v[100:103], v[212:215], a[244:247], v[100:103]
    ds_read_b128 v[208:211], v22 offset:20480
    v_mfma_f32_16x16x32_bf16 v[100:103], v[216:219], a[248:251], v[100:103]
    buffer_store_dwordx4 v[40:43], v4, s[16:19], s88 offen offset:2048 sc1
    v_cvt_pk_bf16_f32 v44, v84, v85
    v_mfma_f32_16x16x32_bf16 v[100:103], v[220:223], a[252:255], v[100:103]
    ds_read_b128 v[212:215], v22 offset:21504
    v_cvt_pk_bf16_f32 v45, v86, v87
    v_mfma_f32_16x16x32_bf16 v[96:99], v[216:219], a[232:235], v[96:99]
    v_cvt_pk_bf16_f32 v46, v92, v93
    v_cvt_pk_bf16_f32 v47, v94, v95
    v_mfma_f32_16x16x32_bf16 v[96:99], v[220:223], a[236:239], v[96:99]
    s_waitcnt lgkmcnt(2)
    ds_read_b128 v[216:219], v22 offset:22528
    v_mfma_f32_16x16x32_bf16 v[104:107], v[192:195], a[192:195], v[104:107]
    v_mfma_f32_16x16x32_bf16 v[104:107], v[196:199], a[196:199], v[104:107]
    ds_read_b128 v[220:223], v22 offset:23552
    v_mfma_f32_16x16x32_bf16 v[108:111], v[192:195], a[208:211], v[108:111]
    v_mfma_f32_16x16x32_bf16 v[108:111], v[196:199], a[212:215], v[108:111]
    ds_read_b128 v[192:195], v22 offset:24576
    v_mfma_f32_16x16x32_bf16 v[108:111], v[200:203], a[216:219], v[108:111]
    s_add_u32 s32, s4, 0x980000
    s_addc_u32 s33, s5, 0
    s_mul_i32 s48, s29, 36864
    v_mfma_f32_16x16x32_bf16 v[108:111], v[204:207], a[220:223], v[108:111]
    s_lshr_b32 s41, s30, 1
    s_lshl_b32 s42, s41, 3
    ds_read_b128 v[196:199], v22 offset:25600
    v_mfma_f32_16x16x32_bf16 v[104:107], v[200:203], a[200:203], v[104:107]
    s_add_u32 s48, s48, s42
    buffer_store_dwordx4 v[44:47], v4, s[16:19], s88 offen offset:3072 sc1
    v_mfma_f32_16x16x32_bf16 v[104:107], v[204:207], a[204:207], v[104:107]
    s_waitcnt lgkmcnt(2)
    s_add_u32 s50, s48, 18432
    ds_read_b128 v[200:203], v22 offset:26624
    v_mfma_f32_16x16x32_bf16 v[104:107], v[208:211], a[224:227], v[104:107]
    s_and_b32 s42, s30, 1
    s_mul_i32 s43, s30, 36
    s_lshl_b32 s44, s42, 2
    v_mfma_f32_16x16x32_bf16 v[104:107], v[212:215], a[228:231], v[104:107]
    s_add_u32 s44, s44, s43
    s_lshl_b32 s40, s26, 3
    ds_read_b128 v[204:207], v22 offset:27648
    v_mfma_f32_16x16x32_bf16 v[108:111], v[208:211], a[240:243], v[108:111]
    s_add_u32 s44, s44, s40
    s_xor_b32 s42, s42, 1
    s_lshl_b32 s42, s42, 5
    v_mfma_f32_16x16x32_bf16 v[108:111], v[212:215], a[244:247], v[108:111]
    s_add_u32 s43, s43, s42
    s_sub_u32 s40, 142, s44
    ds_read_b128 v[208:211], v22 offset:28672
    v_mfma_f32_16x16x32_bf16 v[108:111], v[216:219], a[248:251], v[108:111]
    s_sub_u32 s42, 143, s43
    s_cmp_eq_u32 s41, 0
    s_cselect_b32 s44, s44, s40
    s_cselect_b32 s43, s43, s42
    s_cselect_b32 s41, 1, -1
    v_mfma_f32_16x16x32_bf16 v[108:111], v[220:223], a[252:255], v[108:111]
    ds_read_b128 v[212:215], v22 offset:29696
    v_mul_lo_u32 v14, v3, s41
    v_mfma_f32_16x16x32_bf16 v[104:107], v[216:219], a[232:235], v[104:107]
    s_waitcnt vmcnt(13)
    s_barrier
    v_add_u32 v15, s43, v14
    v_mfma_f32_16x16x32_bf16 v[104:107], v[220:223], a[236:239], v[104:107]
    s_waitcnt lgkmcnt(2)
    ds_read_b128 v[216:219], v22 offset:30720
    v_lshl_add_u32 v14, v14, 1, s44
    v_mfma_f32_16x16x32_bf16 v[112:115], v[192:195], a[192:195], v[112:115]
    v_add_u32 v17, 2, v14
    v_mfma_f32_16x16x32_bf16 v[112:115], v[196:199], a[196:199], v[112:115]
    ds_read_b128 v[220:223], v22 offset:31744
    v_mfma_f32_16x16x32_bf16 v[116:119], v[192:195], a[208:211], v[116:119]
    v_cmp_gt_u32 vcc, 72, v17
    s_nop 1
    v_cndmask_b32 v17, 0, v17, vcc
    v_mfma_f32_16x16x32_bf16 v[116:119], v[196:199], a[212:215], v[116:119]
    ds_read_b128 v[192:195], v4 offset:36864
    v_lshlrev_b32 v18, 4, v2
    v_mfma_f32_16x16x32_bf16 v[116:119], v[200:203], a[216:219], v[116:119]
    v_lshl_add_u32 v14, v14, 8, v18
    v_lshl_add_u32 v15, v15, 8, v18
    v_mfma_f32_16x16x32_bf16 v[116:119], v[204:207], a[220:223], v[116:119]
    ds_read_b128 v[196:199], v4 offset:37888
    v_lshl_add_u32 v17, v17, 8, v18
    v_mfma_f32_16x16x32_bf16 v[112:115], v[200:203], a[200:203], v[112:115]
    s_lshl_b32 s53, s29, 8
    s_add_u32 s53, s53, 2359296
    v_lshlrev_b32 v18, 3, v2
    v_mfma_f32_16x16x32_bf16 v[112:115], v[204:207], a[204:207], v[112:115]
    s_waitcnt lgkmcnt(2)
    s_lshr_b32 s40, s29, 1
    ds_read_b128 v[200:203], v4 offset:38912
    v_mfma_f32_16x16x32_bf16 v[112:115], v[208:211], a[224:227], v[112:115]
    s_sub_u32 s42, 64, s40
    v_cvt_pk_bf16_f32 v48, v96, v97
    v_cvt_pk_bf16_f32 v49, v98, v99
    v_mfma_f32_16x16x32_bf16 v[112:115], v[212:215], a[228:231], v[112:115]
    ds_read_b128 v[204:207], v4 offset:39936
    v_cvt_pk_bf16_f32 v50, v104, v105
    v_mfma_f32_16x16x32_bf16 v[116:119], v[208:211], a[240:243], v[116:119]
    s_cmp_eq_u32 s40, 0
    s_cselect_b32 s42, 32, s42
    v_cvt_pk_bf16_f32 v51, v106, v107
    v_mfma_f32_16x16x32_bf16 v[116:119], v[212:215], a[244:247], v[116:119]
    s_bitcmp0_b32 s29, 0
    s_cselect_b32 s42, s40, s42
    ds_read_b128 v[208:211], v4 offset:40960
    v_mfma_f32_16x16x32_bf16 v[116:119], v[216:219], a[248:251], v[116:119]
    buffer_store_dwordx4 v[48:51], v4, s[16:19], s89 offen offset:0 sc1
    v_cvt_pk_bf16_f32 v52, v100, v101
    v_mfma_f32_16x16x32_bf16 v[116:119], v[220:223], a[252:255], v[116:119]
    s_mul_i32 s42, s42, 1152
    ds_read_b128 v[212:215], v4 offset:41984
    v_cvt_pk_bf16_f32 v53, v102, v103
    v_mfma_f32_16x16x32_bf16 v[112:115], v[216:219], a[232:235], v[112:115]
    s_mul_i32 s40, s30, 288
    v_cvt_pk_bf16_f32 v54, v108, v109
    v_cvt_pk_bf16_f32 v55, v110, v111
    v_mfma_f32_16x16x32_bf16 v[112:115], v[220:223], a[236:239], v[112:115]
    s_waitcnt lgkmcnt(2)
    s_add_u32 s42, s42, s40
    ds_read_b128 v[216:219], v4 offset:43008
    v_mfma_f32_16x16x32_bf16 v[120:123], v[192:195], v[160:163], 0
    s_and_b32 s40, s30, 1
    s_lshl_b32 s41, s40, 5
    s_add_u32 s41, s41, s42
    v_mfma_f32_16x16x32_bf16 v[120:123], v[196:199], v[164:167], v[120:123]
    s_lshl_b32 s43, s26, 6
    s_add_u32 s41, s41, s43
    ds_read_b128 v[220:223], v4 offset:44032
    v_mfma_f32_16x16x32_bf16 v[124:127], v[192:195], v[176:179], 0
    s_xor_b32 s40, s40, 1
    s_lshl_b32 s40, s40, 8
    s_add_u32 s40, s40, s42
    v_mfma_f32_16x16x32_bf16 v[124:127], v[196:199], v[180:183], v[124:127]
    s_add_u32 s42, s40, 1179648
    s_add_u32 s43, s41, 1179648
    ds_read_b128 v[192:195], v4 offset:45056
    v_mfma_f32_16x16x32_bf16 v[124:127], v[200:203], v[184:187], v[124:127]
    v_lshrrev_b32 v9, 2, v1
    v_and_b32 v10, 3, v1
    v_mfma_f32_16x16x32_bf16 v[124:127], v[204:207], v[188:191], v[124:127]
    ds_read_b128 v[196:199], v4 offset:46080
    v_lshl_add_u32 v11, v10, 4, v9
    v_mfma_f32_16x16x32_bf16 v[120:123], v[200:203], v[168:171], v[120:123]
    buffer_store_dwordx4 v[52:55], v4, s[16:19], s89 offen offset:1024 sc1
    v_lshlrev_b32 v11, 4, v11
    v_mfma_f32_16x16x32_bf16 v[120:123], v[204:207], v[172:175], v[120:123]
    s_waitcnt lgkmcnt(2)
    s_lshl_b32 s44, s3, 11
    ds_read_b128 v[200:203], v4 offset:47104
    v_mfma_f32_16x16x32_bf16 v[224:227], v[208:211], v[160:163], 0
    s_add_u32 s44, s44, 0
    v_cvt_pk_bf16_f32 v56, v112, v113
    v_cvt_pk_bf16_f32 v57, v114, v115
    v_mfma_f32_16x16x32_bf16 v[224:227], v[212:215], v[164:167], v[224:227]
    ds_read_b128 v[204:207], v4 offset:48128
    v_cvt_pk_bf16_f32 v58, v116, v117
    v_mfma_f32_16x16x32_bf16 v[228:231], v[208:211], v[176:179], 0
    v_cvt_pk_bf16_f32 v59, v118, v119
    v_add_u32 v11, s44, v11
    v_mfma_f32_16x16x32_bf16 v[228:231], v[212:215], v[180:183], v[228:231]
    ds_read_b128 v[208:211], v4 offset:49152
    v_add_u32 v12, s44, v4
    v_mfma_f32_16x16x32_bf16 v[228:231], v[216:219], v[184:187], v[228:231]
    buffer_store_dwordx4 v[56:59], v4, s[16:19], s89 offen offset:2048 sc1
    v_mul_u32_u24 v9, 73728, v9
    v_mfma_f32_16x16x32_bf16 v[228:231], v[220:223], v[188:191], v[228:231]
    ds_read_b128 v[212:215], v4 offset:50176
    v_lshl_add_u32 v9, v10, 4, v9
    v_mfma_f32_16x16x32_bf16 v[224:227], v[216:219], v[168:171], v[224:227]
    v_mul_u32_u24 v10, 73728, v2
    v_lshl_add_u32 v10, v3, 3, v10
    v_mfma_f32_16x16x32_bf16 v[224:227], v[220:223], v[172:175], v[224:227]
    s_waitcnt lgkmcnt(2)
    ds_read_b128 v[216:219], v4 offset:51200
    v_mfma_f32_16x16x32_bf16 v[120:123], v[192:195], a[0:3], v[120:123]
    v_mfma_f32_16x16x32_bf16 v[120:123], v[196:199], a[4:7], v[120:123]
    ds_read_b128 v[220:223], v4 offset:52224
    v_mfma_f32_16x16x32_bf16 v[124:127], v[192:195], a[16:19], v[124:127]
    v_mfma_f32_16x16x32_bf16 v[124:127], v[196:199], a[20:23], v[124:127]
    ds_read_b128 v[192:195], v4 offset:53248
    v_mfma_f32_16x16x32_bf16 v[124:127], v[200:203], a[24:27], v[124:127]
    v_mfma_f32_16x16x32_bf16 v[124:127], v[204:207], a[28:31], v[124:127]
    ds_read_b128 v[196:199], v4 offset:54272
    v_mfma_f32_16x16x32_bf16 v[120:123], v[200:203], a[8:11], v[120:123]
    buffer_load_dwordx2 v[128:129], v14, s[32:35], s48 offen sc1
    v_mfma_f32_16x16x32_bf16 v[120:123], v[204:207], a[12:15], v[120:123]
    s_waitcnt lgkmcnt(2)
    ds_read_b128 v[200:203], v4 offset:55296
    v_mfma_f32_16x16x32_bf16 v[224:227], v[208:211], a[0:3], v[224:227]
    v_mfma_f32_16x16x32_bf16 v[224:227], v[212:215], a[4:7], v[224:227]
    ds_read_b128 v[204:207], v4 offset:56320
    v_mfma_f32_16x16x32_bf16 v[228:231], v[208:211], a[16:19], v[228:231]
    v_mfma_f32_16x16x32_bf16 v[228:231], v[212:215], a[20:23], v[228:231]
    ds_read_b128 v[208:211], v4 offset:57344
    v_mfma_f32_16x16x32_bf16 v[228:231], v[216:219], a[24:27], v[228:231]
    buffer_load_dwordx2 v[130:131], v14, s[32:35], s48 offen offset:256 sc1
    v_mfma_f32_16x16x32_bf16 v[228:231], v[220:223], a[28:31], v[228:231]
    ds_read_b128 v[212:215], v4 offset:58368
    v_mfma_f32_16x16x32_bf16 v[224:227], v[216:219], a[8:11], v[224:227]
    v_mfma_f32_16x16x32_bf16 v[224:227], v[220:223], a[12:15], v[224:227]
    s_waitcnt lgkmcnt(2)
    ds_read_b128 v[216:219], v4 offset:59392
    v_mfma_f32_16x16x32_bf16 v[120:123], v[192:195], a[32:35], v[120:123]
    v_mfma_f32_16x16x32_bf16 v[120:123], v[196:199], a[36:39], v[120:123]
    ds_read_b128 v[220:223], v4 offset:60416
    v_mfma_f32_16x16x32_bf16 v[124:127], v[192:195], a[48:51], v[124:127]
    buffer_load_dwordx2 v[132:133], v15, s[32:35], s48 offen sc1
    v_mfma_f32_16x16x32_bf16 v[124:127], v[196:199], a[52:55], v[124:127]
    ds_read_b128 v[192:195], v4 offset:61440
    v_mfma_f32_16x16x32_bf16 v[124:127], v[200:203], a[56:59], v[124:127]
    v_mfma_f32_16x16x32_bf16 v[124:127], v[204:207], a[60:63], v[124:127]
    ds_read_b128 v[196:199], v4 offset:62464
    v_mfma_f32_16x16x32_bf16 v[120:123], v[200:203], a[40:43], v[120:123]
    v_mfma_f32_16x16x32_bf16 v[120:123], v[204:207], a[44:47], v[120:123]
    s_waitcnt lgkmcnt(2)
    ds_read_b128 v[200:203], v4 offset:63488
    v_mfma_f32_16x16x32_bf16 v[224:227], v[208:211], a[32:35], v[224:227]
    v_mfma_f32_16x16x32_bf16 v[224:227], v[212:215], a[36:39], v[224:227]
    ds_read_b128 v[204:207], v4 offset:64512
    v_mfma_f32_16x16x32_bf16 v[228:231], v[208:211], a[48:51], v[228:231]
    buffer_load_dword v134, v17, s[32:35], s48 offen sc1
    v_mfma_f32_16x16x32_bf16 v[228:231], v[212:215], a[52:55], v[228:231]
    ds_read_b128 v[208:211], v21 offset:0
    v_mfma_f32_16x16x32_bf16 v[228:231], v[216:219], a[56:59], v[228:231]
    v_mfma_f32_16x16x32_bf16 v[228:231], v[220:223], a[60:63], v[228:231]
    ds_read_b128 v[212:215], v21 offset:1024
    v_mfma_f32_16x16x32_bf16 v[224:227], v[216:219], a[40:43], v[224:227]
    v_mfma_f32_16x16x32_bf16 v[224:227], v[220:223], a[44:47], v[224:227]
    s_waitcnt lgkmcnt(2)
    ds_read_b128 v[216:219], v21 offset:2048
    v_mfma_f32_16x16x32_bf16 v[120:123], v[192:195], a[64:67], v[120:123]
    buffer_load_dword v135, v15, s[32:35], s48 offen offset:256 sc1
    v_mfma_f32_16x16x32_bf16 v[120:123], v[196:199], a[68:71], v[120:123]
    ds_read_b128 v[220:223], v21 offset:3072
    v_mfma_f32_16x16x32_bf16 v[124:127], v[192:195], a[80:83], v[124:127]
    v_mfma_f32_16x16x32_bf16 v[124:127], v[196:199], a[84:87], v[124:127]
    ds_read_b128 v[192:195], v21 offset:4096
    v_mfma_f32_16x16x32_bf16 v[124:127], v[200:203], a[88:91], v[124:127]
    v_mfma_f32_16x16x32_bf16 v[124:127], v[204:207], a[92:95], v[124:127]
    ds_read_b128 v[196:199], v21 offset:5120
    v_mfma_f32_16x16x32_bf16 v[120:123], v[200:203], a[72:75], v[120:123]
    s_waitcnt vmcnt(10)
    s_barrier
    v_mfma_f32_16x16x32_bf16 v[120:123], v[204:207], a[76:79], v[120:123]
    s_waitcnt lgkmcnt(2)
    ds_read_b128 v[200:203], v21 offset:6144
    v_mfma_f32_16x16x32_bf16 v[224:227], v[208:211], a[64:67], v[224:227]
    buffer_load_dwordx2 v[152:153], v18, s[32:35], s53 offen offset:0 sc1
    v_mfma_f32_16x16x32_bf16 v[224:227], v[212:215], a[68:71], v[224:227]
    ds_read_b128 v[204:207], v21 offset:7168
    v_mfma_f32_16x16x32_bf16 v[228:231], v[208:211], a[80:83], v[228:231]
    v_mfma_f32_16x16x32_bf16 v[228:231], v[212:215], a[84:87], v[228:231]
    ds_read_b128 v[208:211], v21 offset:8192
    v_mfma_f32_16x16x32_bf16 v[228:231], v[216:219], a[88:91], v[228:231]
    v_mfma_f32_16x16x32_bf16 v[228:231], v[220:223], a[92:95], v[228:231]
    ds_read_b128 v[212:215], v21 offset:9216
    v_mfma_f32_16x16x32_bf16 v[224:227], v[216:219], a[72:75], v[224:227]
    buffer_load_dwordx2 v[138:139], v14, s[32:35], s50 offen sc1
    v_mfma_f32_16x16x32_bf16 v[224:227], v[220:223], a[76:79], v[224:227]
    s_waitcnt lgkmcnt(2)
    ds_read_b128 v[216:219], v21 offset:10240
    v_mfma_f32_16x16x32_bf16 v[120:123], v[192:195], a[96:99], v[120:123]
    v_mfma_f32_16x16x32_bf16 v[120:123], v[196:199], a[100:103], v[120:123]
    ds_read_b128 v[220:223], v21 offset:11264
    v_mfma_f32_16x16x32_bf16 v[124:127], v[192:195], a[112:115], v[124:127]
    v_mfma_f32_16x16x32_bf16 v[124:127], v[196:199], a[116:119], v[124:127]
    ds_read_b128 v[192:195], v21 offset:12288
    v_mfma_f32_16x16x32_bf16 v[124:127], v[200:203], a[120:123], v[124:127]
    v_mov_b32 v24, s6
    v_mfma_f32_16x16x32_bf16 v[124:127], v[204:207], a[124:127], v[124:127]
    s_waitcnt vmcnt(7)
    ds_read_b128 v[196:199], v21 offset:13312
    v_mfma_f32_16x16x32_bf16 v[120:123], v[200:203], a[104:107], v[120:123]
    buffer_store_dword v24, v23, s[12:15], s87 offen sc1
    v_mfma_f32_16x16x32_bf16 v[120:123], v[204:207], a[108:111], v[120:123]
    s_waitcnt lgkmcnt(2)
    ds_read_b128 v[200:203], v21 offset:14336
Lhop11:
    s_cbranch_execz Lhopret
    v_mfma_f32_16x16x32_bf16 v[224:227], v[208:211], a[96:99], v[224:227]
    buffer_load_dwordx2 v[140:141], v14, s[32:35], s50 offen offset:256 sc1
    v_mfma_f32_16x16x32_bf16 v[224:227], v[212:215], a[100:103], v[224:227]
    ds_read_b128 v[204:207], v21 offset:15360
    v_mfma_f32_16x16x32_bf16 v[228:231], v[208:211], a[112:115], v[228:231]
    v_mfma_f32_16x16x32_bf16 v[228:231], v[212:215], a[116:119], v[228:231]
    ds_read_b128 v[208:211], v21 offset:16384
    v_mfma_f32_16x16x32_bf16 v[228:231], v[216:219], a[120:123], v[228:231]
    v_mfma_f32_16x16x32_bf16 v[228:231], v[220:223], a[124:127], v[228:231]
    ds_read_b128 v[212:215], v21 offset:17408
    v_mfma_f32_16x16x32_bf16 v[224:227], v[216:219], a[104:107], v[224:227]
    buffer_load_dwordx2 v[142:143], v15, s[32:35], s50 offen sc1
    v_mfma_f32_16x16x32_bf16 v[224:227], v[220:223], a[108:111], v[224:227]
    s_waitcnt lgkmcnt(2)
    ds_read_b128 v[216:219], v21 offset:18432
    v_mfma_f32_16x16x32_bf16 v[120:123], v[192:195], a[128:131], v[120:123]
    v_mfma_f32_16x16x32_bf16 v[120:123], v[196:199], a[132:135], v[120:123]
    ds_read_b128 v[220:223], v21 offset:19456
    v_mfma_f32_16x16x32_bf16 v[124:127], v[192:195], a[144:147], v[124:127]
    v_mfma_f32_16x16x32_bf16 v[124:127], v[196:199], a[148:151], v[124:127]
    ds_read_b128 v[192:195], v21 offset:20480
    v_mfma_f32_16x16x32_bf16 v[124:127], v[200:203], a[152:155], v[124:127]
    buffer_load_dword v144, v17, s[32:35], s50 offen sc1
    v_mfma_f32_16x16x32_bf16 v[124:127], v[204:207], a[156:159], v[124:127]
    ds_read_b128 v[196:199], v21 offset:21504
    v_mfma_f32_16x16x32_bf16 v[120:123], v[200:203], a[136:139], v[120:123]
    v_mfma_f32_16x16x32_bf16 v[120:123], v[204:207], a[140:143], v[120:123]
    s_waitcnt lgkmcnt(2)
    ds_read_b128 v[200:203], v21 offset:22528
    v_mfma_f32_16x16x32_bf16 v[224:227], v[208:211], a[128:131], v[224:227]
    v_mfma_f32_16x16x32_bf16 v[224:227], v[212:215], a[132:135], v[224:227]
    ds_read_b128 v[204:207], v21 offset:23552
    v_mfma_f32_16x16x32_bf16 v[228:231], v[208:211], a[144:147], v[228:231]
    v_mfma_f32_16x16x32_bf16 v[228:231], v[212:215], a[148:151], v[228:231]
    ds_read_b128 v[208:211], v21 offset:24576
    v_mfma_f32_16x16x32_bf16 v[228:231], v[216:219], a[152:155], v[228:231]
    buffer_load_dword v145, v15, s[32:35], s50 offen offset:256 sc1
    v_mfma_f32_16x16x32_bf16 v[228:231], v[220:223], a[156:159], v[228:231]
    ds_read_b128 v[212:215], v21 offset:25600
    v_mfma_f32_16x16x32_bf16 v[224:227], v[216:219], a[136:139], v[224:227]
    v_mfma_f32_16x16x32_bf16 v[224:227], v[220:223], a[140:143], v[224:227]
    s_waitcnt lgkmcnt(2)
    ds_read_b128 v[216:219], v21 offset:26624
    v_mfma_f32_16x16x32_bf16 v[120:123], v[192:195], a[160:163], v[120:123]
    v_mfma_f32_16x16x32_bf16 v[120:123], v[196:199], a[164:167], v[120:123]
    ds_read_b128 v[220:223], v21 offset:27648
    v_mfma_f32_16x16x32_bf16 v[124:127], v[192:195], a[176:179], v[124:127]
    buffer_load_dwordx2 v[154:155], v18, s[32:35], s53 offen offset:128 sc1
    v_mfma_f32_16x16x32_bf16 v[124:127], v[196:199], a[180:183], v[124:127]
    s_mov_b32 s53, 0xffff0000
    ds_read_b128 v[192:195], v21 offset:28672
    v_mfma_f32_16x16x32_bf16 v[124:127], v[200:203], a[184:187], v[124:127]
    v_mfma_f32_16x16x32_bf16 v[124:127], v[204:207], a[188:191], v[124:127]
    ds_read_b128 v[196:199], v21 offset:29696
    v_mfma_f32_16x16x32_bf16 v[120:123], v[200:203], a[168:171], v[120:123]
    v_mfma_f32_16x16x32_bf16 v[120:123], v[204:207], a[172:175], v[120:123]
    s_waitcnt lgkmcnt(2)
    ds_read_b128 v[200:203], v21 offset:30720
    v_mfma_f32_16x16x32_bf16 v[224:227], v[208:211], a[160:163], v[224:227]
    v_mfma_f32_16x16x32_bf16 v[224:227], v[212:215], a[164:167], v[224:227]
    ds_read_b128 v[204:207], v21 offset:31744
    v_mfma_f32_16x16x32_bf16 v[228:231], v[208:211], a[176:179], v[228:231]
    v_mfma_f32_16x16x32_bf16 v[228:231], v[212:215], a[180:183], v[228:231]
    ds_read_b128 v[208:211], v21 offset:32768
    v_mfma_f32_16x16x32_bf16 v[228:231], v[216:219], a[184:187], v[228:231]
    v_mfma_f32_16x16x32_bf16 v[228:231], v[220:223], a[188:191], v[228:231]
    ds_read_b128 v[212:215], v21 offset:33792
    v_mfma_f32_16x16x32_bf16 v[224:227], v[216:219], a[168:171], v[224:227]
    v_mfma_f32_16x16x32_bf16 v[224:227], v[220:223], a[172:175], v[224:227]
    s_waitcnt lgkmcnt(2)
    ds_read_b128 v[216:219], v21 offset:34816
    v_mfma_f32_16x16x32_bf16 v[120:123], v[192:195], a[192:195], v[120:123]
    v_mfma_f32_16x16x32_bf16 v[120:123], v[196:199], a[196:199], v[120:123]
    ds_read_b128 v[220:223], v21 offset:35840
    v_mfma_f32_16x16x32_bf16 v[124:127], v[192:195], a[208:211], v[124:127]
    v_mfma_f32_16x16x32_bf16 v[124:127], v[196:199], a[212:215], v[124:127]
    ds_read_b128 v[192:195], v21 offset:36864
    v_mfma_f32_16x16x32_bf16 v[124:127], v[200:203], a[216:219], v[124:127]
    v_mfma_f32_16x16x32_bf16 v[124:127], v[204:207], a[220:223], v[124:127]
    ds_read_b128 v[196:199], v21 offset:37888
    v_mfma_f32_16x16x32_bf16 v[120:123], v[200:203], a[200:203], v[120:123]
    v_mfma_f32_16x16x32_bf16 v[120:123], v[204:207], a[204:207], v[120:123]
    s_waitcnt lgkmcnt(2)
    ds_read_b128 v[200:203], v21 offset:38912
    v_mfma_f32_16x16x32_bf16 v[224:227], v[208:211], a[192:195], v[224:227]
    buffer_load_dword v31, v8, s[12:15], s86 offen sc1
    v_mfma_f32_16x16x32_bf16 v[224:227], v[212:215], a[196:199], v[224:227]
    ds_read_b128 v[204:207], v21 offset:39936
    v_mfma_f32_16x16x32_bf16 v[228:231], v[208:211], a[208:211], v[228:231]
    v_mfma_f32_16x16x32_bf16 v[228:231], v[212:215], a[212:215], v[228:231]
    ds_read_b128 v[208:211], v21 offset:40960
    v_mfma_f32_16x16x32_bf16 v[228:231], v[216:219], a[216:219], v[228:231]
    v_mfma_f32_16x16x32_bf16 v[228:231], v[220:223], a[220:223], v[228:231]
    ds_read_b128 v[212:215], v21 offset:41984
    v_mfma_f32_16x16x32_bf16 v[224:227], v[216:219], a[200:203], v[224:227]
    v_mfma_f32_16x16x32_bf16 v[224:227], v[220:223], a[204:207], v[224:227]
    s_waitcnt lgkmcnt(2)
    ds_read_b128 v[216:219], v21 offset:43008
    v_mfma_f32_16x16x32_bf16 v[120:123], v[192:195], a[224:227], v[120:123]
    v_mfma_f32_16x16x32_bf16 v[120:123], v[196:199], a[228:231], v[120:123]
    ds_read_b128 v[220:223], v21 offset:44032
    v_mfma_f32_16x16x32_bf16 v[124:127], v[192:195], a[240:243], v[124:127]
    v_mfma_f32_16x16x32_bf16 v[124:127], v[196:199], a[244:247], v[124:127]
    v_mfma_f32_16x16x32_bf16 v[124:127], v[200:203], a[248:251], v[124:127]
    v_mfma_f32_16x16x32_bf16 v[124:127], v[204:207], a[252:255], v[124:127]
    v_mfma_f32_16x16x32_bf16 v[120:123], v[200:203], a[232:235], v[120:123]
    v_mfma_f32_16x16x32_bf16 v[120:123], v[204:207], a[236:239], v[120:123]
    s_waitcnt lgkmcnt(0)
    v_mfma_f32_16x16x32_bf16 v[224:227], v[208:211], a[224:227], v[224:227]
    v_mfma_f32_16x16x32_bf16 v[224:227], v[212:215], a[228:231], v[224:227]
    v_mfma_f32_16x16x32_bf16 v[228:231], v[208:211], a[240:243], v[228:231]
    v_mfma_f32_16x16x32_bf16 v[228:231], v[212:215], a[244:247], v[228:231]
    v_mfma_f32_16x16x32_bf16 v[228:231], v[216:219], a[248:251], v[228:231]
    v_mfma_f32_16x16x32_bf16 v[228:231], v[220:223], a[252:255], v[228:231]
    v_mfma_f32_16x16x32_bf16 v[224:227], v[216:219], a[232:235], v[224:227]
    v_mfma_f32_16x16x32_bf16 v[224:227], v[220:223], a[236:239], v[224:227]
    s_load_dwordx2 s[24:25], s[0:1], 72
    s_waitcnt vmcnt(0)
    v_cmp_ne_u32 vcc, s6, v31
    s_nop 1
    s_cbranch_vccnz Lslow_32
Lback_33:
    buffer_load_dwordx4 v[32:35], v19, s[16:19], s80 offen offset:0 sc1
    buffer_load_dwordx4 v[36:39], v19, s[16:19], s80 offen offset:1024 sc1
    buffer_load_dwordx4 v[40:43], v19, s[16:19], s80 offen offset:2048 sc1
    buffer_load_dwordx4 v[44:47], v4, s[16:19], s81 offen offset:2048 sc1
    buffer_load_dwordx4 v[48:51], v4, s[16:19], s81 offen offset:3072 sc1
    buffer_load_dwordx4 v[52:55], v19, s[16:19], s81 offen offset:2048 sc1
    buffer_load_dwordx4 v[232:235], v4, s[16:19], s82 offen offset:0 sc1
    buffer_load_dwordx4 v[236:239], v4, s[16:19], s82 offen offset:1024 sc1
    buffer_load_dwordx4 v[240:243], v19, s[16:19], s82 offen offset:2048 sc1
    s_cmp_ge_u32 s30, 2
    s_cbranch_scc1 Lmir_34
    v_lshlrev_b32 v64, 16, v128
    v_and_b32 v65, s53, v128
    v_lshlrev_b32 v66, 16, v129
    v_and_b32 v67, s53, v129
    v_lshlrev_b32 v68, 16, v130
    v_and_b32 v69, s53, v130
    v_lshlrev_b32 v70, 16, v131
    v_and_b32 v71, s53, v131
    v_lshlrev_b32 v72, 16, v132
    v_and_b32 v73, s53, v132
    v_lshlrev_b32 v74, 16, v133
    v_and_b32 v75, s53, v133
    v_lshlrev_b32 v76, 16, v138
    v_and_b32 v77, s53, v138
    v_lshlrev_b32 v78, 16, v139
    v_and_b32 v79, s53, v139
    v_lshlrev_b32 v80, 16, v140
    v_and_b32 v81, s53, v140
    v_lshlrev_b32 v82, 16, v141
    v_and_b32 v83, s53, v141
    v_lshlrev_b32 v84, 16, v142
    v_and_b32 v85, s53, v142
    v_lshlrev_b32 v86, 16, v143
    v_and_b32 v87, s53, v143
    s_branch Lunp_35
Lmir_34:
    v_lshlrev_b32 v64, 16, v134
    v_and_b32 v65, s53, v131
    v_lshlrev_b32 v66, 16, v131
    v_and_b32 v67, s53, v130
    v_lshlrev_b32 v68, 16, v130
    v_and_b32 v69, s53, v129
    v_lshlrev_b32 v70, 16, v129
    v_and_b32 v71, s53, v128
    v_lshlrev_b32 v72, 16, v135
    v_and_b32 v73, s53, v133
    v_lshlrev_b32 v74, 16, v133
    v_and_b32 v75, s53, v132
    v_lshlrev_b32 v76, 16, v144
    v_and_b32 v77, s53, v141
    v_lshlrev_b32 v78, 16, v141
    v_and_b32 v79, s53, v140
    v_lshlrev_b32 v80, 16, v140
    v_and_b32 v81, s53, v139
    v_lshlrev_b32 v82, 16, v139
    v_and_b32 v83, s53, v138
    v_lshlrev_b32 v84, 16, v145
    v_and_b32 v85, s53, v143
    v_lshlrev_b32 v86, 16, v143
    v_and_b32 v87, s53, v142
Lunp_35:
    v_pk_fma_f32 v[64:65], v[64:65], v[152:153], v[152:153] op_sel:[0,0,1] op_sel_hi:[1,0,1]
    v_pk_fma_f32 v[66:67], v[66:67], v[152:153], v[152:153] op_sel:[0,0,1] op_sel_hi:[1,0,1]
    v_pk_fma_f32 v[68:69], v[68:69], v[152:153], v[152:153] op_sel:[0,0,1] op_sel_hi:[1,0,1]
    v_pk_fma_f32 v[70:71], v[70:71], v[152:153], v[152:153] op_sel:[0,0,1] op_sel_hi:[1,0,1]
    v_pk_fma_f32 v[72:73], v[72:73], v[152:153], v[152:153] op_sel:[0,0,1] op_sel_hi:[1,0,1]
    v_pk_fma_f32 v[74:75], v[74:75], v[152:153], v[152:153] op_sel:[0,0,1] op_sel_hi:[1,0,1]
    v_pk_fma_f32 v[76:77], v[76:77], v[154:155], v[154:155] op_sel:[0,0,1] op_sel_hi:[1,0,1]
    v_pk_fma_f32 v[78:79], v[78:79], v[154:155], v[154:155] op_sel:[0,0,1] op_sel_hi:[1,0,1]
    v_pk_fma_f32 v[80:81], v[80:81], v[154:155], v[154:155] op_sel:[0,0,1] op_sel_hi:[1,0,1]
    v_pk_fma_f32 v[82:83], v[82:83], v[154:155], v[154:155] op_sel:[0,0,1] op_sel_hi:[1,0,1]
    v_pk_fma_f32 v[84:85], v[84:85], v[154:155], v[154:155] op_sel:[0,0,1] op_sel_hi:[1,0,1]
    v_pk_fma_f32 v[86:87], v[86:87], v[154:155], v[154:155] op_sel:[0,0,1] op_sel_hi:[1,0,1]
    v_mov_b32 v16, 0x3ef5fdf0
    v_mov_b32 v17, 0x3ef5fdf0
    v_pk_fma_f32 v[120:121], v[120:121], v[16:17], v[64:65]
    v_pk_fma_f32 v[122:123], v[122:123], v[16:17], v[66:67]
    v_pk_fma_f32 v[224:225], v[224:225], v[16:17], v[68:69]
    v_pk_fma_f32 v[226:227], v[226:227], v[16:17], v[70:71]
    v_pk_fma_f32 v[112:113], v[112:113], v[16:17], v[72:73]
    v_pk_fma_f32 v[114:115], v[114:115], v[16:17], v[74:75]
    v_pk_fma_f32 v[124:125], v[124:125], v[16:17], v[76:77]
    v_pk_fma_f32 v[126:127], v[126:127], v[16:17], v[78:79]
    v_pk_fma_f32 v[228:229], v[228:229], v[16:17], v[80:81]
    v_pk_fma_f32 v[230:231], v[230:231], v[16:17], v[82:83]
    v_pk_fma_f32 v[116:117], v[116:117], v[16:17], v[84:85]
    v_pk_fma_f32 v[118:119], v[118:119], v[16:17], v[86:87]
    v_cmp_eq_u32 s[34:35], s26, v3
    s_waitcnt lgkmcnt(0)
    s_mov_b32 s20, s24
    s_mov_b32 s21, s25
    s_mov_b32 s22, 0x240000
    s_mov_b32 s23, 0x20000
    s_waitcnt vmcnt(6)
    v_lshlrev_b32 v6, 16, v32
    v_and_b32 v7, s53, v32
    v_pk_fma_f32 v[120:121], v[6:7], v[16:17], v[120:121]
    v_lshlrev_b32 v14, 16, v33
    v_and_b32 v15, s53, v33
    v_pk_fma_f32 v[122:123], v[14:15], v[16:17], v[122:123]
    v_lshlrev_b32 v6, 16, v34
    v_and_b32 v7, s53, v34
    v_pk_fma_f32 v[224:225], v[6:7], v[16:17], v[224:225]
    v_lshlrev_b32 v14, 16, v35
    v_and_b32 v15, s53, v35
    v_pk_fma_f32 v[226:227], v[14:15], v[16:17], v[226:227]
    v_lshlrev_b32 v6, 16, v36
    v_and_b32 v7, s53, v36
    v_pk_fma_f32 v[124:125], v[6:7], v[16:17], v[124:125]
    v_lshlrev_b32 v14, 16, v37
    v_and_b32 v15, s53, v37
    v_pk_fma_f32 v[126:127], v[14:15], v[16:17], v[126:127]
    v_lshlrev_b32 v6, 16, v38
    v_and_b32 v7, s53, v38
    v_pk_fma_f32 v[228:229], v[6:7], v[16:17], v[228:229]
    v_lshlrev_b32 v14, 16, v39
    v_and_b32 v15, s53, v39
    v_pk_fma_f32 v[230:231], v[14:15], v[16:17], v[230:231]
    v_lshlrev_b32 v6, 16, v40
    v_and_b32 v7, s53, v40
    v_pk_fma_f32 v[112:113], v[6:7], v[16:17], v[112:113]
    v_lshlrev_b32 v14, 16, v41
    v_and_b32 v15, s53, v41
    v_pk_fma_f32 v[114:115], v[14:15], v[16:17], v[114:115]
    v_lshlrev_b32 v6, 16, v42
    v_and_b32 v7, s53, v42
    v_pk_fma_f32 v[116:117], v[6:7], v[16:17], v[116:117]
    v_lshlrev_b32 v14, 16, v43
    v_and_b32 v15, s53, v43
    v_pk_fma_f32 v[118:119], v[14:15], v[16:17], v[118:119]
    s_waitcnt vmcnt(3)
    v_lshlrev_b32 v6, 16, v44
    v_and_b32 v7, s53, v44
    v_pk_fma_f32 v[120:121], v[6:7], v[16:17], v[120:121]
    v_lshlrev_b32 v14, 16, v45
    v_and_b32 v15, s53, v45
    v_pk_fma_f32 v[122:123], v[14:15], v[16:17], v[122:123]
    v_lshlrev_b32 v6, 16, v46
    v_and_b32 v7, s53, v46
    v_pk_fma_f32 v[224:225], v[6:7], v[16:17], v[224:225]
    v_lshlrev_b32 v14, 16, v47
    v_and_b32 v15, s53, v47
    v_pk_fma_f32 v[226:227], v[14:15], v[16:17], v[226:227]
    v_lshlrev_b32 v6, 16, v48
    v_and_b32 v7, s53, v48
    v_pk_fma_f32 v[124:125], v[6:7], v[16:17], v[124:125]
    v_lshlrev_b32 v14, 16, v49
    v_and_b32 v15, s53, v49
    v_pk_fma_f32 v[126:127], v[14:15], v[16:17], v[126:127]
    v_lshlrev_b32 v6, 16, v50
    v_and_b32 v7, s53, v50
    v_pk_fma_f32 v[228:229], v[6:7], v[16:17], v[228:229]
    v_lshlrev_b32 v14, 16, v51
    v_and_b32 v15, s53, v51
    v_pk_fma_f32 v[230:231], v[14:15], v[16:17], v[230:231]
    v_lshlrev_b32 v6, 16, v52
    v_and_b32 v7, s53, v52
    v_pk_fma_f32 v[112:113], v[6:7], v[16:17], v[112:113]
    v_lshlrev_b32 v14, 16, v53
    v_and_b32 v15, s53, v53
    v_pk_fma_f32 v[114:115], v[14:15], v[16:17], v[114:115]
    v_lshlrev_b32 v6, 16, v54
    v_and_b32 v7, s53, v54
    v_pk_fma_f32 v[116:117], v[6:7], v[16:17], v[116:117]
    v_lshlrev_b32 v14, 16, v55
    v_and_b32 v15, s53, v55
    v_pk_fma_f32 v[118:119], v[14:15], v[16:17], v[118:119]
    s_waitcnt vmcnt(0)
    v_lshlrev_b32 v6, 16, v232
    v_and_b32 v7, s53, v232
    v_pk_fma_f32 v[120:121], v[6:7], v[16:17], v[120:121]
    v_lshlrev_b32 v14, 16, v233
    v_and_b32 v15, s53, v233
    v_pk_fma_f32 v[122:123], v[14:15], v[16:17], v[122:123]
    v_lshlrev_b32 v6, 16, v234
    v_and_b32 v7, s53, v234
    v_pk_fma_f32 v[224:225], v[6:7], v[16:17], v[224:225]
    v_lshlrev_b32 v14, 16, v235
    v_and_b32 v15, s53, v235
    v_pk_fma_f32 v[226:227], v[14:15], v[16:17], v[226:227]
    v_cvt_pk_bf16_f32 v128, v120, v121
    v_cvt_pk_bf16_f32 v129, v122, v123
    v_cvt_pk_bf16_f32 v130, v224, v225
    v_cvt_pk_bf16_f32 v131, v226, v227
    ds_write_b128 v12, v[128:131] offset:0
    ds_read_b128 v[144:147], v11 offset:0
    v_lshlrev_b32 v6, 16, v236
    v_and_b32 v7, s53, v236
    v_pk_fma_f32 v[124:125], v[6:7], v[16:17], v[124:125]
    v_lshlrev_b32 v14, 16, v237
    v_and_b32 v15, s53, v237
    v_pk_fma_f32 v[126:127], v[14:15], v[16:17], v[126:127]
    v_lshlrev_b32 v6, 16, v238
    v_and_b32 v7, s53, v238
    v_pk_fma_f32 v[228:229], v[6:7], v[16:17], v[228:229]
    v_lshlrev_b32 v14, 16, v239
    v_and_b32 v15, s53, v239
    v_pk_fma_f32 v[230:231], v[14:15], v[16:17], v[230:231]
    v_cvt_pk_bf16_f32 v136, v124, v125
    v_cvt_pk_bf16_f32 v137, v126, v127
    v_cvt_pk_bf16_f32 v138, v228, v229
    v_cvt_pk_bf16_f32 v139, v230, v231
    ds_write_b128 v12, v[136:139] offset:1024
    ds_read_b128 v[148:151], v11 offset:1024
    v_lshlrev_b32 v6, 16, v240
    v_and_b32 v7, s53, v240
    v_pk_fma_f32 v[112:113], v[6:7], v[16:17], v[112:113]
    v_lshlrev_b32 v14, 16, v241
    v_and_b32 v15, s53, v241
    v_pk_fma_f32 v[114:115], v[14:15], v[16:17], v[114:115]
    v_lshlrev_b32 v6, 16, v242
    v_and_b32 v7, s53, v242
    v_pk_fma_f32 v[116:117], v[6:7], v[16:17], v[116:117]
    v_lshlrev_b32 v14, 16, v243
    v_and_b32 v15, s53, v243
    v_pk_fma_f32 v[118:119], v[14:15], v[16:17], v[118:119]
    s_waitcnt lgkmcnt(2)
    buffer_store_dwordx4 v[144:147], v9, s[20:23], s41 offen
    v_cvt_pk_bf16_f32 v132, v112, v113
    v_cvt_pk_bf16_f32 v133, v114, v115
    v_cvt_pk_bf16_f32 v140, v116, v117
    v_cvt_pk_bf16_f32 v141, v118, v119
    s_waitcnt lgkmcnt(0)
    buffer_store_dwordx4 v[148:151], v9, s[20:23], s43 offen
    s_mov_b64 exec, s[34:35]
    buffer_store_dwordx2 v[132:133], v10, s[20:23], s40 offen
    buffer_store_dwordx2 v[140:141], v10, s[20:23], s42 offen
    s_mov_b64 exec, -1
Lend:
    s_endpgm
Lslow_20:
    s_mov_b32 s9, 0
Lpoll_36:
    buffer_load_dword v14, v15, s[12:15], s85 offen sc1
    s_waitcnt vmcnt(0)
    v_subrev_u32 v14, s6, v14
    v_subrev_u32 v14, 2, v14
    v_cmp_lt_u32 vcc, 7, v14
    s_nop 1
    s_cbranch_vccz Lpd_37
    s_add_u32 s9, s9, 1
    s_cmp_gt_u32 s9, 200000
    s_cbranch_scc1 Lpd_37
    s_sleep 1
    s_branch Lpoll_36
Lpd_37:
    s_branch Lback_21
Lslow_22:
    s_mov_b32 s9, 0
Lpoll_38:
    buffer_load_dword v14, v31, s[12:15], s53 offen sc1
    s_waitcnt vmcnt(0)
    v_cmp_ne_u32 vcc, s6, v14
    s_nop 1
    s_cbranch_vccz Lpd_39
    s_add_u32 s9, s9, 1
    s_cmp_gt_u32 s9, 200000
    s_cbranch_scc1 Lpd_39
    s_sleep 1
    s_branch Lpoll_38
Lpd_39:
    s_add_u32 s53, s53, 4
    s_mov_b32 s9, 0
Lpoll_40:
    buffer_load_dword v14, v31, s[12:15], s53 offen sc1
    s_waitcnt vmcnt(0)
    v_cmp_ne_u32 vcc, s6, v14
    s_nop 1
    s_cbranch_vccz Lpd_41
    s_add_u32 s9, s9, 1
    s_cmp_gt_u32 s9, 200000
    s_cbranch_scc1 Lpd_41
    s_sleep 1
    s_branch Lpoll_40
Lpd_41:
    s_branch Lback_23
Lslow_24:
    s_mov_b32 s9, 0
Lpoll_42:
    buffer_load_dword v31, v13, s[12:15], s47 offen sc1
    s_waitcnt vmcnt(0)
    v_subrev_u32 v31, s6, v31
    v_subrev_u32 v31, 3, v31
    v_cmp_lt_u32 vcc, 6, v31
    s_nop 1
    s_cbranch_vccz Lpd_43
    s_add_u32 s9, s9, 1
    s_cmp_gt_u32 s9, 200000
    s_cbranch_scc1 Lpd_43
    s_sleep 1
    s_branch Lpoll_42
Lpd_43:
    s_branch Lback_25
Lslow_26:
    s_mov_b32 s9, 0
Lpoll_44:
    buffer_load_dword v31, v13, s[12:15], s47 offen sc1
    s_waitcnt vmcnt(0)
    v_subrev_u32 v31, s6, v31
    v_subrev_u32 v31, 5, v31
    v_cmp_lt_u32 vcc, 4, v31
    s_nop 1
    s_cbranch_vccz Lpd_45
    s_add_u32 s9, s9, 1
    s_cmp_gt_u32 s9, 200000
    s_cbranch_scc1 Lpd_45
    s_sleep 1
    s_branch Lpoll_44
Lpd_45:
    s_branch Lback_27
Lslow_28:
    s_mov_b32 s9, 0
Lpoll_46:
    buffer_load_dword v31, v13, s[12:15], s47 offen sc1
    s_waitcnt vmcnt(0)
    v_subrev_u32 v31, s6, v31
    v_subrev_u32 v31, 7, v31
    v_cmp_lt_u32 vcc, 2, v31
    s_nop 1
    s_cbranch_vccz Lpd_47
    s_add_u32 s9, s9, 1
    s_cmp_gt_u32 s9, 200000
    s_cbranch_scc1 Lpd_47
    s_sleep 1
    s_branch Lpoll_46
Lpd_47:
    s_branch Lback_29
Lslow_30:
    s_mov_b32 s9, 0
Lpoll_48:
    buffer_load_dword v31, v13, s[12:15], s47 offen sc1
    s_waitcnt vmcnt(0)
    v_subrev_u32 v31, s6, v31
    v_subrev_u32 v31, 9, v31
    v_cmp_lt_u32 vcc, 0, v31
    s_nop 1
    s_cbranch_vccz Lpd_49
    s_add_u32 s9, s9, 1
    s_cmp_gt_u32 s9, 200000
    s_cbranch_scc1 Lpd_49
    s_sleep 1
    s_branch Lpoll_48
Lpd_49:
    s_branch Lback_31
Lep:
    s_mov_b32 s48, 0
    v_mov_b32 v14, 0
    v_mov_b32 v15, s6
    s_mov_b64 exec, 1
    buffer_store_dword v15, v14, s[12:15], s48 offen sc1
    s_mov_b64 exec, -1
    s_branch Lepb
Lslow_32:
    s_mov_b32 s9, 0
Lpoll_50:
    buffer_load_dword v31, v8, s[12:15], s86 offen sc1
    s_waitcnt vmcnt(0)
    v_cmp_ne_u32 vcc, s6, v31
    s_nop 1
    s_cbranch_vccz Lpd_51
    s_add_u32 s9, s9, 1
    s_cmp_gt_u32 s9, 200000
    s_cbranch_scc1 Lpd_51
    s_sleep 1
    s_branch Lpoll_50
Lpd_51:
    s_branch Lback_33
Lroleb:
    s_waitcnt vmcnt(0)
    s_barrier
    s_cmp_lg_u32 s3, 0
    s_cbranch_scc1 Lp1f_16
    v_mov_b32 v44, 0
    v_mov_b32 v45, s6
    s_mov_b64 exec, 1
    buffer_store_dword v45, v44, s[12:15], s101 offen sc1
    s_mov_b64 exec, -1
Lp1f_16:
    s_lshr_b32 s23, s8, 2
    s_lshl_b32 s23, s23, 3
    s_add_u32 s23, s23, s7
    s_lshl_b32 s22, s3, 6
    s_add_u32 s22, s22, s23
    s_lshl_b32 s101, s23, 7
    s_add_u32 s101, s101, 61444
    s_mul_i32 s11, s3, 12288
    s_add_u32 s11, s11, 73728
    s_load_dwordx4 s[28:31], s[0:1], 48
    v_lshrrev_b32 v14, 3, v1
    v_and_b32 v15, 7, v1
    v_lshlrev_b32 v5, 1, v3
    v_xor_b32 v5, v5, v15
    v_lshlrev_b32 v5, 4, v5
    v_sub_u32 v6, 295, v14
    v_mul_u32_u24 v6, 9216, v6
    v_add_u32 v6, v6, v5
    v_mul_u32_u24 v7, 9216, v14
    v_add_u32 v5, v5, v7
    s_mul_i32 s44, s22, 43
    s_lshr_b32 s44, s44, 8
    s_mul_i32 s45, s44, 6
    s_sub_u32 s45, s22, s45
    s_cmp_eq_u32 s45, 0
    s_cselect_b32 s46, 2654208, 0
    v_cmp_eq_u32 vcc, 0, v14
    v_subrev_u32 v7, s46, v6
    s_and_b32 s46, s44, 1
    v_cndmask_b32 v7, v6, v7, vcc
    s_lshr_b32 s44, s44, 1
    s_mul_i32 s47, s45, 442368
    s_mul_i32 s48, s44, 1152
    s_add_u32 s48, s48, 1024
    s_sub_u32 s51, s48, s47
    s_add_u32 s51, s51, 2589696
    s_add_u32 s47, s47, s48
    s_mul_i32 s48, s44, 147456
    s_mul_i32 s49, s46, 18432
    s_add_u32 s48, s48, s49
    s_mul_i32 s49, s45, 3072
    s_add_u32 s48, s48, s49
    v_lshrrev_b32 v12, 2, v1
    v_bfe_u32 v13, v12, 1, 2
    v_lshlrev_b32 v12, 7, v12
    v_lshl_or_b32 v12, v13, 5, v12
    v_and_b32 v13, 3, v1
    v_lshl_or_b32 v12, v13, 3, v12
    s_add_u32 s40, s4, 0x80000
    s_addc_u32 s41, s5, 0
    s_mov_b32 s42, 0x120000
    s_mov_b32 s43, 0x20000
    v_add_u32 v12, s11, v12
    v_xor_b32 v13, 32, v12
    v_xor_b32 v14, 64, v12
    v_xor_b32 v15, 96, v12
    s_waitcnt lgkmcnt(0)
    s_cmp_eq_u32 s46, 0
    s_cselect_b32 s32, s28, s30
    s_cselect_b32 s33, s29, s31
    s_cmp_lt_u32 s22, 96
    s_cselect_b32 s34, 5308416, 0
    s_mov_b32 s35, 0x20000
    s_add_u32 m0, s11, 0
    s_add_u32 s50, s47, 0
    buffer_load_dwordx4 v5, s[32:35], s50 offen lds
    s_add_u32 m0, s11, 1024
    s_add_u32 s50, s47, 73728
    buffer_load_dwordx4 v5, s[32:35], s50 offen lds
    s_add_u32 m0, s11, 2048
    s_sub_u32 s50, s51, 0
    buffer_load_dwordx4 v7, s[32:35], s50 offen lds
    s_add_u32 m0, s11, 3072
    s_sub_u32 s50, s51, 73728
    buffer_load_dwordx4 v6, s[32:35], s50 offen lds
    s_add_u32 m0, s11, 4096
    s_add_u32 s50, s47, 147456
    buffer_load_dwordx4 v5, s[32:35], s50 offen lds
    s_add_u32 m0, s11, 5120
    s_add_u32 s50, s47, 221184
    buffer_load_dwordx4 v5, s[32:35], s50 offen lds
    s_add_u32 m0, s11, 6144
    s_sub_u32 s50, s51, 147456
    buffer_load_dwordx4 v6, s[32:35], s50 offen lds
    s_add_u32 m0, s11, 7168
    s_sub_u32 s50, s51, 221184
    buffer_load_dwordx4 v6, s[32:35], s50 offen lds
    s_add_u32 m0, s11, 8192
    s_add_u32 s50, s47, 294912
    buffer_load_dwordx4 v5, s[32:35], s50 offen lds
    s_add_u32 m0, s11, 9216
    s_add_u32 s50, s47, 368640
    buffer_load_dwordx4 v5, s[32:35], s50 offen lds
    s_add_u32 m0, s11, 10240
    s_sub_u32 s50, s51, 294912
    buffer_load_dwordx4 v6, s[32:35], s50 offen lds
    s_add_u32 m0, s11, 11264
    s_sub_u32 s50, s51, 368640
    buffer_load_dwordx4 v6, s[32:35], s50 offen lds
    s_mov_b32 s100, s48
    s_load_dwordx4 s[28:31], s[0:1], 48
    s_and_b32 s24, s7, 1
    s_lshl_b32 s24, s24, 2
    s_and_b32 s25, s8, 3
    s_add_u32 s24, s24, s25
    s_lshr_b32 s25, s8, 2
    s_lshr_b32 s26, s7, 1
    s_lshl_b32 s27, s26, 3
    s_add_u32 s27, s27, s25
    s_lshr_b32 s45, s3, 1
    s_and_b32 s46, s3, 1
    s_lshr_b32 s47, s27, 2
    s_mul_i32 s47, s47, 1152
    s_and_b32 s48, s27, 3
    s_lshl_b32 s49, s48, 7
    s_add_u32 s98, s47, s49
    s_mul_i32 s49, s46, 5059584
    s_add_u32 s83, s98, s49
    s_mul_i32 s49, s46, 2552832
    s_add_u32 s98, s98, s49
    s_mul_i32 s11, s3, 6144
    s_mul_i32 s80, s46, -18432
    s_add_u32 s80, s80, 9216
    s_mul_i32 s81, s80, 48
    s_lshl_b32 s82, s80, 5
    s_lshl_b32 s47, s80, 3
    s_sub_u32 s47, s47, 1024
    s_mul_i32 s48, s46, 2939904
    s_mul_i32 s49, s46, 2654208
    v_lshrrev_b32 v9, 3, v1
    v_and_b32 v8, 7, v1
    v_lshlrev_b32 v5, 1, v3
    v_xor_b32 v5, v5, v8
    v_lshlrev_b32 v5, 4, v5
    v_mul_lo_u32 v8, v9, s80
    v_cmp_eq_u32 vcc, 0, v9
    v_add3_u32 v5, v5, v8, s48
    v_add_u32 v6, s47, v5
    v_add_u32 v7, s47, v6
    v_add_u32 v8, s47, v7
    v_subrev_u32 v9, s49, v5
    v_cndmask_b32 v9, v5, v9, vcc
    s_mul_i32 s49, s46, 184320
    s_waitcnt lgkmcnt(0)
    s_cmp_eq_u32 s45, 0
    s_cselect_b32 s16, s28, s30
    s_cselect_b32 s17, s29, s31
    s_sub_u32 s16, s16, s49
    s_subb_u32 s17, s17, 0
    s_add_u32 s18, s49, 5308416
    s_mov_b32 s19, 0x20000
    v_lshrrev_b32 v16, 2, v1
    v_min_u32 v16, 11, v16
    v_mul_u32_u24 v16, 9216, v16
    v_and_b32 v17, 3, v1
    v_lshl_add_u32 v16, v17, 7, v16
    s_and_b32 s47, s27, 3
    s_mul_i32 s47, s47, 110464
    s_add_u32 s47, s47, s83
    s_bitcmp1_b32 s7, 0
    s_cselect_b32 s49, 5, 3
    s_mul_i32 s49, s81, s49
    s_add_u32 s49, s49, s47
    buffer_load_dword v30, v16, s[16:19], s49 offen
    s_bitcmp1_b32 s7, 0
    s_cselect_b32 s49, 4, 4
    s_mul_i32 s49, s81, s49
    s_add_u32 s49, s49, s47
    buffer_load_dword v30, v16, s[16:19], s49 offen
    s_bitcmp1_b32 s7, 0
    s_cselect_b32 s49, 3, 5
    s_mul_i32 s49, s81, s49
    s_add_u32 s49, s49, s47
    buffer_load_dword v30, v16, s[16:19], s49 offen
    s_mov_b32 s48, s100
    s_cmp_lt_u32 s22, 96
    s_cbranch_scc1 Lbgo
    s_waitcnt vmcnt(3)
    s_branch Lbs
Lbgo:
    s_waitcnt vmcnt(11)
    ds_read_b64_tr_b16 v[32:33], v12 offset:0
    ds_read_b64_tr_b16 v[34:35], v12 offset:2048
    ds_read_b64_tr_b16 v[36:37], v13 offset:0
    ds_read_b64_tr_b16 v[38:39], v13 offset:2048
    ds_read_b64_tr_b16 v[40:41], v14 offset:0
    ds_read_b64_tr_b16 v[42:43], v14 offset:2048
    ds_read_b64_tr_b16 v[44:45], v15 offset:0
    ds_read_b64_tr_b16 v[46:47], v15 offset:2048
    s_add_u32 s50, s48, 0
    s_waitcnt lgkmcnt(6)
    buffer_store_dwordx4 v[32:35], v4, s[40:43], s50 offen offset:0 sc1
    s_add_u32 s50, s48, 36864
    s_waitcnt lgkmcnt(4)
    buffer_store_dwordx4 v[36:39], v4, s[40:43], s50 offen offset:0 sc1
    s_add_u32 s50, s48, 73728
    s_waitcnt lgkmcnt(2)
    buffer_store_dwordx4 v[40:43], v4, s[40:43], s50 offen offset:0 sc1
    s_add_u32 s50, s48, 110592
    s_waitcnt lgkmcnt(0)
    buffer_store_dwordx4 v[44:47], v4, s[40:43], s50 offen offset:0 sc1
    s_waitcnt vmcnt(11)
    ds_read_b64_tr_b16 v[48:49], v12 offset:4096
    ds_read_b64_tr_b16 v[50:51], v12 offset:6144
    ds_read_b64_tr_b16 v[52:53], v13 offset:4096
    ds_read_b64_tr_b16 v[54:55], v13 offset:6144
    ds_read_b64_tr_b16 v[56:57], v14 offset:4096
    ds_read_b64_tr_b16 v[58:59], v14 offset:6144
    ds_read_b64_tr_b16 v[60:61], v15 offset:4096
    ds_read_b64_tr_b16 v[62:63], v15 offset:6144
    s_add_u32 s50, s48, 0
    s_waitcnt lgkmcnt(6)
    buffer_store_dwordx4 v[48:51], v4, s[40:43], s50 offen offset:1024 sc1
    s_add_u32 s50, s48, 36864
    s_waitcnt lgkmcnt(4)
    buffer_store_dwordx4 v[52:55], v4, s[40:43], s50 offen offset:1024 sc1
    s_add_u32 s50, s48, 73728
    s_waitcnt lgkmcnt(2)
    buffer_store_dwordx4 v[56:59], v4, s[40:43], s50 offen offset:1024 sc1
    s_add_u32 s50, s48, 110592
    s_waitcnt lgkmcnt(0)
    buffer_store_dwordx4 v[60:63], v4, s[40:43], s50 offen offset:1024 sc1
    s_waitcnt vmcnt(11)
    ds_read_b64_tr_b16 v[64:65], v12 offset:8192
    ds_read_b64_tr_b16 v[66:67], v12 offset:10240
    ds_read_b64_tr_b16 v[68:69], v13 offset:8192
    ds_read_b64_tr_b16 v[70:71], v13 offset:10240
    ds_read_b64_tr_b16 v[72:73], v14 offset:8192
    ds_read_b64_tr_b16 v[74:75], v14 offset:10240
    ds_read_b64_tr_b16 v[76:77], v15 offset:8192
    ds_read_b64_tr_b16 v[78:79], v15 offset:10240
    s_add_u32 s50, s48, 0
    s_waitcnt lgkmcnt(6)
    buffer_store_dwordx4 v[64:67], v4, s[40:43], s50 offen offset:2048 sc1
    s_add_u32 s50, s48, 36864
    s_waitcnt lgkmcnt(4)
    buffer_store_dwordx4 v[68:71], v4, s[40:43], s50 offen offset:2048 sc1
    s_add_u32 s50, s48, 73728
    s_waitcnt lgkmcnt(2)
    buffer_store_dwordx4 v[72:75], v4, s[40:43], s50 offen offset:2048 sc1
    s_add_u32 s50, s48, 110592
    s_waitcnt lgkmcnt(0)
    buffer_store_dwordx4 v[76:79], v4, s[40:43], s50 offen offset:2048 sc1
Lbs:
    s_barrier
    s_mul_i32 s49, s81, 2
    s_add_u32 s49, s49, s98
    s_add_u32 m0, s11, 49152
    s_nop 0
    buffer_load_dwordx4 v5, s[16:19], s49 offen offset:0 lds
    buffer_load_dwordx4 v6, s[16:19], s49 offen offset:1024 lds
    buffer_load_dwordx4 v7, s[16:19], s49 offen offset:2048 lds
    buffer_load_dwordx4 v8, s[16:19], s49 offen offset:3072 lds
    s_add_u32 s49, s49, s82
    s_add_u32 m0, s11, 53248
    s_nop 0
    buffer_load_dwordx4 v5, s[16:19], s49 offen offset:0 lds
    buffer_load_dwordx4 v6, s[16:19], s49 offen offset:1024 lds
    s_waitcnt vmcnt(6)
    s_barrier
    s_cmp_lg_u32 s3, 0
    s_cbranch_scc1 Lbf
    v_mov_b32 v14, 0
    v_mov_b32 v15, s6
    s_mov_b64 exec, 1
    buffer_store_dword v15, v14, s[12:15], s101 offen sc1
    s_mov_b64 exec, -1
Lbf:
    s_mov_b32 s49, s98
    s_add_u32 m0, s11, 0
    s_nop 0
    buffer_load_dwordx4 v9, s[16:19], s49 offen offset:0 lds
    buffer_load_dwordx4 v6, s[16:19], s49 offen offset:1024 lds
    buffer_load_dwordx4 v7, s[16:19], s49 offen offset:2048 lds
    buffer_load_dwordx4 v8, s[16:19], s49 offen offset:3072 lds
    s_add_u32 s49, s49, s82
    s_add_u32 m0, s11, 4096
    s_nop 0
    buffer_load_dwordx4 v5, s[16:19], s49 offen offset:0 lds
    buffer_load_dwordx4 v6, s[16:19], s49 offen offset:1024 lds
    s_mul_i32 s49, s81, 1
    s_add_u32 s49, s49, s98
    s_add_u32 m0, s11, 24576
    s_nop 0
    buffer_load_dwordx4 v5, s[16:19], s49 offen offset:0 lds
    buffer_load_dwordx4 v6, s[16:19], s49 offen offset:1024 lds
    buffer_load_dwordx4 v7, s[16:19], s49 offen offset:2048 lds
    buffer_load_dwordx4 v8, s[16:19], s49 offen offset:3072 lds
    s_add_u32 s49, s49, s82
    s_add_u32 m0, s11, 28672
    s_nop 0
    buffer_load_dwordx4 v5, s[16:19], s49 offen offset:0 lds
    buffer_load_dwordx4 v6, s[16:19], s49 offen offset:1024 lds
    s_mul_i32 s49, s81, 3
    s_add_u32 s49, s49, s98
    s_add_u32 m0, s11, 73728
    s_nop 0
    buffer_load_dwordx4 v5, s[16:19], s49 offen offset:0 lds
    buffer_load_dwordx4 v6, s[16:19], s49 offen offset:1024 lds
    buffer_load_dwordx4 v7, s[16:19], s49 offen offset:2048 lds
    buffer_load_dwordx4 v8, s[16:19], s49 offen offset:3072 lds
    s_add_u32 s49, s49, s82
    s_add_u32 m0, s11, 77824
    s_nop 0
    buffer_load_dwordx4 v5, s[16:19], s49 offen offset:0 lds
    buffer_load_dwordx4 v6, s[16:19], s49 offen offset:1024 lds
    s_mul_i32 s49, s81, 4
    s_add_u32 s49, s49, s98
    s_add_u32 m0, s11, 98304
    s_nop 0
    buffer_load_dwordx4 v5, s[16:19], s49 offen offset:0 lds
    buffer_load_dwordx4 v6, s[16:19], s49 offen offset:1024 lds
    buffer_load_dwordx4 v7, s[16:19], s49 offen offset:2048 lds
    buffer_load_dwordx4 v8, s[16:19], s49 offen offset:3072 lds
    s_add_u32 s49, s49, s82
    s_add_u32 m0, s11, 102400
    s_nop 0
    buffer_load_dwordx4 v5, s[16:19], s49 offen offset:0 lds
    buffer_load_dwordx4 v6, s[16:19], s49 offen offset:1024 lds
    s_lshr_b32 s30, s25, 1
    s_lshl_b32 s29, s26, 2
    s_add_u32 s29, s29, s30
    s_mul_i32 s29, s29, 331776
    s_add_u32 s20, s4, 0x200000
    s_addc_u32 s21, s5, 0
    s_add_u32 s20, s20, s29
    s_addc_u32 s21, s21, 0
    s_mov_b32 s22, 331776
    s_mov_b32 s23, 0x20000
    s_add_u32 s32, s4, 0x980000
    s_addc_u32 s33, s5, 0
    s_mov_b32 s34, 0x244000
    s_mov_b32 s35, 0x20000
    s_add_u32 s36, s4, 0xc00000
    s_addc_u32 s37, s5, 0
    s_mov_b32 s38, 0x1200000
    s_mov_b32 s39, 0x20000
    s_lshl_b32 s28, s24, 2
    s_add_u32 s28, s28, s3
    s_lshl_b32 s28, s28, 2
    s_mul_i32 s31, s3, 9216
    s_mul_i32 s40, s28, 18432
    s_mul_i32 s41, s28, 147456
    s_mul_i32 s47, s26, 36864
    s_add_u32 s41, s41, s47
    s_lshl_b32 s48, s25, 9
    s_add_u32 s41, s41, s48
    s_and_b32 s49, s25, 1
    s_lshl_b32 s29, s49, 2
    s_add_u32 s29, s29, s3
    s_lshl_b32 s48, s24, 3
    s_add_u32 s29, s29, s48
    s_mul_i32 s42, s29, 294912
    s_add_u32 s42, s42, s47
    s_lshl_b32 s47, s24, 2
    s_add_u32 s47, s47, s26
    s_lshl_b32 s47, s47, 12
    s_add_u32 s47, s47, 262144
    s_lshl_b32 s44, s3, 10
    s_add_u32 s44, s44, s47
    s_lshl_b32 s48, s25, 7
    s_add_u32 s44, s44, s48
    s_lshl_b32 s49, s49, 1
    s_add_u32 s49, s49, s45
    s_lshl_b32 s49, s49, 10
    s_add_u32 s47, s47, s49
    s_mul_i32 s99, s27, 36864
    v_bfe_u32 v10, v1, 4, 1
    v_mul_u32_u24 v10, 147456, v10
    v_lshrrev_b32 v11, 5, v1
    v_lshl_add_u32 v11, v11, 4, v2
    v_lshl_add_u32 v10, v11, 4, v10
    v_add_u32 v11, 294912, v10
    v_and_b32 v13, 7, v1
    v_lshlrev_b32 v13, 7, v13
    v_add_u32 v16, 18432, v4
    v_add_u32 v17, 36864, v4
    v_add_u32 v18, 55296, v4
    v_add_u32 v19, 147456, v4
    v_add_u32 v20, s31, v4
    v_add_u32 v21, 65536, v4
    v_add_u32 v22, 131072, v4
    v_mov_b32 v23, 0
    v_mov_b32 v24, s6
    v_lshrrev_b32 v12, 2, v1
    v_bfe_u32 v14, v12, 1, 2
    v_lshlrev_b32 v12, 7, v12
    v_lshl_or_b32 v12, v14, 5, v12
    v_and_b32 v14, 3, v1
    v_lshl_or_b32 v12, v14, 3, v12
    v_and_b32 v15, 3, v1
    v_lshlrev_b32 v15, 7, v15
    s_lshl_b32 s85, s28, 7
    s_add_u32 s85, s85, 36864
    s_call_b64 s[96:97], LhopdispF
    s_branch Lffn
Lrolec:
    s_waitcnt lgkmcnt(0)
    s_load_dword s10, s[4:5], 0
    s_mov_b32 s12, s4
    s_mov_b32 s13, s5
    s_mov_b32 s14, 0x60000
    s_mov_b32 s15, 0x20000
    s_mul_i32 s25, s24, 43
    s_lshr_b32 s25, s25, 7
    s_mul_i32 s25, s25, 3
    s_lshr_b32 s25, s25, 1
    s_sub_u32 s25, s25, 1
    s_cmp_lt_i32 s25, 0
    s_cselect_b32 s25, 8, s25
    s_lshl_b32 s25, s25, 7
    s_cmp_lt_u32 s24, 9
    s_cselect_b32 s16, s42, s44
    s_cselect_b32 s17, s43, s45
    s_cselect_b32 s26, 0, 9
    s_sub_u32 s26, s24, s26
    s_mul_i32 s26, s26, 36864
    s_add_u32 s25, s25, s26
    s_mov_b32 s18, 332928
    s_mov_b32 s27, 1152
    s_cmp_eq_u32 s24, 18
    s_cselect_b32 s16, s38, s16
    s_cselect_b32 s17, s39, s17
    s_cmp_eq_u32 s24, 19
    s_cselect_b32 s16, s40, s16
    s_cselect_b32 s17, s41, s17
    s_and_b32 s26, s24, -2
    s_cmp_eq_u32 s26, 18
    s_cselect_b32 s18, 4325376, s18
    s_cselect_b32 s25, 0, s25
    s_cselect_b32 s27, 131072, s27
    s_mov_b32 s19, 0x20000
    v_min_u32 v5, 32, v1
    v_mul_lo_u32 v5, v5, s27
    buffer_load_dword v30, v5, s[16:19], s25 offen
    s_and_b32 s22, s8, -4
    s_add_u32 s22, s22, s3
    s_lshl_b32 s22, s22, 3
    s_add_u32 s22, s22, s7
    s_mul_i32 s22, s22, 1536
    v_min_u32 v5, 11, v1
    v_lshlrev_b32 v5, 7, v5
    buffer_load_dword v30, v5, s[12:15], s22 offen
    s_waitcnt vmcnt(0)
    s_load_dwordx4 s[28:31], s[0:1], 48
    s_and_b32 s24, s7, 1
    s_lshl_b32 s24, s24, 2
    s_and_b32 s25, s8, 3
    s_add_u32 s24, s24, s25
    s_lshr_b32 s25, s8, 2
    s_lshr_b32 s26, s7, 1
    s_lshl_b32 s27, s26, 3
    s_add_u32 s27, s27, s25
    s_lshr_b32 s45, s3, 1
    s_and_b32 s46, s3, 1
    s_lshr_b32 s47, s27, 2
    s_mul_i32 s47, s47, 1152
    s_and_b32 s48, s27, 3
    s_lshl_b32 s49, s48, 7
    s_add_u32 s98, s47, s49
    s_mul_i32 s49, s46, 5059584
    s_add_u32 s83, s98, s49
    s_mul_i32 s49, s46, 2552832
    s_add_u32 s98, s98, s49
    s_mul_i32 s11, s3, 6144
    s_mul_i32 s80, s46, -18432
    s_add_u32 s80, s80, 9216
    s_mul_i32 s81, s80, 48
    s_lshl_b32 s82, s80, 5
    s_lshl_b32 s47, s80, 3
    s_sub_u32 s47, s47, 1024
    s_mul_i32 s48, s46, 2939904
    s_mul_i32 s49, s46, 2654208
    v_lshrrev_b32 v9, 3, v1
    v_and_b32 v8, 7, v1
    v_lshlrev_b32 v5, 1, v3
    v_xor_b32 v5, v5, v8
    v_lshlrev_b32 v5, 4, v5
    v_mul_lo_u32 v8, v9, s80
    v_cmp_eq_u32 vcc, 0, v9
    v_add3_u32 v5, v5, v8, s48
    v_add_u32 v6, s47, v5
    v_add_u32 v7, s47, v6
    v_add_u32 v8, s47, v7
    v_subrev_u32 v9, s49, v5
    v_cndmask_b32 v9, v5, v9, vcc
    s_mul_i32 s49, s46, 184320
    s_waitcnt lgkmcnt(0)
    s_cmp_eq_u32 s45, 0
    s_cselect_b32 s16, s28, s30
    s_cselect_b32 s17, s29, s31
    s_sub_u32 s16, s16, s49
    s_subb_u32 s17, s17, 0
    s_add_u32 s18, s49, 5308416
    s_mov_b32 s19, 0x20000
    v_lshrrev_b32 v14, 2, v1
    v_min_u32 v14, 11, v14
    v_mul_u32_u24 v14, 9216, v14
    v_and_b32 v15, 3, v1
    v_lshl_add_u32 v14, v15, 7, v14
    s_and_b32 s47, s27, 3
    s_mul_i32 s47, s47, 110464
    s_add_u32 s47, s47, s83
    s_bitcmp1_b32 s7, 0
    s_cselect_b32 s49, 2, 0
    s_mul_i32 s49, s81, s49
    s_add_u32 s49, s49, s47
    buffer_load_dword v30, v14, s[16:19], s49 offen
    s_bitcmp1_b32 s7, 0
    s_cselect_b32 s49, 1, 1
    s_mul_i32 s49, s81, s49
    s_add_u32 s49, s49, s47
    buffer_load_dword v30, v14, s[16:19], s49 offen
    s_bitcmp1_b32 s7, 0
    s_cselect_b32 s49, 0, 2
    s_mul_i32 s49, s81, s49
    s_add_u32 s49, s49, s47
    buffer_load_dword v30, v14, s[16:19], s49 offen
    s_lshr_b32 s23, s8, 2
    s_lshl_b32 s23, s23, 3
    s_add_u32 s23, s23, s7
    s_lshl_b32 s22, s3, 6
    s_add_u32 s22, s22, s23
    s_mul_i32 s11, s3, 24576
    s_add_u32 s11, s11, 49152
    v_lshrrev_b32 v14, 3, v1
    v_and_b32 v15, 7, v1
    v_bfe_u32 v5, v14, 1, 1
    v_lshlrev_b32 v5, 2, v5
    v_xor_b32 v5, v5, v15
    v_lshlrev_b32 v5, 4, v5
    v_lshrrev_b32 v11, 2, v2
    v_lshl_add_u32 v11, v3, 3, v11
    v_lshlrev_b32 v11, 7, v11
    v_add_u32 v11, s11, v11
    v_and_b32 v8, 1, v3
    v_bfe_u32 v12, v2, 3, 1
    v_lshl_or_b32 v8, v12, 1, v8
    v_lshlrev_b32 v8, 5, v8
    v_and_b32 v9, 3, v2
    v_mul_u32_u24 v6, 1152, v14
    v_add_u32 v5, v5, v6
    v_xor_b32 v6, 32, v5
    s_mov_b32 s32, s52
    s_mov_b32 s33, s53
    s_mov_b32 s34, 0x510000
    s_mov_b32 s35, 0x20000
    s_add_u32 s40, s4, 0x200000
    s_addc_u32 s41, s5, 0
    s_mov_b32 s42, 0x510000
    s_mov_b32 s43, 0x20000
    s_add_u32 s24, s22, 0
    s_cmp_lt_u32 s24, 432
    s_cselect_b32 s34, 5308416, 0
    s_mul_i32 s44, s24, 21846
    s_lshr_b32 s44, s44, 16
    s_mul_i32 s45, s44, 3
    s_sub_u32 s45, s24, s45
    s_mul_i32 s16, s45, 3
    s_and_b32 s46, s44, 3
    s_lshr_b32 s44, s44, 2
    s_mul_i32 s47, s44, 57
    s_lshr_b32 s47, s47, 9
    s_mul_i32 s48, s47, 9
    s_sub_u32 s48, s44, s48
    s_lshl_b32 s49, s47, 1
    s_lshr_b32 s50, s46, 1
    s_add_u32 s49, s49, s50
    s_mul_i32 s49, s49, 576
    s_lshl_b32 s50, s48, 4
    s_add_u32 s51, s50, 176
    s_cmp_lt_u32 s48, 4
    s_cselect_b32 s50, s50, s51
    s_cmp_eq_u32 s48, 4
    s_cselect_b32 s50, 512, s50
    s_cselect_b32 s51, 16, 64
    s_add_u32 s49, s49, s50
    s_and_b32 s50, s46, 1
    s_mul_i32 s50, s50, s51
    s_lshl_b32 s50, s50, 1
    s_add_u32 s49, s49, s50
    s_mul_i32 s49, s49, 1152
    s_lshl_b32 s50, s16, 7
    s_add_u32 s49, s49, s50
    s_mul_i32 s51, s51, 1152
    s_add_u32 s25, s49, s51
    s_mul_i32 s50, s47, 1327104
    s_lshl_b32 s51, s46, 10
    s_add_u32 s17, s50, s51
    s_mov_b32 s26, s48
    s_mov_b32 s18, s47
    s_add_u32 m0, s11, 0
    s_add_u32 s50, s49, 0
    buffer_load_dwordx4 v5, s[32:35], s50 offen lds
    s_add_u32 m0, s11, 1024
    s_add_u32 s50, s49, 9216
    buffer_load_dwordx4 v6, s[32:35], s50 offen lds
    s_add_u32 m0, s11, 2048
    s_add_u32 s50, s25, 0
    buffer_load_dwordx4 v5, s[32:35], s50 offen lds
    s_add_u32 m0, s11, 3072
    s_add_u32 s50, s25, 9216
    buffer_load_dwordx4 v6, s[32:35], s50 offen lds
    s_add_u32 m0, s11, 4096
    s_add_u32 s50, s49, 128
    buffer_load_dwordx4 v5, s[32:35], s50 offen lds
    s_add_u32 m0, s11, 5120
    s_add_u32 s50, s49, 9344
    buffer_load_dwordx4 v6, s[32:35], s50 offen lds
    s_add_u32 m0, s11, 6144
    s_add_u32 s50, s25, 128
    buffer_load_dwordx4 v5, s[32:35], s50 offen lds
    s_add_u32 m0, s11, 7168
    s_add_u32 s50, s25, 9344
    buffer_load_dwordx4 v6, s[32:35], s50 offen lds
    s_add_u32 m0, s11, 8192
    s_add_u32 s50, s49, 256
    buffer_load_dwordx4 v5, s[32:35], s50 offen lds
    s_add_u32 m0, s11, 9216
    s_add_u32 s50, s49, 9472
    buffer_load_dwordx4 v6, s[32:35], s50 offen lds
    s_add_u32 m0, s11, 10240
    s_add_u32 s50, s25, 256
    buffer_load_dwordx4 v5, s[32:35], s50 offen lds
    s_add_u32 m0, s11, 11264
    s_add_u32 s50, s25, 9472
    buffer_load_dwordx4 v6, s[32:35], s50 offen lds
    s_add_u32 s24, s22, 256
    s_cmp_lt_u32 s24, 432
    s_cselect_b32 s34, 5308416, 0
    s_mul_i32 s44, s24, 21846
    s_lshr_b32 s44, s44, 16
    s_mul_i32 s45, s44, 3
    s_sub_u32 s45, s24, s45
    s_mul_i32 s20, s45, 3
    s_and_b32 s46, s44, 3
    s_lshr_b32 s44, s44, 2
    s_mul_i32 s47, s44, 57
    s_lshr_b32 s47, s47, 9
    s_mul_i32 s48, s47, 9
    s_sub_u32 s48, s44, s48
    s_lshl_b32 s49, s47, 1
    s_lshr_b32 s50, s46, 1
    s_add_u32 s49, s49, s50
    s_mul_i32 s49, s49, 576
    s_lshl_b32 s50, s48, 4
    s_add_u32 s51, s50, 176
    s_cmp_lt_u32 s48, 4
    s_cselect_b32 s50, s50, s51
    s_cmp_eq_u32 s48, 4
    s_cselect_b32 s50, 512, s50
    s_cselect_b32 s51, 16, 64
    s_add_u32 s49, s49, s50
    s_and_b32 s50, s46, 1
    s_mul_i32 s50, s50, s51
    s_lshl_b32 s50, s50, 1
    s_add_u32 s49, s49, s50
    s_mul_i32 s49, s49, 1152
    s_lshl_b32 s50, s20, 7
    s_add_u32 s49, s49, s50
    s_mul_i32 s51, s51, 1152
    s_add_u32 s25, s49, s51
    s_mul_i32 s50, s47, 1327104
    s_lshl_b32 s51, s46, 10
    s_add_u32 s21, s50, s51
    s_mov_b32 s27, s48
    s_mov_b32 s22, s47
    s_add_u32 m0, s11, 12288
    s_add_u32 s50, s49, 0
    buffer_load_dwordx4 v5, s[32:35], s50 offen lds
    s_add_u32 m0, s11, 13312
    s_add_u32 s50, s49, 9216
    buffer_load_dwordx4 v6, s[32:35], s50 offen lds
    s_add_u32 m0, s11, 14336
    s_add_u32 s50, s25, 0
    buffer_load_dwordx4 v5, s[32:35], s50 offen lds
    s_add_u32 m0, s11, 15360
    s_add_u32 s50, s25, 9216
    buffer_load_dwordx4 v6, s[32:35], s50 offen lds
    s_add_u32 m0, s11, 16384
    s_add_u32 s50, s49, 128
    buffer_load_dwordx4 v5, s[32:35], s50 offen lds
    s_add_u32 m0, s11, 17408
    s_add_u32 s50, s49, 9344
    buffer_load_dwordx4 v6, s[32:35], s50 offen lds
    s_add_u32 m0, s11, 18432
    s_add_u32 s50, s25, 128
    buffer_load_dwordx4 v5, s[32:35], s50 offen lds
    s_add_u32 m0, s11, 19456
    s_add_u32 s50, s25, 9344
    buffer_load_dwordx4 v6, s[32:35], s50 offen lds
    s_add_u32 m0, s11, 20480
    s_add_u32 s50, s49, 256
    buffer_load_dwordx4 v5, s[32:35], s50 offen lds
    s_add_u32 m0, s11, 21504
    s_add_u32 s50, s49, 9472
    buffer_load_dwordx4 v6, s[32:35], s50 offen lds
    s_add_u32 m0, s11, 22528
    s_add_u32 s50, s25, 256
    buffer_load_dwordx4 v5, s[32:35], s50 offen lds
    s_add_u32 m0, s11, 23552
    s_add_u32 s50, s25, 9472
    buffer_load_dwordx4 v6, s[32:35], s50 offen lds
    s_add_u32 s53, s16, 0
    s_waitcnt vmcnt(20)
    s_cmp_eq_u32 s53, 2
    s_cselect_b32 s44, 8, 16
    s_cselect_b32 s46, 0, 0
    s_add_u32 s46, s46, 0
    v_mov_b32 v13, s46
    v_mad_u32_u24 v13, v9, s44, v13
    v_xor_b32 v13, v13, v8
    v_add_u32 v13, v13, v11
    ds_read_b64_tr_b16 v[16:17], v13 offset:0
    ds_read_b64_tr_b16 v[18:19], v13 offset:512
    s_cmp_eq_u32 s53, 2
    s_cselect_b32 s44, 8, 16
    s_cselect_b32 s46, 32, 8
    s_add_u32 s46, s46, 0
    v_mov_b32 v13, s46
    v_mad_u32_u24 v13, v9, s44, v13
    v_xor_b32 v13, v13, v8
    v_add_u32 v13, v13, v11
    ds_read_b64_tr_b16 v[20:21], v13 offset:0
    ds_read_b64_tr_b16 v[22:23], v13 offset:512
    s_cmp_eq_u32 s53, 6
    s_cselect_b32 s44, 8, 16
    s_cselect_b32 s46, 0, 0
    s_add_u32 s46, s46, 64
    v_mov_b32 v13, s46
    v_mad_u32_u24 v13, v9, s44, v13
    v_xor_b32 v13, v13, v8
    v_add_u32 v13, v13, v11
    ds_read_b64_tr_b16 v[24:25], v13 offset:0
    ds_read_b64_tr_b16 v[26:27], v13 offset:512
    s_cmp_eq_u32 s53, 6
    s_cselect_b32 s44, 8, 16
    s_cselect_b32 s46, 32, 8
    s_add_u32 s46, s46, 64
    v_mov_b32 v13, s46
    v_mad_u32_u24 v13, v9, s44, v13
    v_xor_b32 v13, v13, v8
    v_add_u32 v13, v13, v11
    ds_read_b64_tr_b16 v[28:29], v13 offset:0
    ds_read_b64_tr_b16 v[30:31], v13 offset:512
    s_lshl_b32 s44, s53, 2
    s_add_u32 s44, s44, 0
    s_mul_i32 s46, s44, 57
    s_lshr_b32 s46, s46, 9
    s_mul_i32 s47, s46, 9
    s_sub_u32 s47, s44, s47
    s_and_b32 s48, s46, 1
    s_sub_u32 s47, s47, s48
    s_lshl_b32 s48, s18, 1
    s_sub_u32 s48, s47, s48
    s_sub_u32 s48, s48, 2
    s_and_b32 s48, s48, 7
    s_cmp_ge_u32 s48, 6
    s_addc_u32 s48, s48, 0
    s_cmp_ge_u32 s47, 8
    s_cselect_b32 s48, 6, s48
    s_mul_i32 s44, s26, 7
    s_lshl_b32 s47, s26, 1
    s_add_u32 s47, s47, 56
    s_add_u32 s45, s26, 42
    s_add_u32 s45, s45, s48
    s_cmp_ge_u32 s26, 7
    s_cselect_b32 s44, s45, s44
    s_cmp_ge_u32 s48, 7
    s_cselect_b32 s44, s47, s44
    s_add_u32 s48, s48, s44
    s_mul_i32 s46, s46, 331776
    s_lshl_b32 s48, s48, 12
    s_add_u32 s51, s17, s46
    s_add_u32 s51, s51, s48
    s_waitcnt lgkmcnt(6)
    buffer_store_dwordx4 v[16:19], v4, s[40:43], s51 offen sc1
    s_lshl_b32 s44, s53, 2
    s_add_u32 s44, s44, 1
    s_mul_i32 s46, s44, 57
    s_lshr_b32 s46, s46, 9
    s_mul_i32 s47, s46, 9
    s_sub_u32 s47, s44, s47
    s_and_b32 s48, s46, 1
    s_sub_u32 s47, s47, s48
    s_lshl_b32 s48, s18, 1
    s_sub_u32 s48, s47, s48
    s_sub_u32 s48, s48, 2
    s_and_b32 s48, s48, 7
    s_cmp_ge_u32 s48, 6
    s_addc_u32 s48, s48, 0
    s_cmp_ge_u32 s47, 8
    s_cselect_b32 s48, 6, s48
    s_mul_i32 s44, s26, 7
    s_lshl_b32 s47, s26, 1
    s_add_u32 s47, s47, 56
    s_add_u32 s45, s26, 42
    s_add_u32 s45, s45, s48
    s_cmp_ge_u32 s26, 7
    s_cselect_b32 s44, s45, s44
    s_cmp_ge_u32 s48, 7
    s_cselect_b32 s44, s47, s44
    s_add_u32 s48, s48, s44
    s_mul_i32 s46, s46, 331776
    s_lshl_b32 s48, s48, 12
    s_add_u32 s51, s17, s46
    s_add_u32 s51, s51, s48
    s_waitcnt lgkmcnt(4)
    buffer_store_dwordx4 v[20:23], v4, s[40:43], s51 offen sc1
    s_lshl_b32 s44, s53, 2
    s_add_u32 s44, s44, 2
    s_mul_i32 s46, s44, 57
    s_lshr_b32 s46, s46, 9
    s_mul_i32 s47, s46, 9
    s_sub_u32 s47, s44, s47
    s_and_b32 s48, s46, 1
    s_sub_u32 s47, s47, s48
    s_lshl_b32 s48, s18, 1
    s_sub_u32 s48, s47, s48
    s_sub_u32 s48, s48, 2
    s_and_b32 s48, s48, 7
    s_cmp_ge_u32 s48, 6
    s_addc_u32 s48, s48, 0
    s_cmp_ge_u32 s47, 8
    s_cselect_b32 s48, 6, s48
    s_mul_i32 s44, s26, 7
    s_lshl_b32 s47, s26, 1
    s_add_u32 s47, s47, 56
    s_add_u32 s45, s26, 42
    s_add_u32 s45, s45, s48
    s_cmp_ge_u32 s26, 7
    s_cselect_b32 s44, s45, s44
    s_cmp_ge_u32 s48, 7
    s_cselect_b32 s44, s47, s44
    s_add_u32 s48, s48, s44
    s_mul_i32 s46, s46, 331776
    s_lshl_b32 s48, s48, 12
    s_add_u32 s51, s17, s46
    s_add_u32 s51, s51, s48
    s_waitcnt lgkmcnt(2)
    buffer_store_dwordx4 v[24:27], v4, s[40:43], s51 offen sc1
    s_lshl_b32 s44, s53, 2
    s_add_u32 s44, s44, 3
    s_mul_i32 s46, s44, 57
    s_lshr_b32 s46, s46, 9
    s_mul_i32 s47, s46, 9
    s_sub_u32 s47, s44, s47
    s_and_b32 s48, s46, 1
    s_sub_u32 s47, s47, s48
    s_lshl_b32 s48, s18, 1
    s_sub_u32 s48, s47, s48
    s_sub_u32 s48, s48, 2
    s_and_b32 s48, s48, 7
    s_cmp_ge_u32 s48, 6
    s_addc_u32 s48, s48, 0
    s_cmp_ge_u32 s47, 8
    s_cselect_b32 s48, 6, s48
    s_mul_i32 s44, s26, 7
    s_lshl_b32 s47, s26, 1
    s_add_u32 s47, s47, 56
    s_add_u32 s45, s26, 42
    s_add_u32 s45, s45, s48
    s_cmp_ge_u32 s26, 7
    s_cselect_b32 s44, s45, s44
    s_cmp_ge_u32 s48, 7
    s_cselect_b32 s44, s47, s44
    s_add_u32 s48, s48, s44
    s_mul_i32 s46, s46, 331776
    s_lshl_b32 s48, s48, 12
    s_add_u32 s51, s17, s46
    s_add_u32 s51, s51, s48
    s_waitcnt lgkmcnt(0)
    buffer_store_dwordx4 v[28:31], v4, s[40:43], s51 offen sc1
    s_add_u32 s53, s16, 1
    s_waitcnt vmcnt(20)
    s_cmp_eq_u32 s53, 2
    s_cselect_b32 s44, 8, 16
    s_cselect_b32 s46, 0, 0
    s_add_u32 s46, s46, 0
    v_mov_b32 v13, s46
    v_mad_u32_u24 v13, v9, s44, v13
    v_xor_b32 v13, v13, v8
    v_add_u32 v13, v13, v11
    ds_read_b64_tr_b16 v[32:33], v13 offset:4096
    ds_read_b64_tr_b16 v[34:35], v13 offset:4608
    s_cmp_eq_u32 s53, 2
    s_cselect_b32 s44, 8, 16
    s_cselect_b32 s46, 32, 8
    s_add_u32 s46, s46, 0
    v_mov_b32 v13, s46
    v_mad_u32_u24 v13, v9, s44, v13
    v_xor_b32 v13, v13, v8
    v_add_u32 v13, v13, v11
    ds_read_b64_tr_b16 v[36:37], v13 offset:4096
    ds_read_b64_tr_b16 v[38:39], v13 offset:4608
    s_cmp_eq_u32 s53, 6
    s_cselect_b32 s44, 8, 16
    s_cselect_b32 s46, 0, 0
    s_add_u32 s46, s46, 64
    v_mov_b32 v13, s46
    v_mad_u32_u24 v13, v9, s44, v13
    v_xor_b32 v13, v13, v8
    v_add_u32 v13, v13, v11
    ds_read_b64_tr_b16 v[40:41], v13 offset:4096
    ds_read_b64_tr_b16 v[42:43], v13 offset:4608
    s_cmp_eq_u32 s53, 6
    s_cselect_b32 s44, 8, 16
    s_cselect_b32 s46, 32, 8
    s_add_u32 s46, s46, 64
    v_mov_b32 v13, s46
    v_mad_u32_u24 v13, v9, s44, v13
    v_xor_b32 v13, v13, v8
    v_add_u32 v13, v13, v11
    ds_read_b64_tr_b16 v[44:45], v13 offset:4096
    ds_read_b64_tr_b16 v[46:47], v13 offset:4608
    s_lshl_b32 s44, s53, 2
    s_add_u32 s44, s44, 0
    s_mul_i32 s46, s44, 57
    s_lshr_b32 s46, s46, 9
    s_mul_i32 s47, s46, 9
    s_sub_u32 s47, s44, s47
    s_and_b32 s48, s46, 1
    s_sub_u32 s47, s47, s48
    s_lshl_b32 s48, s18, 1
    s_sub_u32 s48, s47, s48
    s_sub_u32 s48, s48, 2
    s_and_b32 s48, s48, 7
    s_cmp_ge_u32 s48, 6
    s_addc_u32 s48, s48, 0
    s_cmp_ge_u32 s47, 8
    s_cselect_b32 s48, 6, s48
    s_mul_i32 s44, s26, 7
    s_lshl_b32 s47, s26, 1
    s_add_u32 s47, s47, 56
    s_add_u32 s45, s26, 42
    s_add_u32 s45, s45, s48
    s_cmp_ge_u32 s26, 7
    s_cselect_b32 s44, s45, s44
    s_cmp_ge_u32 s48, 7
    s_cselect_b32 s44, s47, s44
    s_add_u32 s48, s48, s44
    s_mul_i32 s46, s46, 331776
    s_lshl_b32 s48, s48, 12
    s_add_u32 s51, s17, s46
    s_add_u32 s51, s51, s48
    s_waitcnt lgkmcnt(6)
    buffer_store_dwordx4 v[32:35], v4, s[40:43], s51 offen sc1
    s_lshl_b32 s44, s53, 2
    s_add_u32 s44, s44, 1
    s_mul_i32 s46, s44, 57
    s_lshr_b32 s46, s46, 9
    s_mul_i32 s47, s46, 9
    s_sub_u32 s47, s44, s47
    s_and_b32 s48, s46, 1
    s_sub_u32 s47, s47, s48
    s_lshl_b32 s48, s18, 1
    s_sub_u32 s48, s47, s48
    s_sub_u32 s48, s48, 2
    s_and_b32 s48, s48, 7
    s_cmp_ge_u32 s48, 6
    s_addc_u32 s48, s48, 0
    s_cmp_ge_u32 s47, 8
    s_cselect_b32 s48, 6, s48
    s_mul_i32 s44, s26, 7
    s_lshl_b32 s47, s26, 1
    s_add_u32 s47, s47, 56
    s_add_u32 s45, s26, 42
    s_add_u32 s45, s45, s48
    s_cmp_ge_u32 s26, 7
    s_cselect_b32 s44, s45, s44
    s_cmp_ge_u32 s48, 7
    s_cselect_b32 s44, s47, s44
    s_add_u32 s48, s48, s44
    s_mul_i32 s46, s46, 331776
    s_lshl_b32 s48, s48, 12
    s_add_u32 s51, s17, s46
    s_add_u32 s51, s51, s48
    s_waitcnt lgkmcnt(4)
    buffer_store_dwordx4 v[36:39], v4, s[40:43], s51 offen sc1
    s_lshl_b32 s44, s53, 2
    s_add_u32 s44, s44, 2
    s_mul_i32 s46, s44, 57
    s_lshr_b32 s46, s46, 9
    s_mul_i32 s47, s46, 9
    s_sub_u32 s47, s44, s47
    s_and_b32 s48, s46, 1
    s_sub_u32 s47, s47, s48
    s_lshl_b32 s48, s18, 1
    s_sub_u32 s48, s47, s48
    s_sub_u32 s48, s48, 2
    s_and_b32 s48, s48, 7
    s_cmp_ge_u32 s48, 6
    s_addc_u32 s48, s48, 0
    s_cmp_ge_u32 s47, 8
    s_cselect_b32 s48, 6, s48
    s_mul_i32 s44, s26, 7
    s_lshl_b32 s47, s26, 1
    s_add_u32 s47, s47, 56
    s_add_u32 s45, s26, 42
    s_add_u32 s45, s45, s48
    s_cmp_ge_u32 s26, 7
    s_cselect_b32 s44, s45, s44
    s_cmp_ge_u32 s48, 7
    s_cselect_b32 s44, s47, s44
    s_add_u32 s48, s48, s44
    s_mul_i32 s46, s46, 331776
    s_lshl_b32 s48, s48, 12
    s_add_u32 s51, s17, s46
    s_add_u32 s51, s51, s48
    s_waitcnt lgkmcnt(2)
    buffer_store_dwordx4 v[40:43], v4, s[40:43], s51 offen sc1
    s_lshl_b32 s44, s53, 2
    s_add_u32 s44, s44, 3
    s_mul_i32 s46, s44, 57
    s_lshr_b32 s46, s46, 9
    s_mul_i32 s47, s46, 9
    s_sub_u32 s47, s44, s47
    s_and_b32 s48, s46, 1
    s_sub_u32 s47, s47, s48
    s_lshl_b32 s48, s18, 1
    s_sub_u32 s48, s47, s48
    s_sub_u32 s48, s48, 2
    s_and_b32 s48, s48, 7
    s_cmp_ge_u32 s48, 6
    s_addc_u32 s48, s48, 0
    s_cmp_ge_u32 s47, 8
    s_cselect_b32 s48, 6, s48
    s_mul_i32 s44, s26, 7
    s_lshl_b32 s47, s26, 1
    s_add_u32 s47, s47, 56
    s_add_u32 s45, s26, 42
    s_add_u32 s45, s45, s48
    s_cmp_ge_u32 s26, 7
    s_cselect_b32 s44, s45, s44
    s_cmp_ge_u32 s48, 7
    s_cselect_b32 s44, s47, s44
    s_add_u32 s48, s48, s44
    s_mul_i32 s46, s46, 331776
    s_lshl_b32 s48, s48, 12
    s_add_u32 s51, s17, s46
    s_add_u32 s51, s51, s48
    s_waitcnt lgkmcnt(0)
    buffer_store_dwordx4 v[44:47], v4, s[40:43], s51 offen sc1
    s_add_u32 s53, s16, 2
    s_waitcnt vmcnt(20)
    s_cmp_eq_u32 s53, 2
    s_cselect_b32 s44, 8, 16
    s_cselect_b32 s46, 0, 0
    s_add_u32 s46, s46, 0
    v_mov_b32 v13, s46
    v_mad_u32_u24 v13, v9, s44, v13
    v_xor_b32 v13, v13, v8
    v_add_u32 v13, v13, v11
    ds_read_b64_tr_b16 v[48:49], v13 offset:8192
    ds_read_b64_tr_b16 v[50:51], v13 offset:8704
    s_cmp_eq_u32 s53, 2
    s_cselect_b32 s44, 8, 16
    s_cselect_b32 s46, 32, 8
    s_add_u32 s46, s46, 0
    v_mov_b32 v13, s46
    v_mad_u32_u24 v13, v9, s44, v13
    v_xor_b32 v13, v13, v8
    v_add_u32 v13, v13, v11
    ds_read_b64_tr_b16 v[52:53], v13 offset:8192
    ds_read_b64_tr_b16 v[54:55], v13 offset:8704
    s_cmp_eq_u32 s53, 6
    s_cselect_b32 s44, 8, 16
    s_cselect_b32 s46, 0, 0
    s_add_u32 s46, s46, 64
    v_mov_b32 v13, s46
    v_mad_u32_u24 v13, v9, s44, v13
    v_xor_b32 v13, v13, v8
    v_add_u32 v13, v13, v11
    ds_read_b64_tr_b16 v[56:57], v13 offset:8192
    ds_read_b64_tr_b16 v[58:59], v13 offset:8704
    s_cmp_eq_u32 s53, 6
    s_cselect_b32 s44, 8, 16
    s_cselect_b32 s46, 32, 8
    s_add_u32 s46, s46, 64
    v_mov_b32 v13, s46
    v_mad_u32_u24 v13, v9, s44, v13
    v_xor_b32 v13, v13, v8
    v_add_u32 v13, v13, v11
    ds_read_b64_tr_b16 v[60:61], v13 offset:8192
    ds_read_b64_tr_b16 v[62:63], v13 offset:8704
    s_lshl_b32 s44, s53, 2
    s_add_u32 s44, s44, 0
    s_mul_i32 s46, s44, 57
    s_lshr_b32 s46, s46, 9
    s_mul_i32 s47, s46, 9
    s_sub_u32 s47, s44, s47
    s_and_b32 s48, s46, 1
    s_sub_u32 s47, s47, s48
    s_lshl_b32 s48, s18, 1
    s_sub_u32 s48, s47, s48
    s_sub_u32 s48, s48, 2
    s_and_b32 s48, s48, 7
    s_cmp_ge_u32 s48, 6
    s_addc_u32 s48, s48, 0
    s_cmp_ge_u32 s47, 8
    s_cselect_b32 s48, 6, s48
    s_mul_i32 s44, s26, 7
    s_lshl_b32 s47, s26, 1
    s_add_u32 s47, s47, 56
    s_add_u32 s45, s26, 42
    s_add_u32 s45, s45, s48
    s_cmp_ge_u32 s26, 7
    s_cselect_b32 s44, s45, s44
    s_cmp_ge_u32 s48, 7
    s_cselect_b32 s44, s47, s44
    s_add_u32 s48, s48, s44
    s_mul_i32 s46, s46, 331776
    s_lshl_b32 s48, s48, 12
    s_add_u32 s51, s17, s46
    s_add_u32 s51, s51, s48
    s_waitcnt lgkmcnt(6)
    buffer_store_dwordx4 v[48:51], v4, s[40:43], s51 offen sc1
    s_lshl_b32 s44, s53, 2
    s_add_u32 s44, s44, 1
    s_mul_i32 s46, s44, 57
    s_lshr_b32 s46, s46, 9
    s_mul_i32 s47, s46, 9
    s_sub_u32 s47, s44, s47
    s_and_b32 s48, s46, 1
    s_sub_u32 s47, s47, s48
    s_lshl_b32 s48, s18, 1
    s_sub_u32 s48, s47, s48
    s_sub_u32 s48, s48, 2
    s_and_b32 s48, s48, 7
    s_cmp_ge_u32 s48, 6
    s_addc_u32 s48, s48, 0
    s_cmp_ge_u32 s47, 8
    s_cselect_b32 s48, 6, s48
    s_mul_i32 s44, s26, 7
    s_lshl_b32 s47, s26, 1
    s_add_u32 s47, s47, 56
    s_add_u32 s45, s26, 42
    s_add_u32 s45, s45, s48
    s_cmp_ge_u32 s26, 7
    s_cselect_b32 s44, s45, s44
    s_cmp_ge_u32 s48, 7
    s_cselect_b32 s44, s47, s44
    s_add_u32 s48, s48, s44
    s_mul_i32 s46, s46, 331776
    s_lshl_b32 s48, s48, 12
    s_add_u32 s51, s17, s46
    s_add_u32 s51, s51, s48
    s_waitcnt lgkmcnt(4)
    buffer_store_dwordx4 v[52:55], v4, s[40:43], s51 offen sc1
    s_lshl_b32 s44, s53, 2
    s_add_u32 s44, s44, 2
    s_mul_i32 s46, s44, 57
    s_lshr_b32 s46, s46, 9
    s_mul_i32 s47, s46, 9
    s_sub_u32 s47, s44, s47
    s_and_b32 s48, s46, 1
    s_sub_u32 s47, s47, s48
    s_lshl_b32 s48, s18, 1
    s_sub_u32 s48, s47, s48
    s_sub_u32 s48, s48, 2
    s_and_b32 s48, s48, 7
    s_cmp_ge_u32 s48, 6
    s_addc_u32 s48, s48, 0
    s_cmp_ge_u32 s47, 8
    s_cselect_b32 s48, 6, s48
    s_mul_i32 s44, s26, 7
    s_lshl_b32 s47, s26, 1
    s_add_u32 s47, s47, 56
    s_add_u32 s45, s26, 42
    s_add_u32 s45, s45, s48
    s_cmp_ge_u32 s26, 7
    s_cselect_b32 s44, s45, s44
    s_cmp_ge_u32 s48, 7
    s_cselect_b32 s44, s47, s44
    s_add_u32 s48, s48, s44
    s_mul_i32 s46, s46, 331776
    s_lshl_b32 s48, s48, 12
    s_add_u32 s51, s17, s46
    s_add_u32 s51, s51, s48
    s_waitcnt lgkmcnt(2)
    buffer_store_dwordx4 v[56:59], v4, s[40:43], s51 offen sc1
    s_lshl_b32 s44, s53, 2
    s_add_u32 s44, s44, 3
    s_mul_i32 s46, s44, 57
    s_lshr_b32 s46, s46, 9
    s_mul_i32 s47, s46, 9
    s_sub_u32 s47, s44, s47
    s_and_b32 s48, s46, 1
    s_sub_u32 s47, s47, s48
    s_lshl_b32 s48, s18, 1
    s_sub_u32 s48, s47, s48
    s_sub_u32 s48, s48, 2
    s_and_b32 s48, s48, 7
    s_cmp_ge_u32 s48, 6
    s_addc_u32 s48, s48, 0
    s_cmp_ge_u32 s47, 8
    s_cselect_b32 s48, 6, s48
    s_mul_i32 s44, s26, 7
    s_lshl_b32 s47, s26, 1
    s_add_u32 s47, s47, 56
    s_add_u32 s45, s26, 42
    s_add_u32 s45, s45, s48
    s_cmp_ge_u32 s26, 7
    s_cselect_b32 s44, s45, s44
    s_cmp_ge_u32 s48, 7
    s_cselect_b32 s44, s47, s44
    s_add_u32 s48, s48, s44
    s_mul_i32 s46, s46, 331776
    s_lshl_b32 s48, s48, 12
    s_add_u32 s51, s17, s46
    s_add_u32 s51, s51, s48
    s_waitcnt lgkmcnt(0)
    buffer_store_dwordx4 v[60:63], v4, s[40:43], s51 offen sc1
    s_cmp_ge_u32 s24, 432
    s_cbranch_scc1 Lw2s_17
    s_add_u32 s53, s20, 0
    s_waitcnt vmcnt(20)
    s_cmp_eq_u32 s53, 2
    s_cselect_b32 s44, 8, 16
    s_cselect_b32 s46, 0, 0
    s_add_u32 s46, s46, 0
    v_mov_b32 v13, s46
    v_mad_u32_u24 v13, v9, s44, v13
    v_xor_b32 v13, v13, v8
    v_add_u32 v13, v13, v11
    ds_read_b64_tr_b16 v[64:65], v13 offset:12288
    ds_read_b64_tr_b16 v[66:67], v13 offset:12800
    s_cmp_eq_u32 s53, 2
    s_cselect_b32 s44, 8, 16
    s_cselect_b32 s46, 32, 8
    s_add_u32 s46, s46, 0
    v_mov_b32 v13, s46
    v_mad_u32_u24 v13, v9, s44, v13
    v_xor_b32 v13, v13, v8
    v_add_u32 v13, v13, v11
    ds_read_b64_tr_b16 v[68:69], v13 offset:12288
    ds_read_b64_tr_b16 v[70:71], v13 offset:12800
    s_cmp_eq_u32 s53, 6
    s_cselect_b32 s44, 8, 16
    s_cselect_b32 s46, 0, 0
    s_add_u32 s46, s46, 64
    v_mov_b32 v13, s46
    v_mad_u32_u24 v13, v9, s44, v13
    v_xor_b32 v13, v13, v8
    v_add_u32 v13, v13, v11
    ds_read_b64_tr_b16 v[72:73], v13 offset:12288
    ds_read_b64_tr_b16 v[74:75], v13 offset:12800
    s_cmp_eq_u32 s53, 6
    s_cselect_b32 s44, 8, 16
    s_cselect_b32 s46, 32, 8
    s_add_u32 s46, s46, 64
    v_mov_b32 v13, s46
    v_mad_u32_u24 v13, v9, s44, v13
    v_xor_b32 v13, v13, v8
    v_add_u32 v13, v13, v11
    ds_read_b64_tr_b16 v[76:77], v13 offset:12288
    ds_read_b64_tr_b16 v[78:79], v13 offset:12800
    s_lshl_b32 s44, s53, 2
    s_add_u32 s44, s44, 0
    s_mul_i32 s46, s44, 57
    s_lshr_b32 s46, s46, 9
    s_mul_i32 s47, s46, 9
    s_sub_u32 s47, s44, s47
    s_and_b32 s48, s46, 1
    s_sub_u32 s47, s47, s48
    s_lshl_b32 s48, s22, 1
    s_sub_u32 s48, s47, s48
    s_sub_u32 s48, s48, 2
    s_and_b32 s48, s48, 7
    s_cmp_ge_u32 s48, 6
    s_addc_u32 s48, s48, 0
    s_cmp_ge_u32 s47, 8
    s_cselect_b32 s48, 6, s48
    s_mul_i32 s44, s27, 7
    s_lshl_b32 s47, s27, 1
    s_add_u32 s47, s47, 56
    s_add_u32 s45, s27, 42
    s_add_u32 s45, s45, s48
    s_cmp_ge_u32 s27, 7
    s_cselect_b32 s44, s45, s44
    s_cmp_ge_u32 s48, 7
    s_cselect_b32 s44, s47, s44
    s_add_u32 s48, s48, s44
    s_mul_i32 s46, s46, 331776
    s_lshl_b32 s48, s48, 12
    s_add_u32 s51, s21, s46
    s_add_u32 s51, s51, s48
    s_waitcnt lgkmcnt(6)
    buffer_store_dwordx4 v[64:67], v4, s[40:43], s51 offen sc1
    s_lshl_b32 s44, s53, 2
    s_add_u32 s44, s44, 1
    s_mul_i32 s46, s44, 57
    s_lshr_b32 s46, s46, 9
    s_mul_i32 s47, s46, 9
    s_sub_u32 s47, s44, s47
    s_and_b32 s48, s46, 1
    s_sub_u32 s47, s47, s48
    s_lshl_b32 s48, s22, 1
    s_sub_u32 s48, s47, s48
    s_sub_u32 s48, s48, 2
    s_and_b32 s48, s48, 7
    s_cmp_ge_u32 s48, 6
    s_addc_u32 s48, s48, 0
    s_cmp_ge_u32 s47, 8
    s_cselect_b32 s48, 6, s48
    s_mul_i32 s44, s27, 7
    s_lshl_b32 s47, s27, 1
    s_add_u32 s47, s47, 56
    s_add_u32 s45, s27, 42
    s_add_u32 s45, s45, s48
    s_cmp_ge_u32 s27, 7
    s_cselect_b32 s44, s45, s44
    s_cmp_ge_u32 s48, 7
    s_cselect_b32 s44, s47, s44
    s_add_u32 s48, s48, s44
    s_mul_i32 s46, s46, 331776
    s_lshl_b32 s48, s48, 12
    s_add_u32 s51, s21, s46
    s_add_u32 s51, s51, s48
    s_waitcnt lgkmcnt(4)
    buffer_store_dwordx4 v[68:71], v4, s[40:43], s51 offen sc1
    s_lshl_b32 s44, s53, 2
    s_add_u32 s44, s44, 2
    s_mul_i32 s46, s44, 57
    s_lshr_b32 s46, s46, 9
    s_mul_i32 s47, s46, 9
    s_sub_u32 s47, s44, s47
    s_and_b32 s48, s46, 1
    s_sub_u32 s47, s47, s48
    s_lshl_b32 s48, s22, 1
    s_sub_u32 s48, s47, s48
    s_sub_u32 s48, s48, 2
    s_and_b32 s48, s48, 7
    s_cmp_ge_u32 s48, 6
    s_addc_u32 s48, s48, 0
    s_cmp_ge_u32 s47, 8
    s_cselect_b32 s48, 6, s48
    s_mul_i32 s44, s27, 7
    s_lshl_b32 s47, s27, 1
    s_add_u32 s47, s47, 56
    s_add_u32 s45, s27, 42
    s_add_u32 s45, s45, s48
    s_cmp_ge_u32 s27, 7
    s_cselect_b32 s44, s45, s44
    s_cmp_ge_u32 s48, 7
    s_cselect_b32 s44, s47, s44
    s_add_u32 s48, s48, s44
    s_mul_i32 s46, s46, 331776
    s_lshl_b32 s48, s48, 12
    s_add_u32 s51, s21, s46
    s_add_u32 s51, s51, s48
    s_waitcnt lgkmcnt(2)
    buffer_store_dwordx4 v[72:75], v4, s[40:43], s51 offen sc1
    s_lshl_b32 s44, s53, 2
    s_add_u32 s44, s44, 3
    s_mul_i32 s46, s44, 57
    s_lshr_b32 s46, s46, 9
    s_mul_i32 s47, s46, 9
    s_sub_u32 s47, s44, s47
    s_and_b32 s48, s46, 1
    s_sub_u32 s47, s47, s48
    s_lshl_b32 s48, s22, 1
    s_sub_u32 s48, s47, s48
    s_sub_u32 s48, s48, 2
    s_and_b32 s48, s48, 7
    s_cmp_ge_u32 s48, 6
    s_addc_u32 s48, s48, 0
    s_cmp_ge_u32 s47, 8
    s_cselect_b32 s48, 6, s48
    s_mul_i32 s44, s27, 7
    s_lshl_b32 s47, s27, 1
    s_add_u32 s47, s47, 56
    s_add_u32 s45, s27, 42
    s_add_u32 s45, s45, s48
    s_cmp_ge_u32 s27, 7
    s_cselect_b32 s44, s45, s44
    s_cmp_ge_u32 s48, 7
    s_cselect_b32 s44, s47, s44
    s_add_u32 s48, s48, s44
    s_mul_i32 s46, s46, 331776
    s_lshl_b32 s48, s48, 12
    s_add_u32 s51, s21, s46
    s_add_u32 s51, s51, s48
    s_waitcnt lgkmcnt(0)
    buffer_store_dwordx4 v[76:79], v4, s[40:43], s51 offen sc1
    s_add_u32 s53, s20, 1
    s_waitcnt vmcnt(20)
    s_cmp_eq_u32 s53, 2
    s_cselect_b32 s44, 8, 16
    s_cselect_b32 s46, 0, 0
    s_add_u32 s46, s46, 0
    v_mov_b32 v13, s46
    v_mad_u32_u24 v13, v9, s44, v13
    v_xor_b32 v13, v13, v8
    v_add_u32 v13, v13, v11
    ds_read_b64_tr_b16 v[80:81], v13 offset:16384
    ds_read_b64_tr_b16 v[82:83], v13 offset:16896
    s_cmp_eq_u32 s53, 2
    s_cselect_b32 s44, 8, 16
    s_cselect_b32 s46, 32, 8
    s_add_u32 s46, s46, 0
    v_mov_b32 v13, s46
    v_mad_u32_u24 v13, v9, s44, v13
    v_xor_b32 v13, v13, v8
    v_add_u32 v13, v13, v11
    ds_read_b64_tr_b16 v[84:85], v13 offset:16384
    ds_read_b64_tr_b16 v[86:87], v13 offset:16896
    s_cmp_eq_u32 s53, 6
    s_cselect_b32 s44, 8, 16
    s_cselect_b32 s46, 0, 0
    s_add_u32 s46, s46, 64
    v_mov_b32 v13, s46
    v_mad_u32_u24 v13, v9, s44, v13
    v_xor_b32 v13, v13, v8
    v_add_u32 v13, v13, v11
    ds_read_b64_tr_b16 v[88:89], v13 offset:16384
    ds_read_b64_tr_b16 v[90:91], v13 offset:16896
    s_cmp_eq_u32 s53, 6
    s_cselect_b32 s44, 8, 16
    s_cselect_b32 s46, 32, 8
    s_add_u32 s46, s46, 64
    v_mov_b32 v13, s46
    v_mad_u32_u24 v13, v9, s44, v13
    v_xor_b32 v13, v13, v8
    v_add_u32 v13, v13, v11
    ds_read_b64_tr_b16 v[92:93], v13 offset:16384
    ds_read_b64_tr_b16 v[94:95], v13 offset:16896
    s_lshl_b32 s44, s53, 2
    s_add_u32 s44, s44, 0
    s_mul_i32 s46, s44, 57
    s_lshr_b32 s46, s46, 9
    s_mul_i32 s47, s46, 9
    s_sub_u32 s47, s44, s47
    s_and_b32 s48, s46, 1
    s_sub_u32 s47, s47, s48
    s_lshl_b32 s48, s22, 1
    s_sub_u32 s48, s47, s48
    s_sub_u32 s48, s48, 2
    s_and_b32 s48, s48, 7
    s_cmp_ge_u32 s48, 6
    s_addc_u32 s48, s48, 0
    s_cmp_ge_u32 s47, 8
    s_cselect_b32 s48, 6, s48
    s_mul_i32 s44, s27, 7
    s_lshl_b32 s47, s27, 1
    s_add_u32 s47, s47, 56
    s_add_u32 s45, s27, 42
    s_add_u32 s45, s45, s48
    s_cmp_ge_u32 s27, 7
    s_cselect_b32 s44, s45, s44
    s_cmp_ge_u32 s48, 7
    s_cselect_b32 s44, s47, s44
    s_add_u32 s48, s48, s44
    s_mul_i32 s46, s46, 331776
    s_lshl_b32 s48, s48, 12
    s_add_u32 s51, s21, s46
    s_add_u32 s51, s51, s48
    s_waitcnt lgkmcnt(6)
    buffer_store_dwordx4 v[80:83], v4, s[40:43], s51 offen sc1
    s_lshl_b32 s44, s53, 2
    s_add_u32 s44, s44, 1
    s_mul_i32 s46, s44, 57
    s_lshr_b32 s46, s46, 9
    s_mul_i32 s47, s46, 9
    s_sub_u32 s47, s44, s47
    s_and_b32 s48, s46, 1
    s_sub_u32 s47, s47, s48
    s_lshl_b32 s48, s22, 1
    s_sub_u32 s48, s47, s48
    s_sub_u32 s48, s48, 2
    s_and_b32 s48, s48, 7
    s_cmp_ge_u32 s48, 6
    s_addc_u32 s48, s48, 0
    s_cmp_ge_u32 s47, 8
    s_cselect_b32 s48, 6, s48
    s_mul_i32 s44, s27, 7
    s_lshl_b32 s47, s27, 1
    s_add_u32 s47, s47, 56
    s_add_u32 s45, s27, 42
    s_add_u32 s45, s45, s48
    s_cmp_ge_u32 s27, 7
    s_cselect_b32 s44, s45, s44
    s_cmp_ge_u32 s48, 7
    s_cselect_b32 s44, s47, s44
    s_add_u32 s48, s48, s44
    s_mul_i32 s46, s46, 331776
    s_lshl_b32 s48, s48, 12
    s_add_u32 s51, s21, s46
    s_add_u32 s51, s51, s48
    s_waitcnt lgkmcnt(4)
    buffer_store_dwordx4 v[84:87], v4, s[40:43], s51 offen sc1
    s_lshl_b32 s44, s53, 2
    s_add_u32 s44, s44, 2
    s_mul_i32 s46, s44, 57
    s_lshr_b32 s46, s46, 9
    s_mul_i32 s47, s46, 9
    s_sub_u32 s47, s44, s47
    s_and_b32 s48, s46, 1
    s_sub_u32 s47, s47, s48
    s_lshl_b32 s48, s22, 1
    s_sub_u32 s48, s47, s48
    s_sub_u32 s48, s48, 2
    s_and_b32 s48, s48, 7
    s_cmp_ge_u32 s48, 6
    s_addc_u32 s48, s48, 0
    s_cmp_ge_u32 s47, 8
    s_cselect_b32 s48, 6, s48
    s_mul_i32 s44, s27, 7
    s_lshl_b32 s47, s27, 1
    s_add_u32 s47, s47, 56
    s_add_u32 s45, s27, 42
    s_add_u32 s45, s45, s48
    s_cmp_ge_u32 s27, 7
    s_cselect_b32 s44, s45, s44
    s_cmp_ge_u32 s48, 7
    s_cselect_b32 s44, s47, s44
    s_add_u32 s48, s48, s44
    s_mul_i32 s46, s46, 331776
    s_lshl_b32 s48, s48, 12
    s_add_u32 s51, s21, s46
    s_add_u32 s51, s51, s48
    s_waitcnt lgkmcnt(2)
    buffer_store_dwordx4 v[88:91], v4, s[40:43], s51 offen sc1
    s_lshl_b32 s44, s53, 2
    s_add_u32 s44, s44, 3
    s_mul_i32 s46, s44, 57
    s_lshr_b32 s46, s46, 9
    s_mul_i32 s47, s46, 9
    s_sub_u32 s47, s44, s47
    s_and_b32 s48, s46, 1
    s_sub_u32 s47, s47, s48
    s_lshl_b32 s48, s22, 1
    s_sub_u32 s48, s47, s48
    s_sub_u32 s48, s48, 2
    s_and_b32 s48, s48, 7
    s_cmp_ge_u32 s48, 6
    s_addc_u32 s48, s48, 0
    s_cmp_ge_u32 s47, 8
    s_cselect_b32 s48, 6, s48
    s_mul_i32 s44, s27, 7
    s_lshl_b32 s47, s27, 1
    s_add_u32 s47, s47, 56
    s_add_u32 s45, s27, 42
    s_add_u32 s45, s45, s48
    s_cmp_ge_u32 s27, 7
    s_cselect_b32 s44, s45, s44
    s_cmp_ge_u32 s48, 7
    s_cselect_b32 s44, s47, s44
    s_add_u32 s48, s48, s44
    s_mul_i32 s46, s46, 331776
    s_lshl_b32 s48, s48, 12
    s_add_u32 s51, s21, s46
    s_add_u32 s51, s51, s48
    s_waitcnt lgkmcnt(0)
    buffer_store_dwordx4 v[92:95], v4, s[40:43], s51 offen sc1
    s_add_u32 s53, s20, 2
    s_waitcnt vmcnt(20)
    s_cmp_eq_u32 s53, 2
    s_cselect_b32 s44, 8, 16
    s_cselect_b32 s46, 0, 0
    s_add_u32 s46, s46, 0
    v_mov_b32 v13, s46
    v_mad_u32_u24 v13, v9, s44, v13
    v_xor_b32 v13, v13, v8
    v_add_u32 v13, v13, v11
    ds_read_b64_tr_b16 v[96:97], v13 offset:20480
    ds_read_b64_tr_b16 v[98:99], v13 offset:20992
    s_cmp_eq_u32 s53, 2
    s_cselect_b32 s44, 8, 16
    s_cselect_b32 s46, 32, 8
    s_add_u32 s46, s46, 0
    v_mov_b32 v13, s46
    v_mad_u32_u24 v13, v9, s44, v13
    v_xor_b32 v13, v13, v8
    v_add_u32 v13, v13, v11
    ds_read_b64_tr_b16 v[100:101], v13 offset:20480
    ds_read_b64_tr_b16 v[102:103], v13 offset:20992
    s_cmp_eq_u32 s53, 6
    s_cselect_b32 s44, 8, 16
    s_cselect_b32 s46, 0, 0
    s_add_u32 s46, s46, 64
    v_mov_b32 v13, s46
    v_mad_u32_u24 v13, v9, s44, v13
    v_xor_b32 v13, v13, v8
    v_add_u32 v13, v13, v11
    ds_read_b64_tr_b16 v[104:105], v13 offset:20480
    ds_read_b64_tr_b16 v[106:107], v13 offset:20992
    s_cmp_eq_u32 s53, 6
    s_cselect_b32 s44, 8, 16
    s_cselect_b32 s46, 32, 8
    s_add_u32 s46, s46, 64
    v_mov_b32 v13, s46
    v_mad_u32_u24 v13, v9, s44, v13
    v_xor_b32 v13, v13, v8
    v_add_u32 v13, v13, v11
    ds_read_b64_tr_b16 v[108:109], v13 offset:20480
    ds_read_b64_tr_b16 v[110:111], v13 offset:20992
    s_lshl_b32 s44, s53, 2
    s_add_u32 s44, s44, 0
    s_mul_i32 s46, s44, 57
    s_lshr_b32 s46, s46, 9
    s_mul_i32 s47, s46, 9
    s_sub_u32 s47, s44, s47
    s_and_b32 s48, s46, 1
    s_sub_u32 s47, s47, s48
    s_lshl_b32 s48, s22, 1
    s_sub_u32 s48, s47, s48
    s_sub_u32 s48, s48, 2
    s_and_b32 s48, s48, 7
    s_cmp_ge_u32 s48, 6
    s_addc_u32 s48, s48, 0
    s_cmp_ge_u32 s47, 8
    s_cselect_b32 s48, 6, s48
    s_mul_i32 s44, s27, 7
    s_lshl_b32 s47, s27, 1
    s_add_u32 s47, s47, 56
    s_add_u32 s45, s27, 42
    s_add_u32 s45, s45, s48
    s_cmp_ge_u32 s27, 7
    s_cselect_b32 s44, s45, s44
    s_cmp_ge_u32 s48, 7
    s_cselect_b32 s44, s47, s44
    s_add_u32 s48, s48, s44
    s_mul_i32 s46, s46, 331776
    s_lshl_b32 s48, s48, 12
    s_add_u32 s51, s21, s46
    s_add_u32 s51, s51, s48
    s_waitcnt lgkmcnt(6)
    buffer_store_dwordx4 v[96:99], v4, s[40:43], s51 offen sc1
    s_lshl_b32 s44, s53, 2
    s_add_u32 s44, s44, 1
    s_mul_i32 s46, s44, 57
    s_lshr_b32 s46, s46, 9
    s_mul_i32 s47, s46, 9
    s_sub_u32 s47, s44, s47
    s_and_b32 s48, s46, 1
    s_sub_u32 s47, s47, s48
    s_lshl_b32 s48, s22, 1
    s_sub_u32 s48, s47, s48
    s_sub_u32 s48, s48, 2
    s_and_b32 s48, s48, 7
    s_cmp_ge_u32 s48, 6
    s_addc_u32 s48, s48, 0
    s_cmp_ge_u32 s47, 8
    s_cselect_b32 s48, 6, s48
    s_mul_i32 s44, s27, 7
    s_lshl_b32 s47, s27, 1
    s_add_u32 s47, s47, 56
    s_add_u32 s45, s27, 42
    s_add_u32 s45, s45, s48
    s_cmp_ge_u32 s27, 7
    s_cselect_b32 s44, s45, s44
    s_cmp_ge_u32 s48, 7
    s_cselect_b32 s44, s47, s44
    s_add_u32 s48, s48, s44
    s_mul_i32 s46, s46, 331776
    s_lshl_b32 s48, s48, 12
    s_add_u32 s51, s21, s46
    s_add_u32 s51, s51, s48
    s_waitcnt lgkmcnt(4)
    buffer_store_dwordx4 v[100:103], v4, s[40:43], s51 offen sc1
    s_lshl_b32 s44, s53, 2
    s_add_u32 s44, s44, 2
    s_mul_i32 s46, s44, 57
    s_lshr_b32 s46, s46, 9
    s_mul_i32 s47, s46, 9
    s_sub_u32 s47, s44, s47
    s_and_b32 s48, s46, 1
    s_sub_u32 s47, s47, s48
    s_lshl_b32 s48, s22, 1
    s_sub_u32 s48, s47, s48
    s_sub_u32 s48, s48, 2
    s_and_b32 s48, s48, 7
    s_cmp_ge_u32 s48, 6
    s_addc_u32 s48, s48, 0
    s_cmp_ge_u32 s47, 8
    s_cselect_b32 s48, 6, s48
    s_mul_i32 s44, s27, 7
    s_lshl_b32 s47, s27, 1
    s_add_u32 s47, s47, 56
    s_add_u32 s45, s27, 42
    s_add_u32 s45, s45, s48
    s_cmp_ge_u32 s27, 7
    s_cselect_b32 s44, s45, s44
    s_cmp_ge_u32 s48, 7
    s_cselect_b32 s44, s47, s44
    s_add_u32 s48, s48, s44
    s_mul_i32 s46, s46, 331776
    s_lshl_b32 s48, s48, 12
    s_add_u32 s51, s21, s46
    s_add_u32 s51, s51, s48
    s_waitcnt lgkmcnt(2)
    buffer_store_dwordx4 v[104:107], v4, s[40:43], s51 offen sc1
    s_lshl_b32 s44, s53, 2
    s_add_u32 s44, s44, 3
    s_mul_i32 s46, s44, 57
    s_lshr_b32 s46, s46, 9
    s_mul_i32 s47, s46, 9
    s_sub_u32 s47, s44, s47
    s_and_b32 s48, s46, 1
    s_sub_u32 s47, s47, s48
    s_lshl_b32 s48, s22, 1
    s_sub_u32 s48, s47, s48
    s_sub_u32 s48, s48, 2
    s_and_b32 s48, s48, 7
    s_cmp_ge_u32 s48, 6
    s_addc_u32 s48, s48, 0
    s_cmp_ge_u32 s47, 8
    s_cselect_b32 s48, 6, s48
    s_mul_i32 s44, s27, 7
    s_lshl_b32 s47, s27, 1
    s_add_u32 s47, s47, 56
    s_add_u32 s45, s27, 42
    s_add_u32 s45, s45, s48
    s_cmp_ge_u32 s27, 7
    s_cselect_b32 s44, s45, s44
    s_cmp_ge_u32 s48, 7
    s_cselect_b32 s44, s47, s44
    s_add_u32 s48, s48, s44
    s_mul_i32 s46, s46, 331776
    s_lshl_b32 s48, s48, 12
    s_add_u32 s51, s21, s46
    s_add_u32 s51, s51, s48
    s_waitcnt lgkmcnt(0)
    buffer_store_dwordx4 v[108:111], v4, s[40:43], s51 offen sc1
Lw2s_17:
    s_lshl_b32 s101, s23, 7
    s_add_u32 s101, s101, 61440
    s_waitcnt lgkmcnt(0)
    s_add_u32 s6, s10, 16
    s_barrier
    s_load_dwordx4 s[28:31], s[0:1], 48
    s_and_b32 s24, s7, 1
    s_lshl_b32 s24, s24, 2
    s_and_b32 s25, s8, 3
    s_add_u32 s24, s24, s25
    s_lshr_b32 s25, s8, 2
    s_lshr_b32 s26, s7, 1
    s_lshl_b32 s27, s26, 3
    s_add_u32 s27, s27, s25
    s_lshr_b32 s45, s3, 1
    s_and_b32 s46, s3, 1
    s_lshr_b32 s47, s27, 2
    s_mul_i32 s47, s47, 1152
    s_and_b32 s48, s27, 3
    s_lshl_b32 s49, s48, 7
    s_add_u32 s98, s47, s49
    s_mul_i32 s49, s46, 5059584
    s_add_u32 s83, s98, s49
    s_mul_i32 s49, s46, 2552832
    s_add_u32 s98, s98, s49
    s_mul_i32 s11, s3, 6144
    s_mul_i32 s80, s46, -18432
    s_add_u32 s80, s80, 9216
    s_mul_i32 s81, s80, 48
    s_lshl_b32 s82, s80, 5
    s_lshl_b32 s47, s80, 3
    s_sub_u32 s47, s47, 1024
    s_mul_i32 s48, s46, 2939904
    s_mul_i32 s49, s46, 2654208
    v_lshrrev_b32 v9, 3, v1
    v_and_b32 v8, 7, v1
    v_lshlrev_b32 v5, 1, v3
    v_xor_b32 v5, v5, v8
    v_lshlrev_b32 v5, 4, v5
    v_mul_lo_u32 v8, v9, s80
    v_cmp_eq_u32 vcc, 0, v9
    v_add3_u32 v5, v5, v8, s48
    v_add_u32 v6, s47, v5
    v_add_u32 v7, s47, v6
    v_add_u32 v8, s47, v7
    v_subrev_u32 v9, s49, v5
    v_cndmask_b32 v9, v5, v9, vcc
    s_mul_i32 s49, s46, 184320
    s_waitcnt lgkmcnt(0)
    s_cmp_eq_u32 s45, 0
    s_cselect_b32 s16, s28, s30
    s_cselect_b32 s17, s29, s31
    s_sub_u32 s16, s16, s49
    s_subb_u32 s17, s17, 0
    s_add_u32 s18, s49, 5308416
    s_mov_b32 s19, 0x20000
    s_mul_i32 s49, s81, 2
    s_add_u32 s49, s49, s98
    s_add_u32 m0, s11, 49152
    s_nop 0
    buffer_load_dwordx4 v5, s[16:19], s49 offen offset:0 lds
    buffer_load_dwordx4 v6, s[16:19], s49 offen offset:1024 lds
    buffer_load_dwordx4 v7, s[16:19], s49 offen offset:2048 lds
    buffer_load_dwordx4 v8, s[16:19], s49 offen offset:3072 lds
    s_add_u32 s49, s49, s82
    s_add_u32 m0, s11, 53248
    s_nop 0
    buffer_load_dwordx4 v5, s[16:19], s49 offen offset:0 lds
    buffer_load_dwordx4 v6, s[16:19], s49 offen offset:1024 lds
    s_waitcnt vmcnt(6)
    s_barrier
    s_cmp_lg_u32 s3, 0
    s_cbranch_scc1 Lcf
    v_mov_b32 v14, 0
    v_mov_b32 v15, s6
    s_mov_b64 exec, 1
    buffer_store_dword v15, v14, s[12:15], s101 offen sc1
    s_mov_b64 exec, -1
Lcf:
    s_mov_b32 s49, s98
    s_add_u32 m0, s11, 0
    s_nop 0
    buffer_load_dwordx4 v9, s[16:19], s49 offen offset:0 lds
    buffer_load_dwordx4 v6, s[16:19], s49 offen offset:1024 lds
    buffer_load_dwordx4 v7, s[16:19], s49 offen offset:2048 lds
    buffer_load_dwordx4 v8, s[16:19], s49 offen offset:3072 lds
    s_add_u32 s49, s49, s82
    s_add_u32 m0, s11, 4096
    s_nop 0
    buffer_load_dwordx4 v5, s[16:19], s49 offen offset:0 lds
    buffer_load_dwordx4 v6, s[16:19], s49 offen offset:1024 lds
    s_mul_i32 s49, s81, 1
    s_add_u32 s49, s49, s98
    s_add_u32 m0, s11, 24576
    s_nop 0
    buffer_load_dwordx4 v5, s[16:19], s49 offen offset:0 lds
    buffer_load_dwordx4 v6, s[16:19], s49 offen offset:1024 lds
    buffer_load_dwordx4 v7, s[16:19], s49 offen offset:2048 lds
    buffer_load_dwordx4 v8, s[16:19], s49 offen offset:3072 lds
    s_add_u32 s49, s49, s82
    s_add_u32 m0, s11, 28672
    s_nop 0
    buffer_load_dwordx4 v5, s[16:19], s49 offen offset:0 lds
    buffer_load_dwordx4 v6, s[16:19], s49 offen offset:1024 lds
    s_mul_i32 s49, s81, 4
    s_add_u32 s49, s49, s98
    s_add_u32 m0, s11, 98304
    s_nop 0
    buffer_load_dwordx4 v5, s[16:19], s49 offen offset:0 lds
    buffer_load_dwordx4 v6, s[16:19], s49 offen offset:1024 lds
    buffer_load_dwordx4 v7, s[16:19], s49 offen offset:2048 lds
    buffer_load_dwordx4 v8, s[16:19], s49 offen offset:3072 lds
    s_add_u32 s49, s49, s82
    s_add_u32 m0, s11, 102400
    s_nop 0
    buffer_load_dwordx4 v5, s[16:19], s49 offen offset:0 lds
    buffer_load_dwordx4 v6, s[16:19], s49 offen offset:1024 lds
    s_mul_i32 s49, s81, 3
    s_add_u32 s49, s49, s98
    s_add_u32 m0, s11, 73728
    s_nop 0
    buffer_load_dwordx4 v5, s[16:19], s49 offen offset:0 lds
    buffer_load_dwordx4 v6, s[16:19], s49 offen offset:1024 lds
    buffer_load_dwordx4 v7, s[16:19], s49 offen offset:2048 lds
    buffer_load_dwordx4 v8, s[16:19], s49 offen offset:3072 lds
    s_add_u32 s49, s49, s82
    s_add_u32 m0, s11, 77824
    s_nop 0
    buffer_load_dwordx4 v5, s[16:19], s49 offen offset:0 lds
    buffer_load_dwordx4 v6, s[16:19], s49 offen offset:1024 lds
    s_lshr_b32 s30, s25, 1
    s_lshl_b32 s29, s26, 2
    s_add_u32 s29, s29, s30
    s_mul_i32 s29, s29, 331776
    s_add_u32 s20, s4, 0x200000
    s_addc_u32 s21, s5, 0
    s_add_u32 s20, s20, s29
    s_addc_u32 s21, s21, 0
    s_mov_b32 s22, 331776
    s_mov_b32 s23, 0x20000
    s_add_u32 s32, s4, 0x980000
    s_addc_u32 s33, s5, 0
    s_mov_b32 s34, 0x244000
    s_mov_b32 s35, 0x20000
    s_add_u32 s36, s4, 0xc00000
    s_addc_u32 s37, s5, 0
    s_mov_b32 s38, 0x1200000
    s_mov_b32 s39, 0x20000
    s_lshl_b32 s28, s24, 2
    s_add_u32 s28, s28, s3
    s_lshl_b32 s28, s28, 2
    s_mul_i32 s31, s3, 9216
    s_mul_i32 s40, s28, 18432
    s_mul_i32 s41, s28, 147456
    s_mul_i32 s47, s26, 36864
    s_add_u32 s41, s41, s47
    s_lshl_b32 s48, s25, 9
    s_add_u32 s41, s41, s48
    s_and_b32 s49, s25, 1
    s_lshl_b32 s29, s49, 2
    s_add_u32 s29, s29, s3
    s_lshl_b32 s48, s24, 3
    s_add_u32 s29, s29, s48
    s_mul_i32 s42, s29, 294912
    s_add_u32 s42, s42, s47
    s_lshl_b32 s47, s24, 2
    s_add_u32 s47, s47, s26
    s_lshl_b32 s47, s47, 12
    s_add_u32 s47, s47, 262144
    s_lshl_b32 s44, s3, 10
    s_add_u32 s44, s44, s47
    s_lshl_b32 s48, s25, 7
    s_add_u32 s44, s44, s48
    s_lshl_b32 s49, s49, 1
    s_add_u32 s49, s49, s45
    s_lshl_b32 s49, s49, 10
    s_add_u32 s47, s47, s49
    s_mul_i32 s99, s27, 36864
    v_bfe_u32 v10, v1, 4, 1
    v_mul_u32_u24 v10, 147456, v10
    v_lshrrev_b32 v11, 5, v1
    v_lshl_add_u32 v11, v11, 4, v2
    v_lshl_add_u32 v10, v11, 4, v10
    v_add_u32 v11, 294912, v10
    v_and_b32 v13, 7, v1
    v_lshlrev_b32 v13, 7, v13
    v_add_u32 v16, 18432, v4
    v_add_u32 v17, 36864, v4
    v_add_u32 v18, 55296, v4
    v_add_u32 v19, 147456, v4
    v_add_u32 v20, s31, v4
    v_add_u32 v21, 65536, v4
    v_add_u32 v22, 131072, v4
    v_mov_b32 v23, 0
    v_mov_b32 v24, s6
    v_lshrrev_b32 v12, 2, v1
    v_bfe_u32 v14, v12, 1, 2
    v_lshlrev_b32 v12, 7, v12
    v_lshl_or_b32 v12, v14, 5, v12
    v_and_b32 v14, 3, v1
    v_lshl_or_b32 v12, v14, 3, v12
    v_and_b32 v15, 3, v1
    v_lshlrev_b32 v15, 7, v15
    s_lshl_b32 s85, s28, 7
    s_add_u32 s85, s85, 36864
    s_call_b64 s[96:97], LhopdispF
    s_branch Lffn
Lcodeend:
    s_endpgm
.section .rodata,"a"
.p2align 6
.amdhsa_kernel sequential_preLN__spectral_fnet__swiglu_ffn__prompt_kernel
  .amdhsa_next_free_vgpr 512
  .amdhsa_next_free_sgpr 102
  .amdhsa_accum_offset 256
  .amdhsa_group_segment_fixed_size 0
  .amdhsa_kernarg_size 96
  .amdhsa_user_sgpr_count 2
  .amdhsa_user_sgpr_kernarg_segment_ptr 1
  .amdhsa_system_sgpr_workgroup_id_x 1
  .amdhsa_float_denorm_mode_32 3
  .amdhsa_float_denorm_mode_16_64 3
.end_amdhsa_kernel
```
